```python
import torch

def _softmax(x, axis=-1):
    return torch.softmax(x, dim=axis)
def _gelu(x):
    return torch.nn.functional.gelu(x, approximate="tanh")
def _silu(x):
    return torch.nn.functional.silu(x)
def _sigmoid(x):
    return torch.sigmoid(x)
def _layernorm(x, axis=-1, eps=1e-5):
    m = x.mean(dim=axis, keepdim=True)
    v = x.var(dim=axis, keepdim=True, unbiased=False)
    return (x - m) / torch.sqrt(v + eps)
def _scatter_add(tgt, idx, src, axis=0):
    return tgt.clone().index_add_(axis, idx, src)
def _segment_sum(src, seg, n):
    out = torch.zeros((n,) + src.shape[1:], dtype=src.dtype)
    return out.index_add_(0, seg, src)
def _pad(x, pw):
    flat = tuple(v for pair in reversed(pw) for v in pair)
    return torch.nn.functional.pad(x, flat)

kernel_name = 'interleave_layers__grouped_kv_mqa__ssm_conv_h3__prompt'

def setup_inputs():

    _w = (lambda a: (lambda t: t.to(torch.bfloat16) if t.is_floating_point() else t)(torch.as_tensor(a)))
    def _A_setup():
        B, S, D, H = 1, 2048, 512, 32
        Dh = D // H
        return {
            "x": _w((lambda *s: torch.randn(*s, dtype=torch.bfloat16) * 0.05)(B, S, D)),
            "wq": _w((lambda *s: torch.randn(*s, dtype=torch.bfloat16) * 0.05)(D, H * Dh)),
            "wk": _w((lambda *s: torch.randn(*s, dtype=torch.bfloat16) * 0.05)(D, Dh)),
            "wv": _w((lambda *s: torch.randn(*s, dtype=torch.bfloat16) * 0.05)(D, Dh)),
            "wo": _w((lambda *s: torch.randn(*s, dtype=torch.bfloat16) * 0.05)(H * Dh, D)),
        }
    _A_in = _A_setup()

    def _B_setup():
        B, S, D = 1, 2048, 512
        ks = 4
        return {
            "q": _w((lambda *s: torch.randn(*s, dtype=torch.bfloat16) * 0.05)(B, S, D)),
            "k": _w((lambda *s: torch.randn(*s, dtype=torch.bfloat16) * 0.4)(B, S, D)),
            "v": _w((lambda *s: torch.randn(*s, dtype=torch.bfloat16) * 0.4)(B, S, D)),
            "shift_k": _w((lambda *s: torch.randn(*s, dtype=torch.bfloat16) * 0.4)(D, ks) * 0.5),
            "ssm_k": _w((lambda *s: torch.randn(*s, dtype=torch.bfloat16) * 0.8)(D, S) * (1.0 / S ** 0.5)),
            "ssm_D": _w((lambda *s: torch.randn(*s, dtype=torch.bfloat16) * 0.4)(D)),
        }
    _B_in = _B_setup()

    return {
        "A_x": _A_in["x"],
        "A_wq": _A_in["wq"],
        "A_wk": _A_in["wk"],
        "A_wv": _A_in["wv"],
        "A_wo": _A_in["wo"],
        "B_q": _B_in["q"],
        "B_k": _B_in["k"],
        "B_v": _B_in["v"],
        "B_shift_k": _B_in["shift_k"],
        "B_ssm_k": _B_in["ssm_k"],
        "B_ssm_D": _B_in["ssm_D"],
    }

def reference(A_x, A_wq, A_wk, A_wv, A_wo, B_q, B_k, B_v, B_shift_k, B_ssm_k, B_ssm_D):
    def _A_ref(x, wq, wk, wv, wo):
        B, S, D = x.shape
        H = 32
        Dh = D // H
        q = (lambda x, *d: x.permute(*d))((x @ wq).reshape(B, S, H, Dh), 0, 2, 1, 3)
        k = x @ wk
        v = x @ wv
        scores = torch.einsum("bhqd,bkd->bhqk", q, k) * (Dh ** -0.5)
        p = _softmax(scores, axis=-1)
        o = torch.einsum("bhqk,bkd->bhqd", p, v)
        return (lambda x, *d: x.permute(*d))(o, 0, 2, 1, 3).reshape(B, S, H * Dh) @ wo

    def _B_ref(q, k, v, shift_k, ssm_k, ssm_D):
        B, S, D = q.shape
        ks = shift_k.shape[-1]
        k_pad = _pad(k, ((0, 0), (ks - 1, 0), (0, 0)))
        k_shift = torch.zeros_like(k)
        for t in range(ks):
            k_shift = k_shift + k_pad[:, t:t + S, :] * shift_k[:, ks - 1 - t][None, None, :]
        kv = k_shift * v
        L = 2 * S
        kv_pad = _pad(kv, ((0, 0), (0, S), (0, 0)))
        kf_pad = _pad(ssm_k, ((0, 0), (0, S)))
        kv_f = (lambda x, axes=(-2,-1): torch.fft.rfft2(x.float(), dim=axes))(kv_pad[:, None, :, :], axes=(1, 2))
        kf_f = (lambda x, axes=(-2,-1): torch.fft.rfft2(x.float(), dim=axes))(kf_pad[:, None, :], axes=(1, 2))
        kf_f = (lambda x, *d: x.permute(*d))(kf_f, 1, 2, 0)
        y_f = kv_f * kf_f[None, :, :, :]
        y = (lambda x, s, axes=(-2,-1): torch.fft.irfft2(x, s=s, dim=axes).to(torch.bfloat16))(y_f, (1, L), axes=(1, 2))[:, 0, :S, :]
        y = y + kv * ssm_D[None, None, :]
        return q * y

    x = A_x
    x = x + _A_ref(_layernorm(x, axis=-1), A_wq, A_wk, A_wv, A_wo)
    x = x + _B_ref(_layernorm(x, axis=-1), B_k, B_v, B_shift_k, B_ssm_k, B_ssm_D)
    x = x + _A_ref(_layernorm(x, axis=-1), A_wq, A_wk, A_wv, A_wo)
    x = x + _B_ref(_layernorm(x, axis=-1), B_k, B_v, B_shift_k, B_ssm_k, B_ssm_D)
    return x
```

```asm
; @launch grid=(256,1,1) block=(512,1,1) lds=163840
.amdgcn_target "amdgcn-amd-amdhsa--gfx950"
.set EV_Q0, 0x8
.set EV_Q2, 0x10
.set EV_R1, 0x20
.set EV_R3, 0x24
.set EV_Q8, 0x38
.set EV_R6, 0x3c
.set EV_R7, 0x40
.set EV_Q12, 0x54
.set EV_R11, 0x58
.text
.globl interleave_layers__grouped_kv_mqa__ssm_conv_h3__prompt_kernel
.p2align 8
.type interleave_layers__grouped_kv_mqa__ssm_conv_h3__prompt_kernel,@function
interleave_layers__grouped_kv_mqa__ssm_conv_h3__prompt_kernel:
    s_cmp_ge_u32 s2, 256
    s_cbranch_scc1 EXIT
    s_load_dwordx16 s[4:19], s[0:1], 0
    s_load_dwordx8 s[20:27], s[0:1], 64
    s_load_dwordx4 s[28:31], s[0:1], 96
    s_getpc_b64 s[44:45]
PC0:
    s_mov_b32 s46, CODE_END-PC0
    s_mov_b32 s47, 0x20000
    s_lshr_b32 s53, s2, 3
    s_and_b32 s2, s2, 7
    s_lshl_b32 s2, s2, 5
    s_add_u32 s2, s2, s53
    s_sub_u32 s53, s53, 1984
    v_lshl_add_u32 v1, v0, 5, s53
    v_max_i32 v1, v1, v0
    v_lshlrev_b32 v1, 7, v1
    v_cmp_gt_u32 vcc, 0x80, v0
    s_cbranch_vccz NOPF
    buffer_load_dword v2, v1, s[44:47], 0 offen
NOPF:
    v_lshrrev_b32 v1, 6, v0
    v_and_b32 v61, 63, v0
    v_readfirstlane_b32 s48, v1
    v_lshlrev_b32 v53, 4, v61
    v_mov_b64 v[4:5], 0
    v_mov_b64 v[6:7], 0
    ds_write_b128 v53, v[4:7]
    s_and_b32 s50, s2, 3
    s_and_b32 s49, s48, 3
    s_lshl_b32 s57, s2, 3
    s_add_u32 s57, s57, s49
    s_lshl_b32 s57, s57, 10
    s_mul_i32 s66, s49, 24576
    s_add_u32 s66, s66, 65536
    s_mov_b32 s52, 0x100000
    s_mov_b32 s91, 0x3727c5ac
    s_lshl_b32 s53, s49, 6
    s_lshr_b32 s54, s2, 2
    s_add_u32 s53, s53, s54
    s_lshl_b32 s53, s53, 5
    s_add_u32 s53, s53, s50
    s_lshl_b32 s67, s53, 2
    v_and_b32 v12, 15, v61
    v_and_b32 v14, 16, v61
    v_cmp_ne_u32 vcc, 0, v14
    s_lshl_b32 s53, s2, 7
    s_and_b32 s54, s53, 0x7c00
    s_bfe_u32 s55, s2, 0x10001
    s_lshl_b32 s55, s55, 9
    s_add_u32 s54, s54, s55
    s_bfe_u32 s55, s2, 0x10002
    s_lshl_b32 s55, s55, 8
    s_add_u32 s54, s54, s55
    s_and_b32 s55, s2, 1
    s_lshl_b32 s55, s55, 3
    s_add_u32 s54, s54, s55
    s_add_u32 s54, s54, 32768
    v_lshrrev_b32 v13, 5, v61
    v_lshl_add_u32 v14, v12, 3, s53
    v_lshl_add_u32 v15, v12, 4, s54
    v_cndmask_b32 v14, v14, v15, vcc
    v_lshl_add_u32 v50, v13, 16, v14
    s_mul_i32 s3, s49, 5120
    s_add_u32 s3, s3, 28672
    s_cmp_eq_u32 s49, 3
    s_cselect_b32 s3, 2560, s3
    s_mov_b32 s34, 268435456
    s_mov_b32 s35, 0x20000
    s_cmp_ge_u32 s48, 4
    s_cbranch_scc1 H_PRE
    s_setprio 3
    s_add_u32 m0, s66, 16384
    s_add_u32 s56, s57, 2048
    v_add_u32 v1, s56, v53
    v_mov_b64 v[8:9], -1
    s_mov_b32 s53, 262144
    s_mov_b32 s54, 393216
    s_lshl_b32 s55, s49, 12
    s_mov_b32 s38, 16384
    s_mov_b32 s39, 0x20000
    s_cmp_eq_u32 s49, 0
    s_waitcnt lgkmcnt(0)
    s_load_dword s51, s[30:31], 0
    s_mov_b64 s[32:33], s[30:31]
    global_load_dwordx4 v[36:39], v1, s[4:5] offset:-2048
    global_load_dwordx4 v[40:43], v1, s[4:5] offset:2048
    s_cbranch_scc0 A_NOC
    buffer_store_dwordx2 v[8:9], v50, s[32:35], s53 offen sc1
    buffer_store_dwordx2 v[8:9], v50, s[32:35], s54 offen sc1
A_NOC:
    s_mov_b64 s[36:37], s[8:9]
    buffer_load_dwordx4 v53, s[36:39], s55 offen offset:0 lds
    buffer_load_dwordx4 v53, s[36:39], s55 offen offset:1024 lds
    buffer_load_dwordx4 v53, s[36:39], s55 offen offset:2048 lds
    buffer_load_dwordx4 v53, s[36:39], s55 offen offset:3072 lds
    s_add_u32 m0, s66, 20480
    s_mov_b64 s[36:37], s[10:11]
    buffer_load_dwordx4 v53, s[36:39], s55 offen offset:0 lds
    buffer_load_dwordx4 v53, s[36:39], s55 offen offset:1024 lds
    buffer_load_dwordx4 v53, s[36:39], s55 offen offset:2048 lds
    buffer_load_dwordx4 v53, s[36:39], s55 offen offset:3072 lds
    s_lshl_b32 s53, s49, 10
    v_add_u32 v3, s53, v53
    global_load_dwordx4 v[196:199], v3, s[20:21]
    s_cmp_eq_u32 s49, 3
    s_cbranch_scc0 A_NOO
    v_lshrrev_b32 v8, 2, v61
    v_and_b32 v9, 3, v61
    v_lshlrev_b32 v10, 10, v8
    v_lshl_add_u32 v10, v9, 4, v10
    v_add_u32 v11, 15360, v10
    s_bfe_u32 s53, s2, 0x20004
    s_lshl_b32 s54, s50, 2
    s_add_u32 s53, s53, s54
    s_lshl_b32 s53, s53, 15
    s_lshr_b32 s54, s2, 6
    s_lshl_b32 s54, s54, 8
    s_add_u32 s53, s53, s54
    s_bfe_u32 s54, s2, 0x20002
    s_lshl_b32 s54, s54, 6
    s_add_u32 s53, s53, s54
    s_mov_b32 m0, 44800
    s_mov_b64 s[36:37], s[12:13]
    s_mov_b32 s38, 524288
    s_mov_b32 s39, 0x20000
    buffer_load_dwordx4 v10, s[36:39], s53 offen lds
    buffer_load_dwordx4 v11, s[36:39], s53 offen offset:1024 lds
A_NOO:
    s_barrier
    v_lshrrev_b32 v13, 4, v61
    v_lshlrev_b32 v16, 8, v13
    v_lshl_add_u32 v16, v12, 3, v16
    v_add_u32 v46, s66, v16
    v_and_b32 v15, 3, v61
    v_mul_u32_u24 v16, 1056, v15
    v_lshl_add_u32 v16, v13, 4, v16
    v_bfe_u32 v17, v61, 2, 1
    v_mul_u32_u24 v18, 35328, v17
    s_lshl_b32 s53, s49, 8
    v_add3_u32 v47, v16, v18, s53
    s_lshl_b32 s53, s49, 10
    v_lshl_add_u32 v16, v17, 9, s53
    v_lshl_add_u32 v16, v15, 6, v16
    v_lshl_add_u32 v49, v13, 4, v16
    v_lshl_add_u32 v16, v13, 9, s53
    v_lshl_add_u32 v51, v12, 4, v16
    s_mul_i32 s53, s49, 1056
    v_add_u32 v45, s53, v53
    v_mov_b32 v52, 0xdddd
    s_mul_i32 s53, s49, 2304
    v_add_u32 v54, s53, v53
    v_and_b32 v12, 31, v61
    v_lshrrev_b32 v13, 5, v61
    v_lshlrev_b32 v56, 5, v12
    v_lshl_add_u32 v56, v13, 4, v56
    v_and_b32 v12, 15, v61
    v_cmp_eq_u32 vcc, 0, v12
    v_mov_b32 v58, 0x3f803f80
    s_lshl_b64 s[72:73], 1, s49
    s_mov_b32 s74, 0xffff
    s_mov_b32 s75, 0xffff
    s_lshl_b32 s76, s49, 13
    s_bfe_u32 s53, s2, 65552
    s_lshl_b32 s53, s53, 16
    s_add_u32 s79, s76, s53
    s_bfe_u32 s53, s2, 65552
    s_lshl_b32 s53, s53, 12
    s_add_u32 s79, s79, s53
    v_cndmask_b32 v58, 0, v58, vcc
    v_mov_b32 v59, v58
    v_mov_b64 v[72:73], v[58:59]
    v_mov_b64 v[74:75], v[58:59]
    v_mov_b64 v[84:85], v[58:59]
    v_mov_b64 v[86:87], v[58:59]
    v_mov_b64 v[96:97], v[58:59]
    v_mov_b64 v[98:99], v[58:59]
    v_mov_b64 v[108:109], v[58:59]
    v_mov_b64 v[110:111], v[58:59]
    v_mov_b64 v[120:121], v[58:59]
    v_mov_b64 v[122:123], v[58:59]
    v_mov_b64 v[132:133], v[58:59]
    v_mov_b64 v[134:135], v[58:59]
    v_mov_b64 v[144:145], v[58:59]
    v_mov_b64 v[146:147], v[58:59]
    v_mov_b64 v[156:157], v[58:59]
    v_mov_b64 v[158:159], v[58:59]
    v_mov_b64 v[168:169], v[58:59]
    v_mov_b64 v[170:171], v[58:59]
    v_mov_b64 v[180:181], v[58:59]
    v_mov_b64 v[182:183], v[58:59]
    v_mov_b64 v[192:193], v[58:59]
    v_mov_b64 v[194:195], v[58:59]
    v_mov_b64 v[204:205], v[58:59]
    v_mov_b64 v[206:207], v[58:59]
    v_mov_b64 v[216:217], v[58:59]
    v_mov_b64 v[218:219], v[58:59]
    v_mov_b64 v[228:229], v[58:59]
    v_mov_b64 v[230:231], v[58:59]
    v_mov_b64 v[240:241], v[58:59]
    v_mov_b64 v[242:243], v[58:59]
    v_mov_b64 v[252:253], v[58:59]
    v_mov_b64 v[254:255], v[58:59]
    s_waitcnt vmcnt(9)
    v_lshlrev_b32 v0, 16, v36
    v_and_b32 v1, 0xffff0000, v36
    v_lshlrev_b32 v2, 16, v37
    v_and_b32 v3, 0xffff0000, v37
    v_lshlrev_b32 v4, 16, v38
    v_and_b32 v5, 0xffff0000, v38
    v_lshlrev_b32 v6, 16, v39
    v_and_b32 v7, 0xffff0000, v39
    v_lshlrev_b32 v8, 16, v40
    v_and_b32 v9, 0xffff0000, v40
    v_lshlrev_b32 v10, 16, v41
    v_and_b32 v11, 0xffff0000, v41
    v_lshlrev_b32 v12, 16, v42
    v_and_b32 v13, 0xffff0000, v42
    v_lshlrev_b32 v14, 16, v43
    v_and_b32 v15, 0xffff0000, v43
    s_waitcnt lgkmcnt(0)
    s_mul_i32 s51, s51, 0x41c64e6d
    s_add_u32 s51, s51, 0x9e3779b9
    v_mov_b32 v62, s51
    s_cmp_eq_u32 s49, 0
    s_cbranch_scc0 A_NOF
    s_add_u32 s53, s67, 32768
    s_mov_b64 exec, 1
    buffer_store_dword v62, off, s[32:35], s53 sc1
    s_mov_b64 exec, -1
A_NOF:
    s_call_b64 s[62:63], LN2
    ds_write_b128 v45, v[28:31] offset:24448
    ds_write_b128 v45, v[32:35] offset:59776
    s_mov_b64 exec, 2
    ds_add_u32 v53, v61 offset:20
    s_mov_b64 exec, -1
    s_waitcnt vmcnt(3)
    s_cmp_eq_u32 s49, 3
    s_cbranch_scc1 A_WW
    s_waitcnt vmcnt(1)
A_WW:
    ds_read_b64_tr_b16 v[64:65], v46 offset:16384
    ds_read_b64_tr_b16 v[66:67], v46 offset:16512
    ds_read_b64_tr_b16 v[76:77], v46 offset:17408
    ds_read_b64_tr_b16 v[78:79], v46 offset:17536
    ds_read_b64_tr_b16 v[88:89], v46 offset:18432
    ds_read_b64_tr_b16 v[90:91], v46 offset:18560
    ds_read_b64_tr_b16 v[100:101], v46 offset:19456
    ds_read_b64_tr_b16 v[102:103], v46 offset:19584
    s_waitcnt lgkmcnt(4)
    ds_read_b64_tr_b16 v[68:69], v46 offset:20480
    ds_read_b64_tr_b16 v[70:71], v46 offset:20608
    ds_read_b64_tr_b16 v[80:81], v46 offset:21504
    ds_read_b64_tr_b16 v[82:83], v46 offset:21632
    ds_read_b64_tr_b16 v[92:93], v46 offset:22528
    ds_read_b64_tr_b16 v[94:95], v46 offset:22656
    ds_read_b64_tr_b16 v[104:105], v46 offset:23552
    ds_read_b64_tr_b16 v[106:107], v46 offset:23680
gw_1:
    ds_read_b32 v55, v53 offset:36
    s_sub_i32 s52, s52, 1
    s_waitcnt lgkmcnt(0)
    v_readfirstlane_b32 s53, v55
    s_cmp_lt_u32 s53, 4
    s_cselect_b32 s53, s52, 0
    s_cmp_gt_i32 s53, 0
    s_cbranch_scc1 gw_1
    ds_read_b128 v[8:11], v47 offset:24448
    ds_read_b128 v[12:15], v47 offset:24512
    ds_read_b128 v[16:19], v47 offset:24576
    ds_read_b128 v[20:23], v47 offset:24640
    s_waitcnt lgkmcnt(3)
    v_mfma_f32_16x16x32_bf16 v[24:27], v[64:67], v[8:11], 0
    v_mfma_f32_16x16x32_bf16 v[28:31], v[8:11], v[68:71], 0
    s_waitcnt lgkmcnt(2)
    v_mfma_f32_16x16x32_bf16 v[24:27], v[76:79], v[12:15], v[24:27]
    v_mfma_f32_16x16x32_bf16 v[28:31], v[12:15], v[80:83], v[28:31]
    s_waitcnt lgkmcnt(1)
    v_mfma_f32_16x16x32_bf16 v[24:27], v[88:91], v[16:19], v[24:27]
    v_mfma_f32_16x16x32_bf16 v[28:31], v[16:19], v[92:95], v[28:31]
    s_waitcnt lgkmcnt(0)
    v_mfma_f32_16x16x32_bf16 v[24:27], v[100:103], v[20:23], v[24:27]
    v_mfma_f32_16x16x32_bf16 v[28:31], v[20:23], v[104:107], v[28:31]
    s_mov_b32 s54, 262144
    s_nop 0
    s_nop 0
    s_nop 0
    s_nop 0
    s_mov_b32 exec_lo, 0xff00ff
    s_mov_b32 exec_hi, 0xff00ff
    ds_write_b128 v49, v[24:27] offset:7680
    s_mov_b32 exec_lo, -1
    s_mov_b32 exec_hi, 0
    ds_write_b128 v51, v[28:31] offset:7936
    s_mov_b64 exec, 2
    ds_add_u32 v53, v61 offset:4
    s_mov_b64 exec, -1
gw_2:
    ds_read_b32 v55, v53 offset:20
    s_sub_i32 s52, s52, 1
    s_waitcnt lgkmcnt(0)
    v_readfirstlane_b32 s53, v55
    s_cmp_lt_u32 s53, 4
    s_cselect_b32 s53, s52, 0
    s_cmp_gt_i32 s53, 0
    s_cbranch_scc1 gw_2
    s_cmp_eq_u32 s49, 0
    s_cbranch_scc0 kvend_3
    ds_read_b128 v[8:11], v53 offset:7680
    ds_read_b128 v[12:15], v53 offset:8704
    ds_read_b128 v[16:19], v53 offset:9728
    ds_read_b128 v[20:23], v53 offset:10752
    s_waitcnt lgkmcnt(2)
    v_pk_add_f32 v[8:9], v[8:9], v[12:13]
    v_pk_add_f32 v[10:11], v[10:11], v[14:15]
    s_waitcnt lgkmcnt(0)
    v_pk_add_f32 v[16:17], v[16:17], v[20:21]
    v_pk_add_f32 v[18:19], v[18:19], v[22:23]
    v_pk_add_f32 v[8:9], v[8:9], v[16:17]
    v_pk_add_f32 v[10:11], v[10:11], v[18:19]
    v_cvt_pk_bf16_f32 v8, v8, v9
    v_cvt_pk_bf16_f32 v9, v10, v11
    v_min_u32 v8, -2, v8
    buffer_store_dwordx2 v[8:9], v50, s[32:35], s54 offen sc1
kvend_3:
    s_cmp_eq_u32 s49, 3
    s_cbranch_scc0 A_NOP
    v_lshrrev_b32 v10, 4, v61
    v_and_b32 v11, 0xf0, v53
    v_lshl_add_u32 v10, v10, 9, v11
    s_lshl_b32 s53, s50, 17
    s_lshr_b32 s54, s2, 2
    s_lshl_b32 s54, s54, 11
    s_add_u32 s53, s53, s54
    s_add_u32 s69, s53, 1572864
    s_waitcnt vmcnt(0)
    ds_read_b64_tr_b16 v[208:209], v10 offset:44800
    ds_read_b64_tr_b16 v[210:211], v10 offset:45056
    ds_read_b64_tr_b16 v[212:213], v10 offset:44808
    ds_read_b64_tr_b16 v[214:215], v10 offset:45064
    s_waitcnt lgkmcnt(0)
    buffer_store_dwordx4 v[208:211], v53, s[32:35], s69 offen sc1
    buffer_store_dwordx4 v[212:215], v53, s[32:35], s69 offen offset:1024 sc1
A_NOP:
    s_cmp_lt_u32 s2, 8
    s_cbranch_scc0 A_NOS
    s_lshl_b32 s53, s49, 3
    s_add_u32 s53, s53, s2
    s_lshl_b32 s53, s53, 10
    s_add_u32 s71, s53, 524288
    s_cmp_eq_u32 s2, 1
    s_cbranch_scc0 st_4
    v_mov_b64 v[64:65], v[76:77]
    v_mov_b64 v[66:67], v[78:79]
st_4:
    s_cmp_eq_u32 s2, 2
    s_cbranch_scc0 st_5
    v_mov_b64 v[64:65], v[88:89]
    v_mov_b64 v[66:67], v[90:91]
st_5:
    s_cmp_eq_u32 s2, 3
    s_cbranch_scc0 st_6
    v_mov_b64 v[64:65], v[100:101]
    v_mov_b64 v[66:67], v[102:103]
st_6:
    s_cmp_eq_u32 s2, 4
    s_cbranch_scc0 st_7
    v_mov_b64 v[64:65], v[68:69]
    v_mov_b64 v[66:67], v[70:71]
st_7:
    s_cmp_eq_u32 s2, 5
    s_cbranch_scc0 st_8
    v_mov_b64 v[64:65], v[80:81]
    v_mov_b64 v[66:67], v[82:83]
st_8:
    s_cmp_eq_u32 s2, 6
    s_cbranch_scc0 st_9
    v_mov_b64 v[64:65], v[92:93]
    v_mov_b64 v[66:67], v[94:95]
st_9:
    s_cmp_eq_u32 s2, 7
    s_cbranch_scc0 st_10
    v_mov_b64 v[64:65], v[104:105]
    v_mov_b64 v[66:67], v[106:107]
st_10:
    buffer_store_dwordx4 v[64:67], v53, s[32:35], s71 offen sc1
A_NOS:
    v_lshrrev_b32 v60, 2, v61
    v_and_b32 v57, 3, v61
    v_lshlrev_b32 v60, 7, v60
    v_lshl_add_u32 v60, v57, 2, v60
    s_lshl_b32 s70, s49, 11
    s_add_u32 s70, s70, 32768
    v_lshl_add_u32 v44, v61, 2, s3
gw_11:
    ds_read_b32 v55, v53 offset:52
    s_sub_i32 s52, s52, 1
    s_waitcnt lgkmcnt(0)
    v_readfirstlane_b32 s53, v55
    s_cmp_lt_u32 s53, 4
    s_cselect_b32 s53, s52, 0
    s_cmp_gt_i32 s53, 0
    s_cbranch_scc1 gw_11
    ds_read2st64_b32 v[160:161], v44 offset0:0 offset1:1
    ds_read2st64_b32 v[162:163], v44 offset0:2 offset1:3
    ds_read2st64_b32 v[164:165], v44 offset0:4 offset1:5
    ds_read2st64_b32 v[166:167], v44 offset0:6 offset1:7
    ds_read2st64_b32 v[172:173], v44 offset0:8 offset1:9
    ds_read2st64_b32 v[174:175], v44 offset0:10 offset1:11
    ds_read2st64_b32 v[176:177], v44 offset0:12 offset1:13
    ds_read2st64_b32 v[178:179], v44 offset0:14 offset1:15
    ds_read2st64_b32 v[184:185], v44 offset0:16 offset1:17
    ds_read2st64_b32 v[186:187], v44 offset0:18 offset1:19
    s_cmp_eq_u32 s49, 1
    s_cselect_b32 s53, 2, s49
    s_cmp_eq_u32 s53, 2
    s_cbranch_scc0 A_TW
    s_waitcnt vmcnt(0)
A_TW:
    s_waitcnt lgkmcnt(0)
    v_lshlrev_b32 v22, 16, v196
    v_lshlrev_b32 v23, 16, v198
    v_and_b32 v24, 0xffff0000, v196
    v_and_b32 v25, 0xffff0000, v198
    v_lshlrev_b32 v26, 16, v197
    v_lshlrev_b32 v27, 16, v199
    v_and_b32 v28, 0xffff0000, v197
    v_and_b32 v29, 0xffff0000, v199
    v_lshlrev_b32 v0, 16, v161
    v_and_b32 v1, 0xffff0000, v161
    v_lshlrev_b32 v2, 16, v162
    v_and_b32 v3, 0xffff0000, v162
    v_lshlrev_b32 v4, 16, v163
    v_and_b32 v5, 0xffff0000, v163
    v_lshlrev_b32 v6, 16, v164
    v_and_b32 v7, 0xffff0000, v164
    v_lshlrev_b32 v8, 16, v165
    v_and_b32 v9, 0xffff0000, v165
    v_lshlrev_b32 v10, 16, v166
    v_and_b32 v11, 0xffff0000, v166
    v_lshlrev_b32 v12, 16, v167
    v_and_b32 v13, 0xffff0000, v167
    v_lshlrev_b32 v14, 16, v172
    v_and_b32 v15, 0xffff0000, v172
    v_lshlrev_b32 v16, 16, v173
    v_and_b32 v17, 0xffff0000, v173
    v_lshlrev_b32 v18, 16, v174
    v_and_b32 v19, 0xffff0000, v174
    v_lshlrev_b32 v20, 16, v175
    v_and_b32 v21, 0xffff0000, v175
    v_pk_mul_f32 v[30:31], v[6:7], v[22:23]
    v_lshlrev_b32 v46, 16, v176
    v_and_b32 v47, 0xffff0000, v176
    v_pk_fma_f32 v[30:31], v[4:5], v[24:25], v[30:31]
    v_pk_fma_f32 v[30:31], v[2:3], v[26:27], v[30:31]
    v_pk_fma_f32 v[30:31], v[0:1], v[28:29], v[30:31]
    v_pk_mul_f32 v[30:31], v[30:31], v[46:47]
    v_pk_mul_f32 v[32:33], v[8:9], v[22:23]
    v_lshlrev_b32 v46, 16, v177
    v_and_b32 v47, 0xffff0000, v177
    v_pk_fma_f32 v[32:33], v[6:7], v[24:25], v[32:33]
    v_pk_fma_f32 v[32:33], v[4:5], v[26:27], v[32:33]
    v_pk_fma_f32 v[32:33], v[2:3], v[28:29], v[32:33]
    v_pk_mul_f32 v[32:33], v[32:33], v[46:47]
    v_pk_mul_f32 v[34:35], v[10:11], v[22:23]
    v_lshlrev_b32 v46, 16, v178
    v_and_b32 v47, 0xffff0000, v178
    v_pk_fma_f32 v[34:35], v[8:9], v[24:25], v[34:35]
    v_pk_fma_f32 v[34:35], v[6:7], v[26:27], v[34:35]
    v_pk_fma_f32 v[34:35], v[4:5], v[28:29], v[34:35]
    v_pk_mul_f32 v[34:35], v[34:35], v[46:47]
    v_pk_mul_f32 v[36:37], v[12:13], v[22:23]
    v_lshlrev_b32 v46, 16, v179
    v_and_b32 v47, 0xffff0000, v179
    v_pk_fma_f32 v[36:37], v[10:11], v[24:25], v[36:37]
    v_pk_fma_f32 v[36:37], v[8:9], v[26:27], v[36:37]
    v_pk_fma_f32 v[36:37], v[6:7], v[28:29], v[36:37]
    v_pk_mul_f32 v[36:37], v[36:37], v[46:47]
    v_pk_mul_f32 v[38:39], v[14:15], v[22:23]
    v_lshlrev_b32 v46, 16, v184
    v_and_b32 v47, 0xffff0000, v184
    v_pk_fma_f32 v[38:39], v[12:13], v[24:25], v[38:39]
    v_pk_fma_f32 v[38:39], v[10:11], v[26:27], v[38:39]
    v_pk_fma_f32 v[38:39], v[8:9], v[28:29], v[38:39]
    v_pk_mul_f32 v[38:39], v[38:39], v[46:47]
    v_pk_mul_f32 v[40:41], v[16:17], v[22:23]
    v_lshlrev_b32 v46, 16, v185
    v_and_b32 v47, 0xffff0000, v185
    v_pk_fma_f32 v[40:41], v[14:15], v[24:25], v[40:41]
    v_pk_fma_f32 v[40:41], v[12:13], v[26:27], v[40:41]
    v_pk_fma_f32 v[40:41], v[10:11], v[28:29], v[40:41]
    v_pk_mul_f32 v[40:41], v[40:41], v[46:47]
    v_pk_mul_f32 v[42:43], v[18:19], v[22:23]
    v_lshlrev_b32 v46, 16, v186
    v_and_b32 v47, 0xffff0000, v186
    v_pk_fma_f32 v[42:43], v[16:17], v[24:25], v[42:43]
    v_pk_fma_f32 v[42:43], v[14:15], v[26:27], v[42:43]
    v_pk_fma_f32 v[42:43], v[12:13], v[28:29], v[42:43]
    v_pk_mul_f32 v[42:43], v[42:43], v[46:47]
    v_pk_mul_f32 v[44:45], v[20:21], v[22:23]
    v_lshlrev_b32 v46, 16, v187
    v_and_b32 v47, 0xffff0000, v187
    v_pk_fma_f32 v[44:45], v[18:19], v[24:25], v[44:45]
    v_pk_fma_f32 v[44:45], v[16:17], v[26:27], v[44:45]
    v_pk_fma_f32 v[44:45], v[14:15], v[28:29], v[44:45]
    v_pk_mul_f32 v[44:45], v[44:45], v[46:47]
    v_cvt_pk_bf16_f32 v0, v44, v42
    v_cvt_pk_bf16_f32 v4, v45, v43
    v_cvt_pk_bf16_f32 v1, v40, v38
    v_cvt_pk_bf16_f32 v5, v41, v39
    v_cvt_pk_bf16_f32 v2, v36, v34
    v_cvt_pk_bf16_f32 v6, v37, v35
    v_cvt_pk_bf16_f32 v3, v32, v30
    v_cvt_pk_bf16_f32 v7, v33, v31
    buffer_load_dword v57, v60, s[32:35], s70 offen sc1
    s_lshl_b32 s53, s49, 10
    s_add_u32 s53, s53, s57
    s_add_u32 s53, s53, 2097152
    v_permlane32_swap_b32 v0, v4
    v_permlane32_swap_b32 v1, v5
    v_permlane32_swap_b32 v2, v6
    v_permlane32_swap_b32 v3, v7
    buffer_store_dwordx4 v[0:3], v56, s[32:35], s53 offen offset:0 sc1
    buffer_store_dwordx4 v[4:7], v56, s[32:35], s53 offen offset:1024 sc1
    s_mul_i32 s53, s49, 1056
    v_add_u32 v45, s53, v53
gw_12:
    ds_read_b32 v55, v53 offset:44
    s_sub_i32 s52, s52, 1
    s_waitcnt lgkmcnt(0)
    v_readfirstlane_b32 s53, v55
    s_cmp_lt_u32 s53, 4
    s_cselect_b32 s53, s52, 0
    s_cmp_gt_i32 s53, 0
    s_cbranch_scc1 gw_12
    ds_read_b128 v[112:115], v45 offset:11776
    ds_read_b128 v[116:119], v45 offset:16000
    s_waitcnt lgkmcnt(0)
    v_lshlrev_b32 v0, 16, v112
    v_and_b32 v1, 0xffff0000, v112
    v_lshlrev_b32 v2, 16, v113
    v_and_b32 v3, 0xffff0000, v113
    v_lshlrev_b32 v4, 16, v114
    v_and_b32 v5, 0xffff0000, v114
    v_lshlrev_b32 v6, 16, v115
    v_and_b32 v7, 0xffff0000, v115
    v_lshlrev_b32 v8, 16, v116
    v_and_b32 v9, 0xffff0000, v116
    v_lshlrev_b32 v10, 16, v117
    v_and_b32 v11, 0xffff0000, v117
    v_lshlrev_b32 v12, 16, v118
    v_and_b32 v13, 0xffff0000, v118
    v_lshlrev_b32 v14, 16, v119
    v_and_b32 v15, 0xffff0000, v119
    s_call_b64 s[62:63], LN2
    ds_write_b128 v45, v[28:31] offset:11776
    ds_write_b128 v45, v[32:35] offset:16000
    s_mov_b64 exec, 2
    ds_add_u32 v53, v61 offset:8
    s_mov_b64 exec, -1
    ds_read_b128 v[160:163], v45 offset:51328
    ds_read_b128 v[164:167], v45 offset:55552
    s_branch A_MAIN
LN2:
    v_pk_add_f32 v[16:17], v[0:1], v[2:3]
    v_pk_add_f32 v[22:23], v[8:9], v[10:11]
    v_pk_mul_f32 v[20:21], v[0:1], v[0:1]
    v_pk_mul_f32 v[26:27], v[8:9], v[8:9]
    v_pk_add_f32 v[18:19], v[4:5], v[6:7]
    v_pk_add_f32 v[24:25], v[12:13], v[14:15]
    v_pk_fma_f32 v[20:21], v[2:3], v[2:3], v[20:21]
    v_pk_fma_f32 v[26:27], v[10:11], v[10:11], v[26:27]
    v_pk_add_f32 v[16:17], v[16:17], v[18:19]
    v_pk_add_f32 v[22:23], v[22:23], v[24:25]
    v_pk_fma_f32 v[20:21], v[4:5], v[4:5], v[20:21]
    v_pk_fma_f32 v[26:27], v[12:13], v[12:13], v[26:27]
    v_add_f32 v16, v16, v17
    v_add_f32 v22, v22, v23
    v_pk_fma_f32 v[20:21], v[6:7], v[6:7], v[20:21]
    v_pk_fma_f32 v[26:27], v[14:15], v[14:15], v[26:27]
    v_add_f32 v17, v20, v21
    v_add_f32 v23, v26, v27
    s_nop 0
    v_permlane32_swap_b32 v16, v17
    v_permlane32_swap_b32 v22, v23
    v_add_f32 v16, v16, v17
    v_add_f32 v22, v22, v23
    s_nop 0
    s_nop 0
    v_permlane16_swap_b32 v16, v22
    v_add_f32 v16, v16, v22
    s_nop 0
    s_nop 0
    v_add_f32_dpp v16, v16, v16 quad_perm:[1,0,3,2] row_mask:0xf bank_mask:0xf
    s_nop 0
    s_nop 0
    v_add_f32_dpp v16, v16, v16 quad_perm:[2,3,0,1] row_mask:0xf bank_mask:0xf
    s_nop 0
    s_nop 0
    v_add_f32_dpp v16, v16, v16 row_half_mirror row_mask:0xf bank_mask:0xf
    s_nop 0
    s_nop 0
    v_add_f32_dpp v16, v16, v16 row_mirror row_mask:0xf bank_mask:0xf
    v_mul_f32 v16, 0x3b000000, v16
    s_nop 0
    v_readlane_b32 s59, v16, 32
    v_readlane_b32 s61, v16, 48
    v_readlane_b32 s58, v16, 0
    v_readlane_b32 s60, v16, 16
    v_mov_b32 v16, s59
    v_mov_b32 v22, s61
    v_fma_f32 v16, -s58, s58, v16
    v_fma_f32 v22, -s60, s60, v22
    v_add_f32 v16, s91, abs(v16)
    v_add_f32 v22, s91, abs(v22)
    v_rsq_f32 v16, v16
    v_rsq_f32 v22, v22
    v_mul_f32 v17, s58, v16
    v_mul_f32 v23, s60, v22
    v_pk_fma_f32 v[0:1], v[0:1], v[16:17], v[16:17] op_sel:[0,0,1] op_sel_hi:[1,0,1] neg_lo:[0,0,1] neg_hi:[0,0,1]
    v_pk_fma_f32 v[2:3], v[2:3], v[16:17], v[16:17] op_sel:[0,0,1] op_sel_hi:[1,0,1] neg_lo:[0,0,1] neg_hi:[0,0,1]
    v_pk_fma_f32 v[4:5], v[4:5], v[16:17], v[16:17] op_sel:[0,0,1] op_sel_hi:[1,0,1] neg_lo:[0,0,1] neg_hi:[0,0,1]
    v_pk_fma_f32 v[6:7], v[6:7], v[16:17], v[16:17] op_sel:[0,0,1] op_sel_hi:[1,0,1] neg_lo:[0,0,1] neg_hi:[0,0,1]
    v_cvt_pk_bf16_f32 v28, v0, v1
    v_cvt_pk_bf16_f32 v29, v2, v3
    v_cvt_pk_bf16_f32 v30, v4, v5
    v_cvt_pk_bf16_f32 v31, v6, v7
    v_pk_fma_f32 v[8:9], v[8:9], v[22:23], v[22:23] op_sel:[0,0,1] op_sel_hi:[1,0,1] neg_lo:[0,0,1] neg_hi:[0,0,1]
    v_pk_fma_f32 v[10:11], v[10:11], v[22:23], v[22:23] op_sel:[0,0,1] op_sel_hi:[1,0,1] neg_lo:[0,0,1] neg_hi:[0,0,1]
    v_pk_fma_f32 v[12:13], v[12:13], v[22:23], v[22:23] op_sel:[0,0,1] op_sel_hi:[1,0,1] neg_lo:[0,0,1] neg_hi:[0,0,1]
    v_pk_fma_f32 v[14:15], v[14:15], v[22:23], v[22:23] op_sel:[0,0,1] op_sel_hi:[1,0,1] neg_lo:[0,0,1] neg_hi:[0,0,1]
    v_cvt_pk_bf16_f32 v32, v8, v9
    v_cvt_pk_bf16_f32 v33, v10, v11
    v_cvt_pk_bf16_f32 v34, v12, v13
    v_cvt_pk_bf16_f32 v35, v14, v15
    s_setpc_b64 s[62:63]
H_PRE:
    v_mov_b32 v128, v61
    v_mov_b32 v129, v53
    v_mov_b32 v140, v50
    v_and_b32 v1, 15, v128
    v_lshrrev_b32 v3, 4, v128
    v_and_b32 v8, 3, v128
    v_lshrrev_b32 v9, 2, v1
    v_and_b32 v10, 1, v3
    v_lshrrev_b32 v11, 1, v3
    v_mov_b64 v[144:145], -1
    v_mov_b64 v[146:147], -1
    v_lshrrev_b32 v12, 2, v128
    v_lshrrev_b32 v13, 3, v128
    v_lshlrev_b32 v13, 10, v13
    v_and_b32 v14, 0x70, v129
    v_lshlrev_b32 v15, 5, v10
    v_xad_u32 v148, v14, v15, v13
    v_xor_b32 v13, 64, v148
    v_add_u32 v149, 7168, v13
    v_add_u32 v150, 14336, v148
    v_add_u32 v151, 21504, v13
    s_and_b32 s53, s2, 0xc
    s_lshl_b32 s87, s53, 10
    s_lshl_b32 s68, s53, 13
    s_lshl_b32 s53, s50, 8
    s_add_u32 s68, s68, s53
    s_lshl_b32 s53, s49, 17
    s_add_u32 s68, s68, s53
    v_lshrrev_b32 v17, 1, v9
    v_lshl_add_u32 v13, v10, 1, v17
    v_xor_b32 v13, s49, v13
    v_lshlrev_b32 v14, 10, v3
    v_lshl_add_u32 v14, v9, 7, v14
    v_lshl_add_u32 v14, v13, 5, v14
    v_lshl_add_u32 v14, v8, 3, v14
    v_add_u32 v152, 65536, v14
    v_add_u32 v153, 114688, v14
    v_mul_u32_u24 v13, 1056, v1
    v_lshl_add_u32 v130, v3, 4, v13
    v_lshlrev_b32 v14, 9, v11
    v_lshl_add_u32 v14, v10, 3, v14
    v_lshlrev_b32 v13, 10, v9
    v_lshl_add_u32 v13, v8, 4, v13
    s_lshl_b32 s53, s49, 6
    v_add3_u32 v131, v13, v14, s53
    v_mul_u32_u24 v18, 768, v9
    v_sub_u32 v18, v131, v18
    v_lshl_add_u32 v154, v17, 9, v18
    v_lshl_add_u32 v13, v10, 9, v13
    v_lshl_add_u32 v132, v11, 6, v13
    s_lshl_b32 s53, s49, 6
    v_lshl_add_u32 v14, v12, 8, s53
    v_lshl_add_u32 v136, v8, 4, v14
    s_lshl_b32 s53, s49, 9
    v_lshl_add_u32 v133, v128, 3, s53
    v_mul_u32_u24 v14, 2112, v8
    v_lshl_add_u32 v14, v3, 5, v14
    v_add_u32 v14, s53, v14
    v_mov_b32 v15, 172032
    v_cmp_eq_u32 vcc, 3, v9
    v_lshrrev_b32 v13, 1, v128
    v_lshlrev_b32 v16, 2, v13
    v_cndmask_b32 v138, v15, v14, vcc
    v_add_u32 v134, 30720, v16
    s_add_u32 s53, s50, 1
    v_add_u32 v14, s53, v9
    v_and_b32 v14, 3, v14
    v_lshlrev_b32 v14, 14, v14
    v_lshl_add_u32 v14, v8, 6, v14
    v_lshl_add_u32 v14, v3, 4, v14
    v_mov_b32 v15, 2146435072
    v_cndmask_b32 v137, v14, v15, vcc
    s_and_b32 s80, s53, 3
    s_add_u32 s53, s50, 2
    s_and_b32 s81, s53, 3
    s_add_u32 s53, s50, 3
    s_and_b32 s82, s53, 3
    s_lshr_b32 s53, s49, 1
    s_lshl_b32 s53, s53, 9
    s_and_b32 s54, s49, 1
    s_lshl_b32 s54, s54, 3
    s_add_u32 s53, s53, s54
    v_and_b32 v15, 1, v128
    v_lshl_add_u32 v14, v13, 4, s53
    v_lshl_add_u32 v135, v15, 2, v14
    v_add_u32 v139, s66, v129
    s_mov_b32 s72, 0x3eb8aa3b
    s_mov_b32 s75, 0x3f80
    s_mov_b32 s76, 0x3f800000
    s_mov_b32 s78, 0x17800000
    s_mov_b32 s79, 0x50000000
    s_mov_b32 s85, 4
    v_lshlrev_b32 v188, 10, v3
    v_lshl_add_u32 v188, v1, 4, v188
    s_cmp_eq_u32 s2, 0
    s_cselect_b32 s55, 2146435072, 0
    v_add_u32 v189, s55, v188
    s_cselect_b32 s55, 0, 4096
    s_lshl_b32 s69, s2, 13
    s_lshl_b32 s54, s49, 8
    s_add_u32 s69, s69, s54
    s_sub_u32 s71, s69, s55
    s_add_u32 s70, s69, 4096
    s_waitcnt lgkmcnt(0)
    s_load_dword s51, s[30:31], 0
    s_mov_b64 s[32:33], s[30:31]
    s_mov_b64 s[40:41], s[6:7]
    s_mov_b32 s42, 524288
    s_mov_b32 s43, 0x20000
    s_mov_b64 s[44:45], s[18:19]
    s_mov_b32 s46, 2097152
    s_mov_b32 s47, 0x20000
    s_and_b32 s55, s57, 0x1f8fff
    s_mul_i32 s56, s49, 1056
    s_setprio 2
    s_barrier
    s_mov_b64 s[36:37], s[16:17]
    s_mov_b32 s38, 2097152
    s_mov_b32 s39, 0x20000
    s_add_u32 m0, s3, 0
    s_nop 0
    buffer_load_dwordx4 v189, s[36:39], s71 offen lds
    s_add_u32 m0, s3, 1024
    s_nop 0
    buffer_load_dwordx4 v188, s[36:39], s69 offen lds
    s_add_u32 m0, s3, 2048
    s_nop 0
    buffer_load_dwordx4 v188, s[36:39], s70 offen lds
    s_add_u32 m0, s3, 3072
    s_nop 0
    buffer_load_dwordx4 v188, s[44:47], s69 offen lds
    s_add_u32 m0, s3, 4096
    s_nop 0
    buffer_load_dwordx4 v188, s[44:47], s70 offen lds
    s_mov_b64 s[36:37], s[4:5]
    s_mov_b32 s38, 2097152
    s_mov_b32 s39, 0x20000
    s_add_u32 m0, s56, 11776
    s_lshl_b32 s53, s80, 13
    s_add_u32 s53, s53, s55
    buffer_load_dwordx4 v53, s[36:39], s53 offen lds
    s_add_u32 m0, s56, 16000
    s_lshl_b32 s53, s81, 13
    s_add_u32 s53, s53, s55
    buffer_load_dwordx4 v53, s[36:39], s53 offen lds
    s_lshl_b32 s53, s82, 13
    s_add_u32 s53, s53, s55
    buffer_load_dwordx4 v[204:207], v53, s[36:39], s53 offen
    s_add_u32 s55, s55, 4096
    s_lshl_b32 s53, s80, 13
    s_add_u32 s53, s53, s55
    buffer_load_dwordx4 v[208:211], v53, s[36:39], s53 offen
    s_add_u32 m0, s56, 51328
    s_lshl_b32 s53, s81, 13
    s_add_u32 s53, s53, s55
    buffer_load_dwordx4 v53, s[36:39], s53 offen lds
    s_add_u32 m0, s56, 55552
    s_lshl_b32 s53, s82, 13
    s_add_u32 s53, s53, s55
    buffer_load_dwordx4 v53, s[36:39], s53 offen lds
    s_waitcnt lgkmcnt(0)
    s_mul_i32 s51, s51, 0x41c64e6d
    s_add_u32 s51, s51, 0x9e3779b9
    v_add_u32 v45, s56, v129
    s_waitcnt vmcnt(8)
    s_xor_b32 s53, s87, 0
    s_add_u32 m0, s66, s53
    s_xor_b32 s53, s68, 0
    buffer_load_dwordx4 v148, s[40:43], s53 offen offset:0 lds
    buffer_load_dwordx4 v149, s[40:43], s53 offen offset:1024 lds
    buffer_load_dwordx4 v150, s[40:43], s53 offen offset:2048 lds
    buffer_load_dwordx4 v151, s[40:43], s53 offen offset:3072 lds
    s_waitcnt vmcnt(10)
    s_mov_b64 exec, 2
    ds_add_u32 v129, v128 offset:36
    s_mov_b64 exec, -1
    s_waitcnt vmcnt(8)
    s_xor_b32 s53, s87, 4096
    s_add_u32 m0, s66, s53
    s_xor_b32 s53, s68, 32768
    buffer_load_dwordx4 v148, s[40:43], s53 offen offset:0 lds
    buffer_load_dwordx4 v149, s[40:43], s53 offen offset:1024 lds
    buffer_load_dwordx4 v150, s[40:43], s53 offen offset:2048 lds
    buffer_load_dwordx4 v151, s[40:43], s53 offen offset:3072 lds
    s_waitcnt vmcnt(8)
    s_mov_b64 exec, 2
    ds_add_u32 v129, v128 offset:28
    s_mov_b64 exec, -1
    s_xor_b32 s53, s87, 8192
    s_add_u32 m0, s66, s53
    s_xor_b32 s53, s68, 65536
    buffer_load_dwordx4 v148, s[40:43], s53 offen offset:0 lds
    buffer_load_dwordx4 v149, s[40:43], s53 offen offset:1024 lds
    buffer_load_dwordx4 v150, s[40:43], s53 offen offset:2048 lds
    buffer_load_dwordx4 v151, s[40:43], s53 offen offset:3072 lds
    v_lshlrev_b32 v0, 16, v204
    v_and_b32 v1, 0xffff0000, v204
    v_lshlrev_b32 v2, 16, v205
    v_and_b32 v3, 0xffff0000, v205
    v_lshlrev_b32 v4, 16, v206
    v_and_b32 v5, 0xffff0000, v206
    v_lshlrev_b32 v6, 16, v207
    v_and_b32 v7, 0xffff0000, v207
    v_lshlrev_b32 v8, 16, v208
    v_and_b32 v9, 0xffff0000, v208
    v_lshlrev_b32 v10, 16, v209
    v_and_b32 v11, 0xffff0000, v209
    v_lshlrev_b32 v12, 16, v210
    v_and_b32 v13, 0xffff0000, v210
    v_lshlrev_b32 v14, 16, v211
    v_and_b32 v15, 0xffff0000, v211
    s_call_b64 s[62:63], LN2
    ds_write_b128 v45, v[28:31] offset:20224
    ds_write_b128 v45, v[32:35] offset:47104
    s_mov_b64 exec, 2
    ds_add_u32 v129, v128 offset:8
    s_mov_b64 exec, -1
    s_waitcnt vmcnt(8)
    s_xor_b32 s53, s87, 12288
    s_add_u32 m0, s66, s53
    s_xor_b32 s53, s68, 98304
    buffer_load_dwordx4 v148, s[40:43], s53 offen offset:0 lds
    buffer_load_dwordx4 v149, s[40:43], s53 offen offset:1024 lds
    buffer_load_dwordx4 v150, s[40:43], s53 offen offset:2048 lds
    buffer_load_dwordx4 v151, s[40:43], s53 offen offset:3072 lds
    v_lshrrev_b32 v196, 4, v128
    v_and_b32 v197, 15, v128
    v_lshrrev_b32 v198, 5, v128
    v_and_b32 v199, 31, v128
    v_lshlrev_b32 v200, 4, v198
    v_lshl_add_u32 v195, v199, 5, v200
    v_lshl_add_u32 v193, v199, 13, v200
    v_sub_u32 v200, v197, v198
    v_and_b32 v196, 1, v196
    v_mul_u32_u24 v196, 1280, v196
    v_lshl_add_u32 v200, v200, 4, v196
    s_add_u32 s53, s66, 16672
    v_add_u32 v142, s53, v200
    v_lshrrev_b32 v196, 2, v128
    v_and_b32 v197, 3, v128
    v_lshlrev_b32 v196, 7, v196
    v_lshl_add_u32 v194, v197, 2, v196
    v_lshrrev_b32 v196, 1, v128
    v_and_b32 v197, 1, v128
    v_xor_b32 v197, 1, v197
    v_mul_u32_u24 v197, 4160, v197
    v_lshl_add_u32 v197, v196, 2, v197
    s_add_u32 s53, s66, 8196
    v_add_u32 v252, s53, v197
    v_add_u32 v253, 1024, v252
    v_add_u32 v254, 2048, v252
    v_add_u32 v255, 3072, v252
    s_and_b32 s74, s2, 0xfc
    s_lshl_b32 s74, s74, 14
    s_lshl_b32 s54, s50, 12
    s_add_u32 s74, s74, s54
    s_lshl_b32 s54, s49, 10
    s_add_u32 s74, s74, s54
    s_add_u32 s74, s74, 16777216
    s_lshl_b32 s77, s50, 17
    s_lshl_b32 s53, s49, 15
    s_add_u32 s77, s77, s53
    s_add_u32 s77, s77, 1572864
    v_and_b32 v164, 0xf0, v129
    v_lshlrev_b32 v164, 3, v164
    v_and_b32 v165, 0xff, v194
    s_lshr_b32 s53, s2, 6
    s_lshl_b32 s53, s53, 13
    s_lshl_b32 s54, s49, 11
    s_add_u32 s55, s53, s54
    s_add_u32 s69, s55, 65536
    s_lshl_b32 s53, s50, 2
    s_add_u32 s53, s53, s54
    s_add_u32 s70, s53, 90112
    s_lshl_b32 s53, s49, 13
    s_add_u32 s71, s53, 65536
    s_lshl_b32 s53, s2, 1
    s_lshr_b32 s54, s49, 1
    s_add_u32 s53, s53, s54
    s_lshl_b32 s54, s53, 1
    v_mov_b32 v249, s54
    s_lshl_b32 s53, s53, 12
    v_add_u32 v248, s53, v129
    v_mov_b32 v201, 0xffff
    v_lshrrev_b32 v199, 1, v128
    v_and_b32 v196, 1, v128
    v_xor_b32 v197, 1, v196
    v_lshlrev_b32 v198, 4, v197
    v_cmp_eq_u32 vcc, 3, v199
    v_lshlrev_b32 v198, v198, v201
    v_mul_u32_u24 v196, 1280, v196
    v_cndmask_b32 v244, 0, v198, vcc
    v_cmp_eq_u32 vcc, 2, v199
    v_lshrrev_b32 v197, 4, v128
    v_and_b32 v197, 2, v197
    v_cndmask_b32 v245, 0, v198, vcc
    v_cmp_eq_u32 vcc, 1, v199
    v_and_or_b32 v197, v199, 1, v197
    v_mul_u32_u24 v197, 24576, v197
    v_cndmask_b32 v246, 0, v198, vcc
    v_cmp_eq_u32 vcc, 0, v199
    v_bfe_u32 v200, v128, 2, 3
    v_lshl_add_u32 v196, v200, 4, v196
    v_cndmask_b32 v247, 0, v198, vcc
    s_lshl_b32 s53, s49, 8
    s_add_u32 s53, s53, 82432
    v_add3_u32 v250, v196, v197, s53
gw_13:
    ds_read_b32 v141, v129 offset:24
    s_sub_i32 s52, s52, 1
    s_waitcnt lgkmcnt(0)
    v_readfirstlane_b32 s53, v141
    s_cmp_lt_u32 s53, 8
    s_cselect_b32 s53, s52, 0
    s_cmp_gt_i32 s53, 0
    s_cbranch_scc1 gw_13
    ds_read_b128 v[64:67], v130 offset:11776
    ds_read_b128 v[68:71], v130 offset:11840
    ds_read_b128 v[72:75], v130 offset:11904
    ds_read_b128 v[76:79], v130 offset:11968
    ds_read_b128 v[80:83], v130 offset:12032
    ds_read_b128 v[84:87], v130 offset:12096
    ds_read_b128 v[88:91], v130 offset:12160
    ds_read_b128 v[92:95], v130 offset:12224
    ds_read_b128 v[96:99], v130 offset:12288
    ds_read_b128 v[100:103], v130 offset:12352
    ds_read_b128 v[104:107], v130 offset:12416
    ds_read_b128 v[108:111], v130 offset:12480
    s_waitcnt lgkmcnt(8)
    ds_read_b128 v[112:115], v130 offset:12544
    ds_read_b128 v[116:119], v130 offset:12608
    ds_read_b128 v[120:123], v130 offset:12672
    ds_read_b128 v[124:127], v130 offset:12736
    s_waitcnt vmcnt(0)
    s_mov_b64 exec, 2
    ds_add_u32 v129, v128 offset:0
    s_mov_b64 exec, -1
gw_14:
    ds_read_b32 v141, v129 offset:16
    s_sub_i32 s52, s52, 1
    s_waitcnt lgkmcnt(0)
    v_readfirstlane_b32 s53, v141
    s_cmp_lt_u32 s53, 4
    s_cselect_b32 s53, s52, 0
    s_cmp_gt_i32 s53, 0
    s_cbranch_scc1 gw_14
    ds_read_b64_tr_b16 v[0:1], v152 offset:0
    ds_read_b64_tr_b16 v[2:3], v152 offset:512
    ds_read_b64_tr_b16 v[4:5], v152 offset:4096
    ds_read_b64_tr_b16 v[6:7], v152 offset:4608
    ds_read_b64_tr_b16 v[8:9], v152 offset:8192
    ds_read_b64_tr_b16 v[10:11], v152 offset:8704
    ds_read_b64_tr_b16 v[12:13], v152 offset:12288
    ds_read_b64_tr_b16 v[14:15], v152 offset:12800
    ds_read_b64_tr_b16 v[16:17], v152 offset:24576
    ds_read_b64_tr_b16 v[18:19], v152 offset:25088
    ds_read_b64_tr_b16 v[20:21], v152 offset:28672
    ds_read_b64_tr_b16 v[22:23], v152 offset:29184
    ds_read_b64_tr_b16 v[24:25], v152 offset:32768
    ds_read_b64_tr_b16 v[26:27], v152 offset:33280
    s_waitcnt lgkmcnt(12)
    v_mfma_f32_16x16x32_bf16 v[236:239], v[0:3], v[64:67], 0
    ds_read_b64_tr_b16 v[28:29], v152 offset:36864
    ds_read_b64_tr_b16 v[30:31], v152 offset:37376
    s_waitcnt lgkmcnt(12)
    v_mfma_f32_16x16x32_bf16 v[236:239], v[4:7], v[68:71], v[236:239]
    ds_read_b64_tr_b16 v[32:33], v153 offset:0
    ds_read_b64_tr_b16 v[34:35], v153 offset:512
    s_waitcnt lgkmcnt(12)
    v_mfma_f32_16x16x32_bf16 v[236:239], v[8:11], v[72:75], v[236:239]
    ds_read_b64_tr_b16 v[36:37], v153 offset:4096
    ds_read_b64_tr_b16 v[38:39], v153 offset:4608
    s_waitcnt lgkmcnt(12)
    v_mfma_f32_16x16x32_bf16 v[236:239], v[12:15], v[76:79], v[236:239]
    ds_read_b64_tr_b16 v[40:41], v153 offset:8192
    ds_read_b64_tr_b16 v[42:43], v153 offset:8704
    s_waitcnt lgkmcnt(12)
    v_mfma_f32_16x16x32_bf16 v[236:239], v[16:19], v[80:83], v[236:239]
    ds_read_b64_tr_b16 v[44:45], v153 offset:12288
    ds_read_b64_tr_b16 v[46:47], v153 offset:12800
    s_waitcnt lgkmcnt(12)
    v_mfma_f32_16x16x32_bf16 v[236:239], v[20:23], v[84:87], v[236:239]
    ds_read_b64_tr_b16 v[48:49], v153 offset:24576
    ds_read_b64_tr_b16 v[50:51], v153 offset:25088
    s_waitcnt lgkmcnt(12)
    v_mfma_f32_16x16x32_bf16 v[236:239], v[24:27], v[88:91], v[236:239]
    ds_read_b64_tr_b16 v[52:53], v153 offset:28672
    ds_read_b64_tr_b16 v[54:55], v153 offset:29184
    s_waitcnt lgkmcnt(12)
    v_mfma_f32_16x16x32_bf16 v[236:239], v[28:31], v[92:95], v[236:239]
    ds_read_b64_tr_b16 v[56:57], v153 offset:32768
    ds_read_b64_tr_b16 v[58:59], v153 offset:33280
    s_waitcnt lgkmcnt(12)
    v_mfma_f32_16x16x32_bf16 v[236:239], v[32:35], v[96:99], v[236:239]
    ds_read_b64_tr_b16 v[60:61], v153 offset:36864
    ds_read_b64_tr_b16 v[62:63], v153 offset:37376
    s_waitcnt lgkmcnt(12)
    v_mfma_f32_16x16x32_bf16 v[236:239], v[36:39], v[100:103], v[236:239]
    s_waitcnt lgkmcnt(10)
    v_mfma_f32_16x16x32_bf16 v[236:239], v[40:43], v[104:107], v[236:239]
    s_waitcnt lgkmcnt(8)
    v_mfma_f32_16x16x32_bf16 v[236:239], v[44:47], v[108:111], v[236:239]
    s_waitcnt lgkmcnt(6)
    v_mfma_f32_16x16x32_bf16 v[236:239], v[48:51], v[112:115], v[236:239]
    s_waitcnt lgkmcnt(4)
    v_mfma_f32_16x16x32_bf16 v[236:239], v[52:55], v[116:119], v[236:239]
    s_waitcnt lgkmcnt(2)
    v_mfma_f32_16x16x32_bf16 v[236:239], v[56:59], v[120:123], v[236:239]
    s_waitcnt lgkmcnt(0)
    v_mfma_f32_16x16x32_bf16 v[236:239], v[60:63], v[124:127], v[236:239]
    s_nop 0
    s_nop 0
    s_nop 0
    s_nop 0
    s_nop 0
    s_nop 0
    s_nop 0
    s_nop 0
    v_pk_mul_f32 v[236:237], v[236:237], s[72:73] op_sel_hi:[1,0]
    v_pk_mul_f32 v[238:239], v[238:239], s[72:73] op_sel_hi:[1,0]
    v_cvt_pk_bf16_f32 v236, v236, v237
    v_cvt_pk_bf16_f32 v237, v238, v239
    ds_write_b64 v154, v[236:237] offset:3584
    s_mov_b64 exec, 2
    ds_add_u32 v129, v128 offset:0
    s_mov_b64 exec, -1
gw_15:
    ds_read_b32 v141, v129 offset:40
    s_sub_i32 s52, s52, 1
    s_waitcnt lgkmcnt(0)
    v_readfirstlane_b32 s53, v141
    s_cmp_lt_u32 s53, 4
    s_cselect_b32 s53, s52, 0
    s_cmp_gt_i32 s53, 0
    s_cbranch_scc1 gw_15
    ds_read_b128 v[196:199], v130 offset:47104
    ds_read_b128 v[200:203], v130 offset:47168
    ds_read_b128 v[204:207], v130 offset:47232
    ds_read_b128 v[208:211], v130 offset:47296
    ds_read_b128 v[212:215], v130 offset:47360
    ds_read_b128 v[216:219], v130 offset:47424
    ds_read_b128 v[220:223], v130 offset:47488
    ds_read_b128 v[224:227], v130 offset:47552
    s_waitcnt lgkmcnt(7)
    v_mfma_f32_16x16x32_bf16 v[240:243], v[0:3], v[196:199], 0
    ds_read_b128 v[196:199], v130 offset:47616
    s_waitcnt lgkmcnt(7)
    v_mfma_f32_16x16x32_bf16 v[240:243], v[4:7], v[200:203], v[240:243]
    ds_read_b128 v[200:203], v130 offset:47680
    s_waitcnt lgkmcnt(7)
    v_mfma_f32_16x16x32_bf16 v[240:243], v[8:11], v[204:207], v[240:243]
    ds_read_b128 v[204:207], v130 offset:47744
    s_waitcnt lgkmcnt(7)
    v_mfma_f32_16x16x32_bf16 v[240:243], v[12:15], v[208:211], v[240:243]
    ds_read_b128 v[208:211], v130 offset:47808
    s_waitcnt lgkmcnt(7)
    v_mfma_f32_16x16x32_bf16 v[240:243], v[16:19], v[212:215], v[240:243]
    ds_read_b128 v[212:215], v130 offset:47872
    s_waitcnt lgkmcnt(7)
    v_mfma_f32_16x16x32_bf16 v[240:243], v[20:23], v[216:219], v[240:243]
    ds_read_b128 v[216:219], v130 offset:47936
    s_waitcnt lgkmcnt(7)
    v_mfma_f32_16x16x32_bf16 v[240:243], v[24:27], v[220:223], v[240:243]
    ds_read_b128 v[220:223], v130 offset:48000
    s_waitcnt lgkmcnt(7)
    v_mfma_f32_16x16x32_bf16 v[240:243], v[28:31], v[224:227], v[240:243]
    ds_read_b128 v[224:227], v130 offset:48064
    s_waitcnt lgkmcnt(7)
    v_mfma_f32_16x16x32_bf16 v[240:243], v[32:35], v[196:199], v[240:243]
    s_waitcnt lgkmcnt(6)
    v_mfma_f32_16x16x32_bf16 v[240:243], v[36:39], v[200:203], v[240:243]
    s_waitcnt lgkmcnt(5)
    v_mfma_f32_16x16x32_bf16 v[240:243], v[40:43], v[204:207], v[240:243]
    s_waitcnt lgkmcnt(4)
    v_mfma_f32_16x16x32_bf16 v[240:243], v[44:47], v[208:211], v[240:243]
    s_waitcnt lgkmcnt(3)
    v_mfma_f32_16x16x32_bf16 v[240:243], v[48:51], v[212:215], v[240:243]
    s_waitcnt lgkmcnt(2)
    v_mfma_f32_16x16x32_bf16 v[240:243], v[52:55], v[216:219], v[240:243]
    s_waitcnt lgkmcnt(1)
    v_mfma_f32_16x16x32_bf16 v[240:243], v[56:59], v[220:223], v[240:243]
    s_waitcnt lgkmcnt(0)
    v_mfma_f32_16x16x32_bf16 v[240:243], v[60:63], v[224:227], v[240:243]
    s_nop 0
    s_nop 0
    s_nop 0
    s_nop 0
    s_nop 0
    s_nop 0
    s_nop 0
    s_nop 0
    v_pk_mul_f32 v[240:241], v[240:241], s[72:73] op_sel_hi:[1,0]
    v_pk_mul_f32 v[242:243], v[242:243], s[72:73] op_sel_hi:[1,0]
    v_cvt_pk_bf16_f32 v240, v240, v241
    v_cvt_pk_bf16_f32 v241, v242, v243
    ds_write_b64 v131, v[240:241] offset:7680
    s_branch H_MAIN
TCH:
    s_mov_b64 exec, 0
    s_cmp_eq_u32 s49, 0
    s_cbranch_scc0 TCH0
    s_call_b64 s[62:63], PAD1
    s_call_b64 s[62:63], PAD5
    s_call_b64 s[62:63], PAD9
TCH0:
    s_cmp_eq_u32 s49, 1
    s_cbranch_scc0 TCH1
    s_call_b64 s[62:63], PAD2
    s_call_b64 s[62:63], PAD6
    s_call_b64 s[62:63], PAD10
TCH1:
    s_cmp_eq_u32 s49, 2
    s_cbranch_scc0 TCH2
    s_call_b64 s[62:63], PAD3
    s_call_b64 s[62:63], PAD7
    s_call_b64 s[62:63], PAD11
TCH2:
    s_cmp_eq_u32 s49, 3
    s_cbranch_scc0 TCH3
    s_call_b64 s[62:63], PAD4
    s_call_b64 s[62:63], PAD8
TCH3:
    s_mov_b64 exec, -1
    s_branch TCHB
PADRET:
    s_setpc_b64 s[62:63]
.p2align 12
A_MAIN:
    s_waitcnt vmcnt(2)
ck_16:
    v_cmp_ne_u32 vcc, s51, v57
    s_cbranch_vccnz ckrt_18
ckok_17:
    s_xor_b32 s77, s79, 262144
    s_add_u32 s78, s77, 32768
    buffer_load_dwordx4 v[64:67], v56, s[32:35], s77 offen offset:0 sc1
    buffer_load_dwordx4 v[68:71], v53, s[32:35], s78 offen offset:0 sc1
    buffer_load_dwordx4 v[76:79], v56, s[32:35], s77 offen offset:1024 sc1
    buffer_load_dwordx4 v[80:83], v53, s[32:35], s78 offen offset:1024 sc1
    buffer_load_dwordx4 v[88:91], v56, s[32:35], s77 offen offset:2048 sc1
    buffer_load_dwordx4 v[92:95], v53, s[32:35], s78 offen offset:2048 sc1
    buffer_load_dwordx4 v[100:103], v56, s[32:35], s77 offen offset:3072 sc1
    buffer_load_dwordx4 v[104:107], v53, s[32:35], s78 offen offset:3072 sc1
    s_waitcnt lgkmcnt(0)
    v_lshlrev_b32 v0, 16, v160
    v_and_b32 v1, 0xffff0000, v160
    v_lshlrev_b32 v2, 16, v161
    v_and_b32 v3, 0xffff0000, v161
    v_lshlrev_b32 v4, 16, v162
    v_and_b32 v5, 0xffff0000, v162
    v_lshlrev_b32 v6, 16, v163
    v_and_b32 v7, 0xffff0000, v163
    v_lshlrev_b32 v8, 16, v164
    v_and_b32 v9, 0xffff0000, v164
    v_lshlrev_b32 v10, 16, v165
    v_and_b32 v11, 0xffff0000, v165
    v_lshlrev_b32 v12, 16, v166
    v_and_b32 v13, 0xffff0000, v166
    v_lshlrev_b32 v14, 16, v167
    v_and_b32 v15, 0xffff0000, v167
    s_call_b64 s[62:63], LN2
    ds_write_b128 v45, v[28:31] offset:51328
    ds_write_b128 v45, v[32:35] offset:55552
    s_mov_b64 exec, 2
    ds_add_u32 v53, v61 offset:24
    s_mov_b64 exec, -1
    s_mul_i32 s53, s49, 2304
    s_mov_b32 m0, s53
    v_mov_b64 v[32:33], 0
    v_mov_b64 v[34:35], 0
    v_mov_b64 v[36:37], 0
    v_mov_b64 v[38:39], 0
    v_mov_b64 v[40:41], 0
    v_mov_b64 v[42:43], 0
    v_mov_b64 v[44:45], 0
    v_mov_b64 v[46:47], 0
    v_mov_b32 v57, 172032
    s_mov_b64 exec, s[72:73]
    v_mov_b32 v57, v53
    s_mov_b64 exec, -1
    s_mov_b64 s[36:37], s[30:31]
    s_mov_b32 s38, 268435456
    s_mov_b32 s39, 0x20000
    s_waitcnt vmcnt(4)
    s_xor_b32 s77, s79, 266240
    s_add_u32 s78, s77, 32768
    buffer_load_dwordx4 v[112:115], v56, s[32:35], s77 offen offset:0 sc1
    buffer_load_dwordx4 v[116:119], v53, s[32:35], s78 offen offset:0 sc1
    buffer_load_dwordx4 v[124:127], v56, s[32:35], s77 offen offset:1024 sc1
    buffer_load_dwordx4 v[128:131], v53, s[32:35], s78 offen offset:1024 sc1
    buffer_load_dwordx4 v[136:139], v56, s[32:35], s77 offen offset:2048 sc1
    buffer_load_dwordx4 v[140:143], v53, s[32:35], s78 offen offset:2048 sc1
    buffer_load_dwordx4 v[148:151], v56, s[32:35], s77 offen offset:3072 sc1
    buffer_load_dwordx4 v[152:155], v53, s[32:35], s78 offen offset:3072 sc1
    s_waitcnt vmcnt(8)
ck_19:
    v_max_u32 v55, v64, v68
    v_max3_u32 v55, v55, v70, v76
    v_max3_u32 v55, v55, v80, v82
    v_max3_u32 v55, v55, v88, v92
    v_max3_u32 v55, v55, v94, v100
    v_max3_u32 v55, v55, v104, v106
    v_cmp_eq_u32 vcc, -1, v55
    s_cbranch_vccnz ckrt_21
ckok_20:
    v_permlane16_swap_b32 v68, v72
    v_permlane16_swap_b32 v69, v73
    v_permlane16_swap_b32 v70, v74
    v_permlane16_swap_b32 v71, v75
    v_permlane16_swap_b32 v80, v84
    v_permlane16_swap_b32 v81, v85
    v_permlane16_swap_b32 v82, v86
    v_permlane16_swap_b32 v83, v87
    v_permlane16_swap_b32 v92, v96
    v_permlane16_swap_b32 v93, v97
    v_permlane16_swap_b32 v94, v98
    v_permlane16_swap_b32 v95, v99
    v_permlane16_swap_b32 v104, v108
    v_permlane16_swap_b32 v105, v109
    v_permlane16_swap_b32 v106, v110
    v_permlane16_swap_b32 v107, v111
    s_add_u32 s54, s67, 65536
    s_mov_b64 exec, 1
    buffer_store_dword v62, off, s[32:35], s54 sc1
    s_mov_b64 exec, -1
    s_xor_b32 s77, s79, 327680
    s_add_u32 s78, s77, 32768
    buffer_load_dwordx4 v[160:163], v56, s[32:35], s77 offen offset:0 sc1
    buffer_load_dwordx4 v[164:167], v53, s[32:35], s78 offen offset:0 sc1
    buffer_load_dwordx4 v[172:175], v56, s[32:35], s77 offen offset:1024 sc1
    buffer_load_dwordx4 v[176:179], v53, s[32:35], s78 offen offset:1024 sc1
    buffer_load_dwordx4 v[184:187], v56, s[32:35], s77 offen offset:2048 sc1
    buffer_load_dwordx4 v[188:191], v53, s[32:35], s78 offen offset:2048 sc1
    buffer_load_dwordx4 v[196:199], v56, s[32:35], s77 offen offset:3072 sc1
    buffer_load_dwordx4 v[200:203], v53, s[32:35], s78 offen offset:3072 sc1
gw_22:
    ds_read_b32 v55, v53 offset:16
    s_sub_i32 s52, s52, 1
    s_waitcnt lgkmcnt(0)
    v_readfirstlane_b32 s53, v55
    s_cmp_lt_u32 s53, EV_Q0
    s_cselect_b32 s53, s52, 0
    s_cmp_gt_i32 s53, 0
    s_cbranch_scc1 gw_22
    ds_read_b128 v[48:51], v53 offset:3584
    s_setprio 1
    s_waitcnt lgkmcnt(0)
    v_mfma_f32_32x32x16_bf16 v[0:15], v[64:67], v[48:51], 0
    s_nop 0
    s_nop 0
    s_nop 0
    s_nop 0
    s_nop 0
    s_nop 0
    s_nop 0
    s_nop 0
    s_nop 0
    s_nop 0
    s_nop 0
    s_nop 0
    v_exp_f32 v0, v0
    v_exp_f32 v1, v1
    v_exp_f32 v2, v2
    v_exp_f32 v3, v3
    v_exp_f32 v4, v4
    v_mfma_f32_32x32x16_bf16 v[16:31], v[76:79], v[48:51], 0
    v_exp_f32 v5, v5
    v_exp_f32 v6, v6
    s_add_u32 s68, s76, 331776
    buffer_load_dwordx4 v[208:211], v56, s[32:35], s68 offen offset:0 sc1
    s_add_u32 s69, s76, 364544
    buffer_load_dwordx4 v[212:215], v53, s[32:35], s69 offen offset:0 sc1
    v_exp_f32 v7, v7
    v_exp_f32 v8, v8
    v_exp_f32 v9, v9
    v_smfmac_f32_32x32x32_bf16 v[32:47], v[68:71], v[0:7], v52
    v_exp_f32 v10, v10
    v_exp_f32 v11, v11
    v_exp_f32 v12, v12
    v_exp_f32 v13, v13
    v_exp_f32 v14, v14
    buffer_load_dwordx4 v[220:223], v56, s[32:35], s68 offen offset:1024 sc1
    buffer_load_dwordx4 v[224:227], v53, s[32:35], s69 offen offset:1024 sc1
    v_exp_f32 v15, v15
    v_exp_f32 v16, v16
    v_exp_f32 v17, v17
    v_smfmac_f32_32x32x32_bf16 v[32:47], v[72:75], v[8:15], v52
    v_exp_f32 v18, v18
    v_exp_f32 v19, v19
    v_exp_f32 v20, v20
    v_mfma_f32_32x32x16_bf16 v[0:15], v[88:91], v[48:51], 0
    v_exp_f32 v21, v21
    v_exp_f32 v22, v22
    buffer_load_dwordx4 v[232:235], v56, s[32:35], s68 offen offset:2048 sc1
    buffer_load_dwordx4 v[236:239], v53, s[32:35], s69 offen offset:2048 sc1
    v_exp_f32 v23, v23
    v_exp_f32 v24, v24
    v_exp_f32 v25, v25
    v_smfmac_f32_32x32x32_bf16 v[32:47], v[80:83], v[16:23], v52
    v_exp_f32 v26, v26
    v_exp_f32 v27, v27
    v_exp_f32 v28, v28
    v_exp_f32 v29, v29
    v_exp_f32 v30, v30
    buffer_load_dwordx4 v[244:247], v56, s[32:35], s68 offen offset:3072 sc1
    buffer_load_dwordx4 v[248:251], v53, s[32:35], s69 offen offset:3072 sc1
    s_mov_b64 exec, 2
    ds_add_u32 v53, v61 offset:32
    s_mov_b64 exec, -1
    v_exp_f32 v31, v31
    v_exp_f32 v0, v0
    v_exp_f32 v1, v1
    v_smfmac_f32_32x32x32_bf16 v[32:47], v[84:87], v[24:31], v52
    v_exp_f32 v2, v2
    v_exp_f32 v3, v3
    v_exp_f32 v4, v4
    v_mfma_f32_32x32x16_bf16 v[16:31], v[100:103], v[48:51], 0
    v_exp_f32 v5, v5
    v_exp_f32 v6, v6
    v_exp_f32 v7, v7
    v_exp_f32 v8, v8
    v_exp_f32 v9, v9
    v_smfmac_f32_32x32x32_bf16 v[32:47], v[92:95], v[0:7], v52
    v_exp_f32 v10, v10
    v_exp_f32 v11, v11
    v_exp_f32 v12, v12
    v_exp_f32 v13, v13
    v_exp_f32 v14, v14
    v_exp_f32 v15, v15
    v_exp_f32 v16, v16
    v_exp_f32 v17, v17
    v_smfmac_f32_32x32x32_bf16 v[32:47], v[96:99], v[8:15], v52
    v_exp_f32 v18, v18
    v_exp_f32 v19, v19
    v_exp_f32 v20, v20
    s_waitcnt vmcnt(17)
ck_23:
    v_max_u32 v55, v112, v116
    v_max3_u32 v55, v55, v118, v124
    v_max3_u32 v55, v55, v128, v130
    v_max3_u32 v55, v55, v136, v140
    v_max3_u32 v55, v55, v142, v148
    v_max3_u32 v55, v55, v152, v154
    v_cmp_eq_u32 vcc, -1, v55
    s_cbranch_vccnz ckrt_25
ckok_24:
    v_permlane16_swap_b32 v116, v120
    v_permlane16_swap_b32 v117, v121
    v_permlane16_swap_b32 v118, v122
    v_permlane16_swap_b32 v119, v123
    v_permlane16_swap_b32 v128, v132
    v_permlane16_swap_b32 v129, v133
    v_permlane16_swap_b32 v130, v134
    v_permlane16_swap_b32 v131, v135
    v_permlane16_swap_b32 v140, v144
    v_permlane16_swap_b32 v141, v145
    v_permlane16_swap_b32 v142, v146
    v_permlane16_swap_b32 v143, v147
    v_permlane16_swap_b32 v152, v156
    v_permlane16_swap_b32 v153, v157
    v_permlane16_swap_b32 v154, v158
    v_permlane16_swap_b32 v155, v159
    v_mfma_f32_32x32x16_bf16 v[0:15], v[112:115], v[48:51], 0
    v_exp_f32 v21, v21
    v_exp_f32 v22, v22
    v_exp_f32 v23, v23
    v_exp_f32 v24, v24
    v_exp_f32 v25, v25
    v_smfmac_f32_32x32x32_bf16 v[32:47], v[104:107], v[16:23], v52
    v_exp_f32 v26, v26
    v_exp_f32 v27, v27
    v_exp_f32 v28, v28
    v_exp_f32 v29, v29
    v_exp_f32 v30, v30
    v_exp_f32 v31, v31
    v_exp_f32 v0, v0
    v_exp_f32 v1, v1
    v_smfmac_f32_32x32x32_bf16 v[32:47], v[108:111], v[24:31], v52
    v_exp_f32 v2, v2
    v_exp_f32 v3, v3
    v_exp_f32 v4, v4
    v_mfma_f32_32x32x16_bf16 v[16:31], v[124:127], v[48:51], 0
    v_exp_f32 v5, v5
    v_exp_f32 v6, v6
    v_exp_f32 v7, v7
    v_exp_f32 v8, v8
    v_exp_f32 v9, v9
    v_smfmac_f32_32x32x32_bf16 v[32:47], v[116:119], v[0:7], v52
    v_exp_f32 v10, v10
    v_exp_f32 v11, v11
    v_exp_f32 v12, v12
    v_exp_f32 v13, v13
    v_exp_f32 v14, v14
    v_exp_f32 v15, v15
    v_exp_f32 v16, v16
    v_exp_f32 v17, v17
    v_smfmac_f32_32x32x32_bf16 v[32:47], v[120:123], v[8:15], v52
    v_exp_f32 v18, v18
    v_exp_f32 v19, v19
    v_exp_f32 v20, v20
    v_mfma_f32_32x32x16_bf16 v[0:15], v[136:139], v[48:51], 0
    v_exp_f32 v21, v21
    v_exp_f32 v22, v22
    v_exp_f32 v23, v23
    v_exp_f32 v24, v24
    v_exp_f32 v25, v25
    v_smfmac_f32_32x32x32_bf16 v[32:47], v[128:131], v[16:23], v52
    v_exp_f32 v26, v26
    v_exp_f32 v27, v27
    v_exp_f32 v28, v28
    v_exp_f32 v29, v29
    v_exp_f32 v30, v30
    v_exp_f32 v31, v31
    v_exp_f32 v0, v0
    v_exp_f32 v1, v1
    v_smfmac_f32_32x32x32_bf16 v[32:47], v[132:135], v[24:31], v52
    v_exp_f32 v2, v2
    v_exp_f32 v3, v3
    v_exp_f32 v4, v4
    v_mfma_f32_32x32x16_bf16 v[16:31], v[148:151], v[48:51], 0
    v_exp_f32 v5, v5
    v_exp_f32 v6, v6
    v_exp_f32 v7, v7
    v_exp_f32 v8, v8
    v_exp_f32 v9, v9
    v_smfmac_f32_32x32x32_bf16 v[32:47], v[140:143], v[0:7], v52
    v_exp_f32 v10, v10
    v_exp_f32 v11, v11
    v_exp_f32 v12, v12
    v_exp_f32 v13, v13
    v_exp_f32 v14, v14
    v_exp_f32 v15, v15
    v_exp_f32 v16, v16
    v_exp_f32 v17, v17
    v_smfmac_f32_32x32x32_bf16 v[32:47], v[144:147], v[8:15], v52
    v_exp_f32 v18, v18
    v_exp_f32 v19, v19
    v_exp_f32 v20, v20
    s_waitcnt vmcnt(8)
ck_26:
    v_max_u32 v55, v160, v164
    v_max3_u32 v55, v55, v166, v172
    v_max3_u32 v55, v55, v176, v178
    v_max3_u32 v55, v55, v184, v188
    v_max3_u32 v55, v55, v190, v196
    v_max3_u32 v55, v55, v200, v202
    v_cmp_eq_u32 vcc, -1, v55
    s_cbranch_vccnz ckrt_28
ckok_27:
    v_permlane16_swap_b32 v164, v168
    v_permlane16_swap_b32 v165, v169
    v_permlane16_swap_b32 v166, v170
    v_permlane16_swap_b32 v167, v171
    v_permlane16_swap_b32 v176, v180
    v_permlane16_swap_b32 v177, v181
    v_permlane16_swap_b32 v178, v182
    v_permlane16_swap_b32 v179, v183
    v_permlane16_swap_b32 v188, v192
    v_permlane16_swap_b32 v189, v193
    v_permlane16_swap_b32 v190, v194
    v_permlane16_swap_b32 v191, v195
    v_permlane16_swap_b32 v200, v204
    v_permlane16_swap_b32 v201, v205
    v_permlane16_swap_b32 v202, v206
    v_permlane16_swap_b32 v203, v207
    v_mfma_f32_32x32x16_bf16 v[0:15], v[160:163], v[48:51], 0
    v_exp_f32 v21, v21
    v_exp_f32 v22, v22
    v_exp_f32 v23, v23
    v_exp_f32 v24, v24
    v_exp_f32 v25, v25
    v_smfmac_f32_32x32x32_bf16 v[32:47], v[152:155], v[16:23], v52
    v_exp_f32 v26, v26
    v_exp_f32 v27, v27
    v_exp_f32 v28, v28
    v_exp_f32 v29, v29
    v_exp_f32 v30, v30
    v_exp_f32 v31, v31
    v_exp_f32 v0, v0
    v_exp_f32 v1, v1
    v_smfmac_f32_32x32x32_bf16 v[32:47], v[156:159], v[24:31], v52
    v_exp_f32 v2, v2
    v_exp_f32 v3, v3
    v_exp_f32 v4, v4
    v_mfma_f32_32x32x16_bf16 v[16:31], v[172:175], v[48:51], 0
    v_exp_f32 v5, v5
    v_exp_f32 v6, v6
    v_exp_f32 v7, v7
    v_exp_f32 v8, v8
    v_exp_f32 v9, v9
    v_smfmac_f32_32x32x32_bf16 v[32:47], v[164:167], v[0:7], v52
    v_exp_f32 v10, v10
    v_exp_f32 v11, v11
    v_exp_f32 v12, v12
    v_exp_f32 v13, v13
    v_exp_f32 v14, v14
    v_exp_f32 v15, v15
    v_exp_f32 v16, v16
    v_exp_f32 v17, v17
    v_smfmac_f32_32x32x32_bf16 v[32:47], v[168:171], v[8:15], v52
    v_exp_f32 v18, v18
    v_exp_f32 v19, v19
    v_exp_f32 v20, v20
    v_mfma_f32_32x32x16_bf16 v[0:15], v[184:187], v[48:51], 0
    v_exp_f32 v21, v21
    v_exp_f32 v22, v22
    v_exp_f32 v23, v23
    v_exp_f32 v24, v24
    v_exp_f32 v25, v25
    v_smfmac_f32_32x32x32_bf16 v[32:47], v[176:179], v[16:23], v52
    v_exp_f32 v26, v26
    v_exp_f32 v27, v27
    v_exp_f32 v28, v28
    v_exp_f32 v29, v29
    v_exp_f32 v30, v30
    v_exp_f32 v31, v31
    v_exp_f32 v0, v0
    v_exp_f32 v1, v1
    v_smfmac_f32_32x32x32_bf16 v[32:47], v[180:183], v[24:31], v52
    v_exp_f32 v2, v2
    v_exp_f32 v3, v3
    v_exp_f32 v4, v4
    v_mfma_f32_32x32x16_bf16 v[16:31], v[196:199], v[48:51], 0
    v_exp_f32 v5, v5
    v_exp_f32 v6, v6
    v_exp_f32 v7, v7
    v_exp_f32 v8, v8
    v_exp_f32 v9, v9
    v_smfmac_f32_32x32x32_bf16 v[32:47], v[188:191], v[0:7], v52
    v_exp_f32 v10, v10
    v_exp_f32 v11, v11
    v_exp_f32 v12, v12
    v_exp_f32 v13, v13
    v_exp_f32 v14, v14
    v_exp_f32 v15, v15
    v_exp_f32 v16, v16
    v_exp_f32 v17, v17
    v_smfmac_f32_32x32x32_bf16 v[32:47], v[192:195], v[8:15], v52
    v_exp_f32 v18, v18
    v_exp_f32 v19, v19
    v_exp_f32 v20, v20
    s_waitcnt vmcnt(0)
ck_29:
    v_max_u32 v55, v208, v212
    v_max3_u32 v55, v55, v214, v220
    v_max3_u32 v55, v55, v224, v226
    v_max3_u32 v55, v55, v232, v236
    v_max3_u32 v55, v55, v238, v244
    v_max3_u32 v55, v55, v248, v250
    v_cmp_eq_u32 vcc, -1, v55
    s_cbranch_vccnz ckrt_31
ckok_30:
    v_permlane16_swap_b32 v212, v216
    v_permlane16_swap_b32 v213, v217
    v_permlane16_swap_b32 v214, v218
    v_permlane16_swap_b32 v215, v219
    v_permlane16_swap_b32 v224, v228
    v_permlane16_swap_b32 v225, v229
    v_permlane16_swap_b32 v226, v230
    v_permlane16_swap_b32 v227, v231
    v_permlane16_swap_b32 v236, v240
    v_permlane16_swap_b32 v237, v241
    v_permlane16_swap_b32 v238, v242
    v_permlane16_swap_b32 v239, v243
    v_permlane16_swap_b32 v248, v252
    v_permlane16_swap_b32 v249, v253
    v_permlane16_swap_b32 v250, v254
    v_permlane16_swap_b32 v251, v255
    v_mfma_f32_32x32x16_bf16 v[0:15], v[208:211], v[48:51], 0
    v_exp_f32 v21, v21
    v_exp_f32 v22, v22
    v_exp_f32 v23, v23
    v_exp_f32 v24, v24
    v_exp_f32 v25, v25
    v_smfmac_f32_32x32x32_bf16 v[32:47], v[200:203], v[16:23], v52
    v_exp_f32 v26, v26
    v_exp_f32 v27, v27
    v_exp_f32 v28, v28
    v_exp_f32 v29, v29
    v_exp_f32 v30, v30
    v_exp_f32 v31, v31
    v_exp_f32 v0, v0
    v_exp_f32 v1, v1
    v_smfmac_f32_32x32x32_bf16 v[32:47], v[204:207], v[24:31], v52
    v_exp_f32 v2, v2
    v_exp_f32 v3, v3
    v_exp_f32 v4, v4
    v_mfma_f32_32x32x16_bf16 v[16:31], v[220:223], v[48:51], 0
    v_exp_f32 v5, v5
    v_exp_f32 v6, v6
    v_exp_f32 v7, v7
    v_exp_f32 v8, v8
    v_exp_f32 v9, v9
    v_smfmac_f32_32x32x32_bf16 v[32:47], v[212:215], v[0:7], v52
    v_exp_f32 v10, v10
    v_exp_f32 v11, v11
    v_exp_f32 v12, v12
    v_exp_f32 v13, v13
    v_exp_f32 v14, v14
    v_exp_f32 v15, v15
    v_exp_f32 v16, v16
    v_exp_f32 v17, v17
    v_smfmac_f32_32x32x32_bf16 v[32:47], v[216:219], v[8:15], v52
    v_exp_f32 v18, v18
    v_exp_f32 v19, v19
    v_exp_f32 v20, v20
    v_mfma_f32_32x32x16_bf16 v[0:15], v[232:235], v[48:51], 0
    v_exp_f32 v21, v21
    v_exp_f32 v22, v22
    v_exp_f32 v23, v23
    v_exp_f32 v24, v24
    v_exp_f32 v25, v25
    v_smfmac_f32_32x32x32_bf16 v[32:47], v[224:227], v[16:23], v52
    v_exp_f32 v26, v26
    v_exp_f32 v27, v27
    v_exp_f32 v28, v28
    v_exp_f32 v29, v29
    v_exp_f32 v30, v30
    v_exp_f32 v31, v31
    v_exp_f32 v0, v0
    v_exp_f32 v1, v1
    v_smfmac_f32_32x32x32_bf16 v[32:47], v[228:231], v[24:31], v52
    v_exp_f32 v2, v2
    v_exp_f32 v3, v3
    v_exp_f32 v4, v4
    v_mfma_f32_32x32x16_bf16 v[16:31], v[244:247], v[48:51], 0
    ds_read_b128 v[48:51], v53 offset:4608
    v_exp_f32 v5, v5
    v_exp_f32 v6, v6
    v_exp_f32 v7, v7
    v_exp_f32 v8, v8
    v_exp_f32 v9, v9
    v_smfmac_f32_32x32x32_bf16 v[32:47], v[236:239], v[0:7], v52
    v_exp_f32 v10, v10
    v_exp_f32 v11, v11
    v_exp_f32 v12, v12
    v_exp_f32 v13, v13
    v_exp_f32 v14, v14
    v_exp_f32 v15, v15
    v_exp_f32 v16, v16
    v_exp_f32 v17, v17
    v_smfmac_f32_32x32x32_bf16 v[32:47], v[240:243], v[8:15], v52
    v_exp_f32 v18, v18
    v_exp_f32 v19, v19
    v_exp_f32 v20, v20
    s_waitcnt lgkmcnt(0)
    v_mfma_f32_32x32x16_bf16 v[0:15], v[64:67], v[48:51], 0
    v_exp_f32 v21, v21
    v_exp_f32 v22, v22
    v_exp_f32 v23, v23
    v_exp_f32 v24, v24
    v_exp_f32 v25, v25
    v_smfmac_f32_32x32x32_bf16 v[32:47], v[248:251], v[16:23], v52
    v_exp_f32 v26, v26
    v_exp_f32 v27, v27
    v_exp_f32 v28, v28
    v_exp_f32 v29, v29
    v_exp_f32 v30, v30
    v_exp_f32 v31, v31
    v_exp_f32 v0, v0
    v_exp_f32 v1, v1
    v_smfmac_f32_32x32x32_bf16 v[32:47], v[252:255], v[24:31], v52
    v_exp_f32 v2, v2
    v_exp_f32 v3, v3
    v_exp_f32 v4, v4
    v_mfma_f32_32x32x16_bf16 v[16:31], v[76:79], v[48:51], 0
    v_exp_f32 v5, v5
    v_exp_f32 v6, v6
    v_exp_f32 v7, v7
    v_exp_f32 v8, v8
    v_exp_f32 v9, v9
    v_exp_f32 v10, v10
    v_exp_f32 v11, v11
    v_exp_f32 v12, v12
    ds_write_b128 v54, v[32:35] offset:28672
    ds_write_b128 v54, v[36:39] offset:29696
    ds_write_addtid_b32 v40 offset:30720
    ds_add_u32 v57, v52 offset:64
    v_mov_b64 v[32:33], 0
    v_mov_b64 v[34:35], 0
    v_mov_b64 v[36:37], 0
    v_mov_b64 v[38:39], 0
    v_mov_b32 v40, 0
    v_exp_f32 v13, v13
    v_exp_f32 v14, v14
    v_smfmac_f32_32x32x32_bf16 v[32:47], v[68:71], v[0:7], v52
    v_exp_f32 v15, v15
    v_exp_f32 v16, v16
    v_exp_f32 v17, v17
    v_smfmac_f32_32x32x32_bf16 v[32:47], v[72:75], v[8:15], v52
    v_exp_f32 v18, v18
    v_exp_f32 v19, v19
    v_exp_f32 v20, v20
    v_mfma_f32_32x32x16_bf16 v[0:15], v[88:91], v[48:51], 0
    v_exp_f32 v21, v21
    v_exp_f32 v22, v22
    v_exp_f32 v23, v23
    v_exp_f32 v24, v24
    v_exp_f32 v25, v25
    v_smfmac_f32_32x32x32_bf16 v[32:47], v[80:83], v[16:23], v52
    v_exp_f32 v26, v26
    v_exp_f32 v27, v27
    v_exp_f32 v28, v28
    v_exp_f32 v29, v29
    v_exp_f32 v30, v30
    v_exp_f32 v31, v31
    v_exp_f32 v0, v0
    v_exp_f32 v1, v1
    v_smfmac_f32_32x32x32_bf16 v[32:47], v[84:87], v[24:31], v52
    v_exp_f32 v2, v2
    v_exp_f32 v3, v3
    v_exp_f32 v4, v4
    v_mfma_f32_32x32x16_bf16 v[16:31], v[100:103], v[48:51], 0
    v_exp_f32 v5, v5
    v_exp_f32 v6, v6
    v_exp_f32 v7, v7
    v_exp_f32 v8, v8
    v_exp_f32 v9, v9
    v_smfmac_f32_32x32x32_bf16 v[32:47], v[92:95], v[0:7], v52
    v_exp_f32 v10, v10
    v_exp_f32 v11, v11
    v_exp_f32 v12, v12
    v_exp_f32 v13, v13
    v_exp_f32 v14, v14
    v_exp_f32 v15, v15
    v_exp_f32 v16, v16
    v_exp_f32 v17, v17
    v_smfmac_f32_32x32x32_bf16 v[32:47], v[96:99], v[8:15], v52
    v_exp_f32 v18, v18
    v_exp_f32 v19, v19
    v_exp_f32 v20, v20
    v_mfma_f32_32x32x16_bf16 v[0:15], v[112:115], v[48:51], 0
    v_exp_f32 v21, v21
    v_exp_f32 v22, v22
    v_exp_f32 v23, v23
    v_exp_f32 v24, v24
    v_exp_f32 v25, v25
    v_smfmac_f32_32x32x32_bf16 v[32:47], v[104:107], v[16:23], v52
    v_exp_f32 v26, v26
    v_exp_f32 v27, v27
    v_exp_f32 v28, v28
    v_exp_f32 v29, v29
    v_exp_f32 v30, v30
    v_exp_f32 v31, v31
    v_exp_f32 v0, v0
    v_exp_f32 v1, v1
    v_smfmac_f32_32x32x32_bf16 v[32:47], v[108:111], v[24:31], v52
    v_exp_f32 v2, v2
    v_exp_f32 v3, v3
    v_exp_f32 v4, v4
    v_mfma_f32_32x32x16_bf16 v[16:31], v[124:127], v[48:51], 0
    v_exp_f32 v5, v5
    v_exp_f32 v6, v6
    v_exp_f32 v7, v7
    v_exp_f32 v8, v8
    v_exp_f32 v9, v9
    v_smfmac_f32_32x32x32_bf16 v[32:47], v[116:119], v[0:7], v52
    v_exp_f32 v10, v10
    v_exp_f32 v11, v11
    v_exp_f32 v12, v12
    v_exp_f32 v13, v13
    v_exp_f32 v14, v14
    v_exp_f32 v15, v15
    v_exp_f32 v16, v16
    v_exp_f32 v17, v17
    v_smfmac_f32_32x32x32_bf16 v[32:47], v[120:123], v[8:15], v52
    v_exp_f32 v18, v18
    v_exp_f32 v19, v19
    v_exp_f32 v20, v20
    v_mfma_f32_32x32x16_bf16 v[0:15], v[136:139], v[48:51], 0
    v_exp_f32 v21, v21
    v_exp_f32 v22, v22
    v_exp_f32 v23, v23
    v_exp_f32 v24, v24
    v_exp_f32 v25, v25
    v_smfmac_f32_32x32x32_bf16 v[32:47], v[128:131], v[16:23], v52
    v_exp_f32 v26, v26
    v_exp_f32 v27, v27
    v_exp_f32 v28, v28
    v_exp_f32 v29, v29
    v_exp_f32 v30, v30
    v_exp_f32 v31, v31
    v_exp_f32 v0, v0
    v_exp_f32 v1, v1
    v_smfmac_f32_32x32x32_bf16 v[32:47], v[132:135], v[24:31], v52
    v_exp_f32 v2, v2
    v_exp_f32 v3, v3
    v_exp_f32 v4, v4
    v_mfma_f32_32x32x16_bf16 v[16:31], v[148:151], v[48:51], 0
    v_exp_f32 v5, v5
    v_exp_f32 v6, v6
    v_exp_f32 v7, v7
    v_exp_f32 v8, v8
    v_exp_f32 v9, v9
    v_smfmac_f32_32x32x32_bf16 v[32:47], v[140:143], v[0:7], v52
    v_exp_f32 v10, v10
    v_exp_f32 v11, v11
    v_exp_f32 v12, v12
    v_exp_f32 v13, v13
    v_exp_f32 v14, v14
    v_exp_f32 v15, v15
    v_exp_f32 v16, v16
    v_exp_f32 v17, v17
    v_smfmac_f32_32x32x32_bf16 v[32:47], v[144:147], v[8:15], v52
    v_exp_f32 v18, v18
    v_exp_f32 v19, v19
    v_exp_f32 v20, v20
    v_mfma_f32_32x32x16_bf16 v[0:15], v[160:163], v[48:51], 0
    v_exp_f32 v21, v21
    v_exp_f32 v22, v22
    v_exp_f32 v23, v23
    v_exp_f32 v24, v24
    v_exp_f32 v25, v25
    v_smfmac_f32_32x32x32_bf16 v[32:47], v[152:155], v[16:23], v52
    v_exp_f32 v26, v26
    v_exp_f32 v27, v27
    v_exp_f32 v28, v28
    v_exp_f32 v29, v29
    v_exp_f32 v30, v30
    v_exp_f32 v31, v31
    v_exp_f32 v0, v0
    v_exp_f32 v1, v1
    v_smfmac_f32_32x32x32_bf16 v[32:47], v[156:159], v[24:31], v52
    v_exp_f32 v2, v2
    v_exp_f32 v3, v3
    v_exp_f32 v4, v4
    v_mfma_f32_32x32x16_bf16 v[16:31], v[172:175], v[48:51], 0
    v_exp_f32 v5, v5
    v_exp_f32 v6, v6
    v_exp_f32 v7, v7
    v_exp_f32 v8, v8
    v_exp_f32 v9, v9
    v_smfmac_f32_32x32x32_bf16 v[32:47], v[164:167], v[0:7], v52
    v_exp_f32 v10, v10
    v_exp_f32 v11, v11
    v_exp_f32 v12, v12
    v_exp_f32 v13, v13
    v_exp_f32 v14, v14
    v_exp_f32 v15, v15
    v_exp_f32 v16, v16
    v_exp_f32 v17, v17
    v_smfmac_f32_32x32x32_bf16 v[32:47], v[168:171], v[8:15], v52
    v_exp_f32 v18, v18
    v_exp_f32 v19, v19
    v_exp_f32 v20, v20
    v_mfma_f32_32x32x16_bf16 v[0:15], v[184:187], v[48:51], 0
    v_exp_f32 v21, v21
    v_exp_f32 v22, v22
    v_exp_f32 v23, v23
    v_exp_f32 v24, v24
    v_exp_f32 v25, v25
    v_smfmac_f32_32x32x32_bf16 v[32:47], v[176:179], v[16:23], v52
    v_exp_f32 v26, v26
    v_exp_f32 v27, v27
    v_exp_f32 v28, v28
    v_exp_f32 v29, v29
    v_exp_f32 v30, v30
    v_exp_f32 v31, v31
    v_exp_f32 v0, v0
    v_exp_f32 v1, v1
    v_smfmac_f32_32x32x32_bf16 v[32:47], v[180:183], v[24:31], v52
    v_exp_f32 v2, v2
    v_exp_f32 v3, v3
    v_exp_f32 v4, v4
    v_mfma_f32_32x32x16_bf16 v[16:31], v[196:199], v[48:51], 0
    v_exp_f32 v5, v5
    v_exp_f32 v6, v6
    v_exp_f32 v7, v7
    v_exp_f32 v8, v8
    v_exp_f32 v9, v9
    v_smfmac_f32_32x32x32_bf16 v[32:47], v[188:191], v[0:7], v52
    v_exp_f32 v10, v10
    v_exp_f32 v11, v11
    v_exp_f32 v12, v12
    v_exp_f32 v13, v13
    v_exp_f32 v14, v14
    v_exp_f32 v15, v15
    v_exp_f32 v16, v16
    v_exp_f32 v17, v17
    v_smfmac_f32_32x32x32_bf16 v[32:47], v[192:195], v[8:15], v52
    v_exp_f32 v18, v18
    v_exp_f32 v19, v19
    v_exp_f32 v20, v20
    v_mfma_f32_32x32x16_bf16 v[0:15], v[208:211], v[48:51], 0
    v_exp_f32 v21, v21
    v_exp_f32 v22, v22
    v_exp_f32 v23, v23
    v_exp_f32 v24, v24
    v_exp_f32 v25, v25
    v_smfmac_f32_32x32x32_bf16 v[32:47], v[200:203], v[16:23], v52
    v_exp_f32 v26, v26
    v_exp_f32 v27, v27
    v_exp_f32 v28, v28
    v_exp_f32 v29, v29
    v_exp_f32 v30, v30
    v_exp_f32 v31, v31
    v_exp_f32 v0, v0
    v_exp_f32 v1, v1
    v_smfmac_f32_32x32x32_bf16 v[32:47], v[204:207], v[24:31], v52
    v_exp_f32 v2, v2
    v_exp_f32 v3, v3
    v_exp_f32 v4, v4
    v_mfma_f32_32x32x16_bf16 v[16:31], v[220:223], v[48:51], 0
    v_exp_f32 v5, v5
    v_exp_f32 v6, v6
    v_exp_f32 v7, v7
    v_exp_f32 v8, v8
    v_exp_f32 v9, v9
    v_smfmac_f32_32x32x32_bf16 v[32:47], v[212:215], v[0:7], v52
    v_exp_f32 v10, v10
    v_exp_f32 v11, v11
    v_exp_f32 v12, v12
    v_exp_f32 v13, v13
    v_exp_f32 v14, v14
    v_exp_f32 v15, v15
    v_exp_f32 v16, v16
    v_exp_f32 v17, v17
    v_smfmac_f32_32x32x32_bf16 v[32:47], v[216:219], v[8:15], v52
    v_exp_f32 v18, v18
    v_exp_f32 v19, v19
    v_exp_f32 v20, v20
    v_mfma_f32_32x32x16_bf16 v[0:15], v[232:235], v[48:51], 0
    ds_read_b32 v55, v53 offset:16
    v_exp_f32 v21, v21
    v_exp_f32 v22, v22
    v_exp_f32 v23, v23
    v_exp_f32 v24, v24
    v_exp_f32 v25, v25
    v_smfmac_f32_32x32x32_bf16 v[32:47], v[224:227], v[16:23], v52
    v_exp_f32 v26, v26
    v_exp_f32 v27, v27
    v_exp_f32 v28, v28
    v_exp_f32 v29, v29
    v_exp_f32 v30, v30
    v_exp_f32 v31, v31
    v_exp_f32 v0, v0
    v_exp_f32 v1, v1
    v_smfmac_f32_32x32x32_bf16 v[32:47], v[228:231], v[24:31], v52
    v_exp_f32 v2, v2
    v_exp_f32 v3, v3
    v_exp_f32 v4, v4
    v_mfma_f32_32x32x16_bf16 v[16:31], v[244:247], v[48:51], 0
    s_waitcnt lgkmcnt(0)
    v_readfirstlane_b32 s53, v55
    s_cmp_ge_u32 s53, EV_Q2
    s_cbranch_scc0 gst_32
gbk_33:
    ds_read_b128 v[48:51], v53 offset:5632
    v_exp_f32 v5, v5
    v_exp_f32 v6, v6
    v_exp_f32 v7, v7
    v_exp_f32 v8, v8
    v_exp_f32 v9, v9
    v_smfmac_f32_32x32x32_bf16 v[32:47], v[236:239], v[0:7], v52
    v_exp_f32 v10, v10
    v_exp_f32 v11, v11
    v_exp_f32 v12, v12
    v_exp_f32 v13, v13
    v_exp_f32 v14, v14
    v_exp_f32 v15, v15
    v_exp_f32 v16, v16
    v_exp_f32 v17, v17
    v_smfmac_f32_32x32x32_bf16 v[32:47], v[240:243], v[8:15], v52
    v_exp_f32 v18, v18
    v_exp_f32 v19, v19
    v_exp_f32 v20, v20
    s_waitcnt lgkmcnt(0)
    v_mfma_f32_32x32x16_bf16 v[0:15], v[64:67], v[48:51], 0
    v_exp_f32 v21, v21
    v_exp_f32 v22, v22
    v_exp_f32 v23, v23
    v_exp_f32 v24, v24
    v_exp_f32 v25, v25
    v_smfmac_f32_32x32x32_bf16 v[32:47], v[248:251], v[16:23], v52
    v_exp_f32 v26, v26
    v_exp_f32 v27, v27
    v_exp_f32 v28, v28
    v_exp_f32 v29, v29
    v_exp_f32 v30, v30
    v_exp_f32 v31, v31
    v_exp_f32 v0, v0
PAD1:
    s_cbranch_execz PADRET
    v_exp_f32 v1, v1
    v_smfmac_f32_32x32x32_bf16 v[32:47], v[252:255], v[24:31], v52
    v_exp_f32 v2, v2
    v_exp_f32 v3, v3
    v_exp_f32 v4, v4
    v_mfma_f32_32x32x16_bf16 v[16:31], v[76:79], v[48:51], 0
    v_exp_f32 v5, v5
    v_exp_f32 v6, v6
    v_exp_f32 v7, v7
    v_exp_f32 v8, v8
    v_exp_f32 v9, v9
    v_exp_f32 v10, v10
    v_exp_f32 v11, v11
    v_exp_f32 v12, v12
    ds_write_b128 v54, v[32:35] offset:37888
    ds_write_b128 v54, v[36:39] offset:38912
    ds_write_addtid_b32 v40 offset:39936
    ds_add_u32 v57, v52 offset:64
    v_mov_b64 v[32:33], 0
    v_mov_b64 v[34:35], 0
    v_mov_b64 v[36:37], 0
    v_mov_b64 v[38:39], 0
    v_mov_b32 v40, 0
    v_exp_f32 v13, v13
    v_exp_f32 v14, v14
    v_smfmac_f32_32x32x32_bf16 v[32:47], v[68:71], v[0:7], v52
    v_exp_f32 v15, v15
    v_exp_f32 v16, v16
    v_exp_f32 v17, v17
    v_smfmac_f32_32x32x32_bf16 v[32:47], v[72:75], v[8:15], v52
    v_exp_f32 v18, v18
    v_exp_f32 v19, v19
    v_exp_f32 v20, v20
    v_mfma_f32_32x32x16_bf16 v[0:15], v[88:91], v[48:51], 0
    v_exp_f32 v21, v21
    v_exp_f32 v22, v22
    v_exp_f32 v23, v23
    v_exp_f32 v24, v24
    v_exp_f32 v25, v25
    v_smfmac_f32_32x32x32_bf16 v[32:47], v[80:83], v[16:23], v52
    v_exp_f32 v26, v26
    v_exp_f32 v27, v27
    v_exp_f32 v28, v28
    v_exp_f32 v29, v29
    v_exp_f32 v30, v30
    v_exp_f32 v31, v31
    v_exp_f32 v0, v0
    v_exp_f32 v1, v1
    v_smfmac_f32_32x32x32_bf16 v[32:47], v[84:87], v[24:31], v52
    v_exp_f32 v2, v2
    v_exp_f32 v3, v3
    v_exp_f32 v4, v4
    v_mfma_f32_32x32x16_bf16 v[16:31], v[100:103], v[48:51], 0
    v_exp_f32 v5, v5
    v_exp_f32 v6, v6
    v_exp_f32 v7, v7
    v_exp_f32 v8, v8
    v_exp_f32 v9, v9
    v_smfmac_f32_32x32x32_bf16 v[32:47], v[92:95], v[0:7], v52
    v_exp_f32 v10, v10
    v_exp_f32 v11, v11
    v_exp_f32 v12, v12
    v_exp_f32 v13, v13
    v_exp_f32 v14, v14
    v_exp_f32 v15, v15
    v_exp_f32 v16, v16
    v_exp_f32 v17, v17
    v_smfmac_f32_32x32x32_bf16 v[32:47], v[96:99], v[8:15], v52
    v_exp_f32 v18, v18
    v_exp_f32 v19, v19
    v_exp_f32 v20, v20
    v_mfma_f32_32x32x16_bf16 v[0:15], v[112:115], v[48:51], 0
    v_exp_f32 v21, v21
    v_exp_f32 v22, v22
    v_exp_f32 v23, v23
    v_exp_f32 v24, v24
    v_exp_f32 v25, v25
    v_smfmac_f32_32x32x32_bf16 v[32:47], v[104:107], v[16:23], v52
    v_exp_f32 v26, v26
    v_exp_f32 v27, v27
    v_exp_f32 v28, v28
    v_exp_f32 v29, v29
    v_exp_f32 v30, v30
    v_exp_f32 v31, v31
    v_exp_f32 v0, v0
    v_exp_f32 v1, v1
    v_smfmac_f32_32x32x32_bf16 v[32:47], v[108:111], v[24:31], v52
    v_exp_f32 v2, v2
    v_exp_f32 v3, v3
    v_exp_f32 v4, v4
    v_mfma_f32_32x32x16_bf16 v[16:31], v[124:127], v[48:51], 0
    v_exp_f32 v5, v5
    v_exp_f32 v6, v6
    v_exp_f32 v7, v7
    v_exp_f32 v8, v8
    v_exp_f32 v9, v9
    v_smfmac_f32_32x32x32_bf16 v[32:47], v[116:119], v[0:7], v52
    v_exp_f32 v10, v10
    v_exp_f32 v11, v11
    v_exp_f32 v12, v12
    v_exp_f32 v13, v13
    v_exp_f32 v14, v14
    v_exp_f32 v15, v15
    v_exp_f32 v16, v16
    v_exp_f32 v17, v17
    v_smfmac_f32_32x32x32_bf16 v[32:47], v[120:123], v[8:15], v52
    v_exp_f32 v18, v18
    v_exp_f32 v19, v19
    v_exp_f32 v20, v20
    v_mfma_f32_32x32x16_bf16 v[0:15], v[136:139], v[48:51], 0
    v_exp_f32 v21, v21
    v_exp_f32 v22, v22
    v_exp_f32 v23, v23
    v_exp_f32 v24, v24
    v_exp_f32 v25, v25
    v_smfmac_f32_32x32x32_bf16 v[32:47], v[128:131], v[16:23], v52
    v_exp_f32 v26, v26
    v_exp_f32 v27, v27
    v_exp_f32 v28, v28
    v_exp_f32 v29, v29
    v_exp_f32 v30, v30
    v_exp_f32 v31, v31
    v_exp_f32 v0, v0
    v_exp_f32 v1, v1
    v_smfmac_f32_32x32x32_bf16 v[32:47], v[132:135], v[24:31], v52
    v_exp_f32 v2, v2
    v_exp_f32 v3, v3
    v_exp_f32 v4, v4
    v_mfma_f32_32x32x16_bf16 v[16:31], v[148:151], v[48:51], 0
    v_exp_f32 v5, v5
    v_exp_f32 v6, v6
    v_exp_f32 v7, v7
    v_exp_f32 v8, v8
    v_exp_f32 v9, v9
    v_smfmac_f32_32x32x32_bf16 v[32:47], v[140:143], v[0:7], v52
    v_exp_f32 v10, v10
    v_exp_f32 v11, v11
    v_exp_f32 v12, v12
    v_exp_f32 v13, v13
    v_exp_f32 v14, v14
    v_exp_f32 v15, v15
    v_exp_f32 v16, v16
    v_exp_f32 v17, v17
    v_smfmac_f32_32x32x32_bf16 v[32:47], v[144:147], v[8:15], v52
    v_exp_f32 v18, v18
    v_exp_f32 v19, v19
    v_exp_f32 v20, v20
    v_mfma_f32_32x32x16_bf16 v[0:15], v[160:163], v[48:51], 0
    v_exp_f32 v21, v21
    v_exp_f32 v22, v22
    v_exp_f32 v23, v23
    v_exp_f32 v24, v24
    v_exp_f32 v25, v25
    v_smfmac_f32_32x32x32_bf16 v[32:47], v[152:155], v[16:23], v52
    v_exp_f32 v26, v26
    v_exp_f32 v27, v27
    v_exp_f32 v28, v28
    v_exp_f32 v29, v29
    v_exp_f32 v30, v30
    v_exp_f32 v31, v31
    v_exp_f32 v0, v0
    v_exp_f32 v1, v1
    v_smfmac_f32_32x32x32_bf16 v[32:47], v[156:159], v[24:31], v52
    v_exp_f32 v2, v2
    v_exp_f32 v3, v3
    v_exp_f32 v4, v4
    v_mfma_f32_32x32x16_bf16 v[16:31], v[172:175], v[48:51], 0
    v_exp_f32 v5, v5
    v_exp_f32 v6, v6
    v_exp_f32 v7, v7
    v_exp_f32 v8, v8
    v_exp_f32 v9, v9
    v_smfmac_f32_32x32x32_bf16 v[32:47], v[164:167], v[0:7], v52
    v_exp_f32 v10, v10
    v_exp_f32 v11, v11
    v_exp_f32 v12, v12
    v_exp_f32 v13, v13
    v_exp_f32 v14, v14
    v_exp_f32 v15, v15
    v_exp_f32 v16, v16
    v_exp_f32 v17, v17
    v_smfmac_f32_32x32x32_bf16 v[32:47], v[168:171], v[8:15], v52
    v_exp_f32 v18, v18
    v_exp_f32 v19, v19
    v_exp_f32 v20, v20
    v_mfma_f32_32x32x16_bf16 v[0:15], v[184:187], v[48:51], 0
    v_exp_f32 v21, v21
    v_exp_f32 v22, v22
    v_exp_f32 v23, v23
    v_exp_f32 v24, v24
    v_exp_f32 v25, v25
    v_smfmac_f32_32x32x32_bf16 v[32:47], v[176:179], v[16:23], v52
    v_exp_f32 v26, v26
    v_exp_f32 v27, v27
    v_exp_f32 v28, v28
    v_exp_f32 v29, v29
    v_exp_f32 v30, v30
    v_exp_f32 v31, v31
    v_exp_f32 v0, v0
    v_exp_f32 v1, v1
    v_smfmac_f32_32x32x32_bf16 v[32:47], v[180:183], v[24:31], v52
    v_exp_f32 v2, v2
    v_exp_f32 v3, v3
    v_exp_f32 v4, v4
    v_mfma_f32_32x32x16_bf16 v[16:31], v[196:199], v[48:51], 0
    v_exp_f32 v5, v5
    v_exp_f32 v6, v6
    v_exp_f32 v7, v7
    v_exp_f32 v8, v8
    v_exp_f32 v9, v9
    v_smfmac_f32_32x32x32_bf16 v[32:47], v[188:191], v[0:7], v52
    v_exp_f32 v10, v10
    v_exp_f32 v11, v11
    v_exp_f32 v12, v12
    v_exp_f32 v13, v13
    v_exp_f32 v14, v14
    v_exp_f32 v15, v15
    v_exp_f32 v16, v16
    v_exp_f32 v17, v17
    v_smfmac_f32_32x32x32_bf16 v[32:47], v[192:195], v[8:15], v52
    v_exp_f32 v18, v18
    v_exp_f32 v19, v19
    v_exp_f32 v20, v20
    v_mfma_f32_32x32x16_bf16 v[0:15], v[208:211], v[48:51], 0
    v_exp_f32 v21, v21
    v_exp_f32 v22, v22
    v_exp_f32 v23, v23
    v_exp_f32 v24, v24
    v_exp_f32 v25, v25
    v_smfmac_f32_32x32x32_bf16 v[32:47], v[200:203], v[16:23], v52
    v_exp_f32 v26, v26
    v_exp_f32 v27, v27
    v_exp_f32 v28, v28
    v_exp_f32 v29, v29
    v_exp_f32 v30, v30
    v_exp_f32 v31, v31
    v_exp_f32 v0, v0
    v_exp_f32 v1, v1
    v_smfmac_f32_32x32x32_bf16 v[32:47], v[204:207], v[24:31], v52
    v_exp_f32 v2, v2
    v_exp_f32 v3, v3
    v_exp_f32 v4, v4
    v_mfma_f32_32x32x16_bf16 v[16:31], v[220:223], v[48:51], 0
    v_exp_f32 v5, v5
    v_exp_f32 v6, v6
    v_exp_f32 v7, v7
    v_exp_f32 v8, v8
    v_exp_f32 v9, v9
    v_smfmac_f32_32x32x32_bf16 v[32:47], v[212:215], v[0:7], v52
    v_exp_f32 v10, v10
    v_exp_f32 v11, v11
    v_exp_f32 v12, v12
    v_exp_f32 v13, v13
    v_exp_f32 v14, v14
    v_exp_f32 v15, v15
    v_exp_f32 v16, v16
    v_exp_f32 v17, v17
    v_smfmac_f32_32x32x32_bf16 v[32:47], v[216:219], v[8:15], v52
    v_exp_f32 v18, v18
    v_exp_f32 v19, v19
    v_exp_f32 v20, v20
    v_mfma_f32_32x32x16_bf16 v[0:15], v[232:235], v[48:51], 0
    v_exp_f32 v21, v21
    v_exp_f32 v22, v22
    v_exp_f32 v23, v23
    v_exp_f32 v24, v24
    v_exp_f32 v25, v25
    v_smfmac_f32_32x32x32_bf16 v[32:47], v[224:227], v[16:23], v52
    v_exp_f32 v26, v26
    v_exp_f32 v27, v27
    v_exp_f32 v28, v28
    v_exp_f32 v29, v29
    v_exp_f32 v30, v30
    v_exp_f32 v31, v31
    v_exp_f32 v0, v0
    v_exp_f32 v1, v1
    v_smfmac_f32_32x32x32_bf16 v[32:47], v[228:231], v[24:31], v52
    v_exp_f32 v2, v2
    v_exp_f32 v3, v3
    v_exp_f32 v4, v4
    v_mfma_f32_32x32x16_bf16 v[16:31], v[244:247], v[48:51], 0
    ds_read_b128 v[48:51], v53 offset:6656
    v_exp_f32 v5, v5
    v_exp_f32 v6, v6
    v_exp_f32 v7, v7
    v_exp_f32 v8, v8
    v_exp_f32 v9, v9
    v_smfmac_f32_32x32x32_bf16 v[32:47], v[236:239], v[0:7], v52
    v_exp_f32 v10, v10
    v_exp_f32 v11, v11
    v_exp_f32 v12, v12
    v_exp_f32 v13, v13
    v_exp_f32 v14, v14
    v_exp_f32 v15, v15
    v_exp_f32 v16, v16
    v_exp_f32 v17, v17
    v_smfmac_f32_32x32x32_bf16 v[32:47], v[240:243], v[8:15], v52
    v_exp_f32 v18, v18
    v_exp_f32 v19, v19
    v_exp_f32 v20, v20
    s_waitcnt lgkmcnt(0)
    v_mfma_f32_32x32x16_bf16 v[0:15], v[64:67], v[48:51], 0
    v_exp_f32 v21, v21
    v_exp_f32 v22, v22
    v_exp_f32 v23, v23
    v_exp_f32 v24, v24
    v_exp_f32 v25, v25
    v_smfmac_f32_32x32x32_bf16 v[32:47], v[248:251], v[16:23], v52
    v_exp_f32 v26, v26
    v_exp_f32 v27, v27
    v_exp_f32 v28, v28
    v_exp_f32 v29, v29
    v_exp_f32 v30, v30
    v_exp_f32 v31, v31
    v_exp_f32 v0, v0
    v_exp_f32 v1, v1
    v_smfmac_f32_32x32x32_bf16 v[32:47], v[252:255], v[24:31], v52
    v_exp_f32 v2, v2
    v_exp_f32 v3, v3
    v_exp_f32 v4, v4
    v_mfma_f32_32x32x16_bf16 v[16:31], v[76:79], v[48:51], 0
    v_exp_f32 v5, v5
    v_exp_f32 v6, v6
    v_exp_f32 v7, v7
    v_exp_f32 v8, v8
    v_exp_f32 v9, v9
    v_exp_f32 v10, v10
    v_exp_f32 v11, v11
    v_exp_f32 v12, v12
    ds_write_b128 v54, v[32:35] offset:47104
    ds_write_b128 v54, v[36:39] offset:48128
    ds_write_addtid_b32 v40 offset:49152
    ds_add_u32 v57, v52 offset:64
    v_mov_b64 v[32:33], 0
    v_mov_b64 v[34:35], 0
    v_mov_b64 v[36:37], 0
    v_mov_b64 v[38:39], 0
    v_mov_b32 v40, 0
    v_exp_f32 v13, v13
    v_exp_f32 v14, v14
    v_smfmac_f32_32x32x32_bf16 v[32:47], v[68:71], v[0:7], v52
    v_exp_f32 v15, v15
    v_exp_f32 v16, v16
    v_exp_f32 v17, v17
    v_smfmac_f32_32x32x32_bf16 v[32:47], v[72:75], v[8:15], v52
    v_exp_f32 v18, v18
    v_exp_f32 v19, v19
    v_exp_f32 v20, v20
    v_mfma_f32_32x32x16_bf16 v[0:15], v[88:91], v[48:51], 0
    v_exp_f32 v21, v21
    v_exp_f32 v22, v22
    v_exp_f32 v23, v23
    v_exp_f32 v24, v24
    v_exp_f32 v25, v25
    v_smfmac_f32_32x32x32_bf16 v[32:47], v[80:83], v[16:23], v52
    v_exp_f32 v26, v26
    v_exp_f32 v27, v27
    v_exp_f32 v28, v28
    v_exp_f32 v29, v29
    v_exp_f32 v30, v30
    v_exp_f32 v31, v31
    v_exp_f32 v0, v0
    v_exp_f32 v1, v1
    v_smfmac_f32_32x32x32_bf16 v[32:47], v[84:87], v[24:31], v52
    v_exp_f32 v2, v2
    v_exp_f32 v3, v3
    v_exp_f32 v4, v4
    v_mfma_f32_32x32x16_bf16 v[16:31], v[100:103], v[48:51], 0
    v_exp_f32 v5, v5
    v_exp_f32 v6, v6
    v_exp_f32 v7, v7
    v_exp_f32 v8, v8
    v_exp_f32 v9, v9
    v_smfmac_f32_32x32x32_bf16 v[32:47], v[92:95], v[0:7], v52
    v_exp_f32 v10, v10
    v_exp_f32 v11, v11
    v_exp_f32 v12, v12
    v_exp_f32 v13, v13
    v_exp_f32 v14, v14
    v_exp_f32 v15, v15
    v_exp_f32 v16, v16
    v_exp_f32 v17, v17
    v_smfmac_f32_32x32x32_bf16 v[32:47], v[96:99], v[8:15], v52
    v_exp_f32 v18, v18
    v_exp_f32 v19, v19
    v_exp_f32 v20, v20
    v_mfma_f32_32x32x16_bf16 v[0:15], v[112:115], v[48:51], 0
    v_exp_f32 v21, v21
    v_exp_f32 v22, v22
    v_exp_f32 v23, v23
    v_exp_f32 v24, v24
    v_exp_f32 v25, v25
    v_smfmac_f32_32x32x32_bf16 v[32:47], v[104:107], v[16:23], v52
    v_exp_f32 v26, v26
    v_exp_f32 v27, v27
    v_exp_f32 v28, v28
    v_exp_f32 v29, v29
    v_exp_f32 v30, v30
    v_exp_f32 v31, v31
    v_exp_f32 v0, v0
    v_exp_f32 v1, v1
    v_smfmac_f32_32x32x32_bf16 v[32:47], v[108:111], v[24:31], v52
    v_exp_f32 v2, v2
    v_exp_f32 v3, v3
    v_exp_f32 v4, v4
    v_mfma_f32_32x32x16_bf16 v[16:31], v[124:127], v[48:51], 0
    v_exp_f32 v5, v5
    v_exp_f32 v6, v6
    v_exp_f32 v7, v7
    v_exp_f32 v8, v8
    v_exp_f32 v9, v9
    v_smfmac_f32_32x32x32_bf16 v[32:47], v[116:119], v[0:7], v52
    v_exp_f32 v10, v10
    v_exp_f32 v11, v11
    v_exp_f32 v12, v12
    v_exp_f32 v13, v13
    v_exp_f32 v14, v14
    v_exp_f32 v15, v15
    v_exp_f32 v16, v16
    v_exp_f32 v17, v17
    v_smfmac_f32_32x32x32_bf16 v[32:47], v[120:123], v[8:15], v52
    v_exp_f32 v18, v18
    v_exp_f32 v19, v19
    v_exp_f32 v20, v20
    v_mfma_f32_32x32x16_bf16 v[0:15], v[136:139], v[48:51], 0
    v_exp_f32 v21, v21
    v_exp_f32 v22, v22
    v_exp_f32 v23, v23
    v_exp_f32 v24, v24
    v_exp_f32 v25, v25
    v_smfmac_f32_32x32x32_bf16 v[32:47], v[128:131], v[16:23], v52
    v_exp_f32 v26, v26
    v_exp_f32 v27, v27
    v_exp_f32 v28, v28
    v_exp_f32 v29, v29
    v_exp_f32 v30, v30
    v_exp_f32 v31, v31
    v_exp_f32 v0, v0
    v_exp_f32 v1, v1
    v_smfmac_f32_32x32x32_bf16 v[32:47], v[132:135], v[24:31], v52
    v_exp_f32 v2, v2
    v_exp_f32 v3, v3
    v_exp_f32 v4, v4
    v_mfma_f32_32x32x16_bf16 v[16:31], v[148:151], v[48:51], 0
    v_exp_f32 v5, v5
    v_exp_f32 v6, v6
    v_exp_f32 v7, v7
    v_exp_f32 v8, v8
    v_exp_f32 v9, v9
    v_smfmac_f32_32x32x32_bf16 v[32:47], v[140:143], v[0:7], v52
    v_exp_f32 v10, v10
    v_exp_f32 v11, v11
    v_exp_f32 v12, v12
    v_exp_f32 v13, v13
    v_exp_f32 v14, v14
    v_exp_f32 v15, v15
    v_exp_f32 v16, v16
    v_exp_f32 v17, v17
    v_smfmac_f32_32x32x32_bf16 v[32:47], v[144:147], v[8:15], v52
    v_exp_f32 v18, v18
    v_exp_f32 v19, v19
    v_exp_f32 v20, v20
    v_mfma_f32_32x32x16_bf16 v[0:15], v[160:163], v[48:51], 0
    v_exp_f32 v21, v21
    v_exp_f32 v22, v22
    v_exp_f32 v23, v23
    v_exp_f32 v24, v24
    v_exp_f32 v25, v25
    v_smfmac_f32_32x32x32_bf16 v[32:47], v[152:155], v[16:23], v52
    v_exp_f32 v26, v26
    v_exp_f32 v27, v27
    v_exp_f32 v28, v28
    v_exp_f32 v29, v29
    v_exp_f32 v30, v30
    v_exp_f32 v31, v31
    v_exp_f32 v0, v0
    v_exp_f32 v1, v1
    v_smfmac_f32_32x32x32_bf16 v[32:47], v[156:159], v[24:31], v52
    v_exp_f32 v2, v2
    v_exp_f32 v3, v3
    v_exp_f32 v4, v4
    v_mfma_f32_32x32x16_bf16 v[16:31], v[172:175], v[48:51], 0
    v_exp_f32 v5, v5
    v_exp_f32 v6, v6
    v_exp_f32 v7, v7
    v_exp_f32 v8, v8
    v_exp_f32 v9, v9
    v_smfmac_f32_32x32x32_bf16 v[32:47], v[164:167], v[0:7], v52
    v_exp_f32 v10, v10
    v_exp_f32 v11, v11
    v_exp_f32 v12, v12
    v_exp_f32 v13, v13
    v_exp_f32 v14, v14
    v_exp_f32 v15, v15
    v_exp_f32 v16, v16
    v_exp_f32 v17, v17
    v_smfmac_f32_32x32x32_bf16 v[32:47], v[168:171], v[8:15], v52
    v_exp_f32 v18, v18
    v_exp_f32 v19, v19
    v_exp_f32 v20, v20
    v_mfma_f32_32x32x16_bf16 v[0:15], v[184:187], v[48:51], 0
    v_exp_f32 v21, v21
    v_exp_f32 v22, v22
    v_exp_f32 v23, v23
    v_exp_f32 v24, v24
    v_exp_f32 v25, v25
    v_smfmac_f32_32x32x32_bf16 v[32:47], v[176:179], v[16:23], v52
    v_exp_f32 v26, v26
    v_exp_f32 v27, v27
    v_exp_f32 v28, v28
    v_exp_f32 v29, v29
    v_exp_f32 v30, v30
    v_exp_f32 v31, v31
    v_exp_f32 v0, v0
    v_exp_f32 v1, v1
    v_smfmac_f32_32x32x32_bf16 v[32:47], v[180:183], v[24:31], v52
    v_exp_f32 v2, v2
    v_exp_f32 v3, v3
    v_exp_f32 v4, v4
    v_mfma_f32_32x32x16_bf16 v[16:31], v[196:199], v[48:51], 0
    v_exp_f32 v5, v5
    v_exp_f32 v6, v6
    v_exp_f32 v7, v7
    v_exp_f32 v8, v8
    v_exp_f32 v9, v9
    v_smfmac_f32_32x32x32_bf16 v[32:47], v[188:191], v[0:7], v52
    v_exp_f32 v10, v10
    v_exp_f32 v11, v11
    v_exp_f32 v12, v12
    v_exp_f32 v13, v13
    v_exp_f32 v14, v14
    v_exp_f32 v15, v15
    v_exp_f32 v16, v16
    v_exp_f32 v17, v17
    v_smfmac_f32_32x32x32_bf16 v[32:47], v[192:195], v[8:15], v52
    v_exp_f32 v18, v18
    v_exp_f32 v19, v19
    v_exp_f32 v20, v20
    v_mfma_f32_32x32x16_bf16 v[0:15], v[208:211], v[48:51], 0
    v_exp_f32 v21, v21
    v_exp_f32 v22, v22
    v_exp_f32 v23, v23
    v_exp_f32 v24, v24
    v_exp_f32 v25, v25
    v_smfmac_f32_32x32x32_bf16 v[32:47], v[200:203], v[16:23], v52
    v_exp_f32 v26, v26
    v_exp_f32 v27, v27
    v_exp_f32 v28, v28
    v_exp_f32 v29, v29
    v_exp_f32 v30, v30
    v_exp_f32 v31, v31
    v_exp_f32 v0, v0
    v_exp_f32 v1, v1
    v_smfmac_f32_32x32x32_bf16 v[32:47], v[204:207], v[24:31], v52
    v_exp_f32 v2, v2
    v_exp_f32 v3, v3
    v_exp_f32 v4, v4
    v_mfma_f32_32x32x16_bf16 v[16:31], v[220:223], v[48:51], 0
    v_exp_f32 v5, v5
    v_exp_f32 v6, v6
    v_exp_f32 v7, v7
    v_exp_f32 v8, v8
    v_exp_f32 v9, v9
    v_smfmac_f32_32x32x32_bf16 v[32:47], v[212:215], v[0:7], v52
    v_exp_f32 v10, v10
    v_exp_f32 v11, v11
    v_exp_f32 v12, v12
    v_exp_f32 v13, v13
    v_exp_f32 v14, v14
    v_exp_f32 v15, v15
    v_exp_f32 v16, v16
    v_exp_f32 v17, v17
    v_smfmac_f32_32x32x32_bf16 v[32:47], v[216:219], v[8:15], v52
    v_exp_f32 v18, v18
    v_exp_f32 v19, v19
    v_exp_f32 v20, v20
    v_mfma_f32_32x32x16_bf16 v[0:15], v[232:235], v[48:51], 0
    v_exp_f32 v21, v21
    v_exp_f32 v22, v22
    v_exp_f32 v23, v23
    v_exp_f32 v24, v24
    v_exp_f32 v25, v25
    v_smfmac_f32_32x32x32_bf16 v[32:47], v[224:227], v[16:23], v52
    v_exp_f32 v26, v26
    v_exp_f32 v27, v27
    v_exp_f32 v28, v28
    v_exp_f32 v29, v29
    v_exp_f32 v30, v30
    v_exp_f32 v31, v31
    v_exp_f32 v0, v0
    v_exp_f32 v1, v1
    v_smfmac_f32_32x32x32_bf16 v[32:47], v[228:231], v[24:31], v52
    v_exp_f32 v2, v2
    v_exp_f32 v3, v3
    v_exp_f32 v4, v4
    v_mfma_f32_32x32x16_bf16 v[16:31], v[244:247], v[48:51], 0
    ds_read_b128 v[48:51], v53 offset:7680
    v_exp_f32 v5, v5
    v_exp_f32 v6, v6
    v_exp_f32 v7, v7
    v_exp_f32 v8, v8
    v_exp_f32 v9, v9
    v_smfmac_f32_32x32x32_bf16 v[32:47], v[236:239], v[0:7], v52
    v_exp_f32 v10, v10
    v_exp_f32 v11, v11
    v_exp_f32 v12, v12
    v_exp_f32 v13, v13
    v_exp_f32 v14, v14
    v_exp_f32 v15, v15
    v_exp_f32 v16, v16
    v_exp_f32 v17, v17
    v_smfmac_f32_32x32x32_bf16 v[32:47], v[240:243], v[8:15], v52
    v_exp_f32 v18, v18
    v_exp_f32 v19, v19
    v_exp_f32 v20, v20
    s_waitcnt lgkmcnt(0)
    v_mfma_f32_32x32x16_bf16 v[0:15], v[64:67], v[48:51], 0
    v_exp_f32 v21, v21
    v_exp_f32 v22, v22
    v_exp_f32 v23, v23
    v_exp_f32 v24, v24
    v_exp_f32 v25, v25
    v_smfmac_f32_32x32x32_bf16 v[32:47], v[248:251], v[16:23], v52
    v_exp_f32 v26, v26
    v_exp_f32 v27, v27
    v_exp_f32 v28, v28
    v_exp_f32 v29, v29
    v_exp_f32 v30, v30
    v_exp_f32 v31, v31
    v_exp_f32 v0, v0
    v_exp_f32 v1, v1
    v_smfmac_f32_32x32x32_bf16 v[32:47], v[252:255], v[24:31], v52
    v_exp_f32 v2, v2
    v_exp_f32 v3, v3
    v_exp_f32 v4, v4
    v_mfma_f32_32x32x16_bf16 v[16:31], v[76:79], v[48:51], 0
    v_exp_f32 v5, v5
    v_exp_f32 v6, v6
    v_exp_f32 v7, v7
    v_exp_f32 v8, v8
    v_exp_f32 v9, v9
    v_exp_f32 v10, v10
    v_exp_f32 v11, v11
    v_exp_f32 v12, v12
    ds_write_b128 v54, v[32:35] offset:56320
    ds_write_b128 v54, v[36:39] offset:57344
    ds_write_addtid_b32 v40 offset:58368
    ds_add_u32 v57, v52 offset:64
    v_mov_b64 v[32:33], 0
    v_mov_b64 v[34:35], 0
    v_mov_b64 v[36:37], 0
    v_mov_b64 v[38:39], 0
    v_mov_b32 v40, 0
    v_exp_f32 v13, v13
    v_exp_f32 v14, v14
    v_smfmac_f32_32x32x32_bf16 v[32:47], v[68:71], v[0:7], v52
    v_exp_f32 v15, v15
    v_exp_f32 v16, v16
    v_exp_f32 v17, v17
    v_smfmac_f32_32x32x32_bf16 v[32:47], v[72:75], v[8:15], v52
    v_exp_f32 v18, v18
    v_exp_f32 v19, v19
    v_exp_f32 v20, v20
    v_mfma_f32_32x32x16_bf16 v[0:15], v[88:91], v[48:51], 0
    v_exp_f32 v21, v21
    v_exp_f32 v22, v22
    v_exp_f32 v23, v23
    v_exp_f32 v24, v24
    v_exp_f32 v25, v25
    v_smfmac_f32_32x32x32_bf16 v[32:47], v[80:83], v[16:23], v52
    v_exp_f32 v26, v26
    v_exp_f32 v27, v27
    v_exp_f32 v28, v28
    v_exp_f32 v29, v29
    v_exp_f32 v30, v30
    v_exp_f32 v31, v31
    v_exp_f32 v0, v0
    v_exp_f32 v1, v1
    v_smfmac_f32_32x32x32_bf16 v[32:47], v[84:87], v[24:31], v52
    v_exp_f32 v2, v2
    v_exp_f32 v3, v3
    v_exp_f32 v4, v4
    v_mfma_f32_32x32x16_bf16 v[16:31], v[100:103], v[48:51], 0
    v_exp_f32 v5, v5
    v_exp_f32 v6, v6
    v_exp_f32 v7, v7
    v_exp_f32 v8, v8
    v_exp_f32 v9, v9
    v_smfmac_f32_32x32x32_bf16 v[32:47], v[92:95], v[0:7], v52
    v_exp_f32 v10, v10
    v_exp_f32 v11, v11
    v_exp_f32 v12, v12
    v_exp_f32 v13, v13
    v_exp_f32 v14, v14
    v_exp_f32 v15, v15
    v_exp_f32 v16, v16
    v_exp_f32 v17, v17
    v_smfmac_f32_32x32x32_bf16 v[32:47], v[96:99], v[8:15], v52
    v_exp_f32 v18, v18
    v_exp_f32 v19, v19
    v_exp_f32 v20, v20
    v_mfma_f32_32x32x16_bf16 v[0:15], v[112:115], v[48:51], 0
    v_exp_f32 v21, v21
    v_exp_f32 v22, v22
    v_exp_f32 v23, v23
    v_exp_f32 v24, v24
    v_exp_f32 v25, v25
    v_smfmac_f32_32x32x32_bf16 v[32:47], v[104:107], v[16:23], v52
    v_exp_f32 v26, v26
    v_exp_f32 v27, v27
    v_exp_f32 v28, v28
    v_exp_f32 v29, v29
    v_exp_f32 v30, v30
    v_exp_f32 v31, v31
    v_exp_f32 v0, v0
    v_exp_f32 v1, v1
    v_smfmac_f32_32x32x32_bf16 v[32:47], v[108:111], v[24:31], v52
    v_exp_f32 v2, v2
    v_exp_f32 v3, v3
    v_exp_f32 v4, v4
    v_mfma_f32_32x32x16_bf16 v[16:31], v[124:127], v[48:51], 0
    v_exp_f32 v5, v5
    v_exp_f32 v6, v6
    v_exp_f32 v7, v7
    v_exp_f32 v8, v8
    v_exp_f32 v9, v9
    v_smfmac_f32_32x32x32_bf16 v[32:47], v[116:119], v[0:7], v52
    v_exp_f32 v10, v10
    v_exp_f32 v11, v11
    v_exp_f32 v12, v12
    v_exp_f32 v13, v13
    v_exp_f32 v14, v14
    v_exp_f32 v15, v15
    v_exp_f32 v16, v16
    v_exp_f32 v17, v17
    v_smfmac_f32_32x32x32_bf16 v[32:47], v[120:123], v[8:15], v52
    v_exp_f32 v18, v18
    v_exp_f32 v19, v19
    v_exp_f32 v20, v20
    v_mfma_f32_32x32x16_bf16 v[0:15], v[136:139], v[48:51], 0
    v_exp_f32 v21, v21
    v_exp_f32 v22, v22
    v_exp_f32 v23, v23
    v_exp_f32 v24, v24
    v_exp_f32 v25, v25
    v_smfmac_f32_32x32x32_bf16 v[32:47], v[128:131], v[16:23], v52
    v_exp_f32 v26, v26
    v_exp_f32 v27, v27
    v_exp_f32 v28, v28
    v_exp_f32 v29, v29
    v_exp_f32 v30, v30
    v_exp_f32 v31, v31
    v_exp_f32 v0, v0
    v_exp_f32 v1, v1
    v_smfmac_f32_32x32x32_bf16 v[32:47], v[132:135], v[24:31], v52
    v_exp_f32 v2, v2
    v_exp_f32 v3, v3
    v_exp_f32 v4, v4
    v_mfma_f32_32x32x16_bf16 v[16:31], v[148:151], v[48:51], 0
    v_exp_f32 v5, v5
    v_exp_f32 v6, v6
    v_exp_f32 v7, v7
    v_exp_f32 v8, v8
    v_exp_f32 v9, v9
    v_smfmac_f32_32x32x32_bf16 v[32:47], v[140:143], v[0:7], v52
    v_exp_f32 v10, v10
    v_exp_f32 v11, v11
    v_exp_f32 v12, v12
    v_exp_f32 v13, v13
    v_exp_f32 v14, v14
    v_exp_f32 v15, v15
    v_exp_f32 v16, v16
    v_exp_f32 v17, v17
    v_smfmac_f32_32x32x32_bf16 v[32:47], v[144:147], v[8:15], v52
    v_exp_f32 v18, v18
    v_exp_f32 v19, v19
    v_exp_f32 v20, v20
    v_mfma_f32_32x32x16_bf16 v[0:15], v[160:163], v[48:51], 0
    v_exp_f32 v21, v21
    v_exp_f32 v22, v22
    v_exp_f32 v23, v23
    v_exp_f32 v24, v24
    v_exp_f32 v25, v25
    v_smfmac_f32_32x32x32_bf16 v[32:47], v[152:155], v[16:23], v52
    v_exp_f32 v26, v26
    v_exp_f32 v27, v27
    v_exp_f32 v28, v28
    v_exp_f32 v29, v29
    v_exp_f32 v30, v30
    v_exp_f32 v31, v31
    v_exp_f32 v0, v0
    v_exp_f32 v1, v1
    v_smfmac_f32_32x32x32_bf16 v[32:47], v[156:159], v[24:31], v52
    v_exp_f32 v2, v2
    v_exp_f32 v3, v3
    v_exp_f32 v4, v4
    v_mfma_f32_32x32x16_bf16 v[16:31], v[172:175], v[48:51], 0
    v_exp_f32 v5, v5
    v_exp_f32 v6, v6
    v_exp_f32 v7, v7
    v_exp_f32 v8, v8
    v_exp_f32 v9, v9
    v_smfmac_f32_32x32x32_bf16 v[32:47], v[164:167], v[0:7], v52
    v_exp_f32 v10, v10
    v_exp_f32 v11, v11
    v_exp_f32 v12, v12
    v_exp_f32 v13, v13
    v_exp_f32 v14, v14
    v_exp_f32 v15, v15
    v_exp_f32 v16, v16
    v_exp_f32 v17, v17
    v_smfmac_f32_32x32x32_bf16 v[32:47], v[168:171], v[8:15], v52
    v_exp_f32 v18, v18
    v_exp_f32 v19, v19
    v_exp_f32 v20, v20
    v_mfma_f32_32x32x16_bf16 v[0:15], v[184:187], v[48:51], 0
    v_exp_f32 v21, v21
    v_exp_f32 v22, v22
    v_exp_f32 v23, v23
    v_exp_f32 v24, v24
    v_exp_f32 v25, v25
    v_smfmac_f32_32x32x32_bf16 v[32:47], v[176:179], v[16:23], v52
    v_exp_f32 v26, v26
    v_exp_f32 v27, v27
    v_exp_f32 v28, v28
    v_exp_f32 v29, v29
    v_exp_f32 v30, v30
    v_exp_f32 v31, v31
    v_exp_f32 v0, v0
    v_exp_f32 v1, v1
    v_smfmac_f32_32x32x32_bf16 v[32:47], v[180:183], v[24:31], v52
    v_exp_f32 v2, v2
    v_exp_f32 v3, v3
    v_exp_f32 v4, v4
    v_mfma_f32_32x32x16_bf16 v[16:31], v[196:199], v[48:51], 0
    v_exp_f32 v5, v5
    v_exp_f32 v6, v6
    v_exp_f32 v7, v7
    v_exp_f32 v8, v8
    v_exp_f32 v9, v9
    v_smfmac_f32_32x32x32_bf16 v[32:47], v[188:191], v[0:7], v52
    v_exp_f32 v10, v10
    v_exp_f32 v11, v11
    v_exp_f32 v12, v12
    v_exp_f32 v13, v13
    v_exp_f32 v14, v14
    v_exp_f32 v15, v15
    v_exp_f32 v16, v16
    v_exp_f32 v17, v17
    v_smfmac_f32_32x32x32_bf16 v[32:47], v[192:195], v[8:15], v52
    v_exp_f32 v18, v18
    v_exp_f32 v19, v19
    v_exp_f32 v20, v20
    v_mfma_f32_32x32x16_bf16 v[0:15], v[208:211], v[48:51], 0
    v_exp_f32 v21, v21
    v_exp_f32 v22, v22
    v_exp_f32 v23, v23
    v_exp_f32 v24, v24
    v_exp_f32 v25, v25
    v_smfmac_f32_32x32x32_bf16 v[32:47], v[200:203], v[16:23], v52
    v_exp_f32 v26, v26
    v_exp_f32 v27, v27
    v_exp_f32 v28, v28
    v_exp_f32 v29, v29
    v_exp_f32 v30, v30
    v_exp_f32 v31, v31
    v_exp_f32 v0, v0
    v_exp_f32 v1, v1
    v_smfmac_f32_32x32x32_bf16 v[32:47], v[204:207], v[24:31], v52
    v_exp_f32 v2, v2
    v_exp_f32 v3, v3
    v_exp_f32 v4, v4
    v_mfma_f32_32x32x16_bf16 v[16:31], v[220:223], v[48:51], 0
    v_exp_f32 v5, v5
    v_exp_f32 v6, v6
PAD2:
    s_cbranch_execz PADRET
    v_exp_f32 v7, v7
    v_exp_f32 v8, v8
    v_exp_f32 v9, v9
    v_smfmac_f32_32x32x32_bf16 v[32:47], v[212:215], v[0:7], v52
    v_exp_f32 v10, v10
    v_exp_f32 v11, v11
    v_exp_f32 v12, v12
    v_exp_f32 v13, v13
    v_exp_f32 v14, v14
    v_exp_f32 v15, v15
    v_exp_f32 v16, v16
    v_exp_f32 v17, v17
    v_smfmac_f32_32x32x32_bf16 v[32:47], v[216:219], v[8:15], v52
    v_exp_f32 v18, v18
    v_exp_f32 v19, v19
    v_exp_f32 v20, v20
    v_mfma_f32_32x32x16_bf16 v[0:15], v[232:235], v[48:51], 0
    ds_read_b32 v55, v53 offset:16
    v_exp_f32 v21, v21
    v_exp_f32 v22, v22
    v_exp_f32 v23, v23
    v_exp_f32 v24, v24
    v_exp_f32 v25, v25
    v_smfmac_f32_32x32x32_bf16 v[32:47], v[224:227], v[16:23], v52
    v_exp_f32 v26, v26
    v_exp_f32 v27, v27
    v_exp_f32 v28, v28
    v_exp_f32 v29, v29
    v_exp_f32 v30, v30
    v_exp_f32 v31, v31
    v_exp_f32 v0, v0
    v_exp_f32 v1, v1
    v_smfmac_f32_32x32x32_bf16 v[32:47], v[228:231], v[24:31], v52
    v_exp_f32 v2, v2
    v_exp_f32 v3, v3
    v_exp_f32 v4, v4
    v_mfma_f32_32x32x16_bf16 v[16:31], v[244:247], v[48:51], 0
    s_waitcnt lgkmcnt(0)
    v_readfirstlane_b32 s53, v55
    s_cmp_ge_u32 s53, EV_R1
    s_cbranch_scc0 gst_34
gbk_35:
    ds_read_b128 v[48:51], v53 offset:8704
    v_exp_f32 v5, v5
    v_exp_f32 v6, v6
    v_exp_f32 v7, v7
    v_exp_f32 v8, v8
    v_exp_f32 v9, v9
    v_smfmac_f32_32x32x32_bf16 v[32:47], v[236:239], v[0:7], v52
    v_exp_f32 v10, v10
    v_exp_f32 v11, v11
    v_exp_f32 v12, v12
    v_exp_f32 v13, v13
    v_exp_f32 v14, v14
    v_exp_f32 v15, v15
    v_exp_f32 v16, v16
    v_exp_f32 v17, v17
    v_smfmac_f32_32x32x32_bf16 v[32:47], v[240:243], v[8:15], v52
    v_exp_f32 v18, v18
    v_exp_f32 v19, v19
    v_exp_f32 v20, v20
    s_waitcnt lgkmcnt(0)
    v_mfma_f32_32x32x16_bf16 v[0:15], v[64:67], v[48:51], 0
    v_exp_f32 v21, v21
    v_exp_f32 v22, v22
    v_exp_f32 v23, v23
    v_exp_f32 v24, v24
    v_exp_f32 v25, v25
    v_smfmac_f32_32x32x32_bf16 v[32:47], v[248:251], v[16:23], v52
    v_exp_f32 v26, v26
    v_exp_f32 v27, v27
    v_exp_f32 v28, v28
    v_exp_f32 v29, v29
    v_exp_f32 v30, v30
    v_exp_f32 v31, v31
    v_exp_f32 v0, v0
    v_exp_f32 v1, v1
    v_smfmac_f32_32x32x32_bf16 v[32:47], v[252:255], v[24:31], v52
    v_exp_f32 v2, v2
    v_exp_f32 v3, v3
    v_exp_f32 v4, v4
    v_mfma_f32_32x32x16_bf16 v[16:31], v[76:79], v[48:51], 0
    v_exp_f32 v5, v5
    v_exp_f32 v6, v6
    v_exp_f32 v7, v7
    v_exp_f32 v8, v8
    v_exp_f32 v9, v9
    v_exp_f32 v10, v10
    v_exp_f32 v11, v11
    v_exp_f32 v12, v12
    ds_write_b128 v54, v[32:35] offset:28672
    ds_write_b128 v54, v[36:39] offset:29696
    ds_write_addtid_b32 v40 offset:30720
    ds_add_u32 v57, v52 offset:64
    v_mov_b64 v[32:33], 0
    v_mov_b64 v[34:35], 0
    v_mov_b64 v[36:37], 0
    v_mov_b64 v[38:39], 0
    v_mov_b32 v40, 0
    v_exp_f32 v13, v13
    v_exp_f32 v14, v14
    v_smfmac_f32_32x32x32_bf16 v[32:47], v[68:71], v[0:7], v52
    v_exp_f32 v15, v15
    v_exp_f32 v16, v16
    v_exp_f32 v17, v17
    v_smfmac_f32_32x32x32_bf16 v[32:47], v[72:75], v[8:15], v52
    v_exp_f32 v18, v18
    v_exp_f32 v19, v19
    v_exp_f32 v20, v20
    v_mfma_f32_32x32x16_bf16 v[0:15], v[88:91], v[48:51], 0
    v_exp_f32 v21, v21
    v_exp_f32 v22, v22
    v_exp_f32 v23, v23
    v_exp_f32 v24, v24
    v_exp_f32 v25, v25
    v_smfmac_f32_32x32x32_bf16 v[32:47], v[80:83], v[16:23], v52
    v_exp_f32 v26, v26
    v_exp_f32 v27, v27
    v_exp_f32 v28, v28
    v_exp_f32 v29, v29
    v_exp_f32 v30, v30
    v_exp_f32 v31, v31
    v_exp_f32 v0, v0
    v_exp_f32 v1, v1
    v_smfmac_f32_32x32x32_bf16 v[32:47], v[84:87], v[24:31], v52
    v_exp_f32 v2, v2
    v_exp_f32 v3, v3
    v_exp_f32 v4, v4
    v_mfma_f32_32x32x16_bf16 v[16:31], v[100:103], v[48:51], 0
    v_exp_f32 v5, v5
    v_exp_f32 v6, v6
    v_exp_f32 v7, v7
    v_exp_f32 v8, v8
    v_exp_f32 v9, v9
    v_smfmac_f32_32x32x32_bf16 v[32:47], v[92:95], v[0:7], v52
    v_exp_f32 v10, v10
    v_exp_f32 v11, v11
    v_exp_f32 v12, v12
    v_exp_f32 v13, v13
    v_exp_f32 v14, v14
    v_exp_f32 v15, v15
    v_exp_f32 v16, v16
    v_exp_f32 v17, v17
    v_smfmac_f32_32x32x32_bf16 v[32:47], v[96:99], v[8:15], v52
    v_exp_f32 v18, v18
    v_exp_f32 v19, v19
    v_exp_f32 v20, v20
    v_mfma_f32_32x32x16_bf16 v[0:15], v[112:115], v[48:51], 0
    v_exp_f32 v21, v21
    v_exp_f32 v22, v22
    v_exp_f32 v23, v23
    v_exp_f32 v24, v24
    v_exp_f32 v25, v25
    v_smfmac_f32_32x32x32_bf16 v[32:47], v[104:107], v[16:23], v52
    v_exp_f32 v26, v26
    v_exp_f32 v27, v27
    v_exp_f32 v28, v28
    v_exp_f32 v29, v29
    v_exp_f32 v30, v30
    v_exp_f32 v31, v31
    v_exp_f32 v0, v0
    v_exp_f32 v1, v1
    v_smfmac_f32_32x32x32_bf16 v[32:47], v[108:111], v[24:31], v52
    v_exp_f32 v2, v2
    v_exp_f32 v3, v3
    v_exp_f32 v4, v4
    v_mfma_f32_32x32x16_bf16 v[16:31], v[124:127], v[48:51], 0
    v_exp_f32 v5, v5
    v_exp_f32 v6, v6
    v_exp_f32 v7, v7
    v_exp_f32 v8, v8
    v_exp_f32 v9, v9
    v_smfmac_f32_32x32x32_bf16 v[32:47], v[116:119], v[0:7], v52
    v_exp_f32 v10, v10
    v_exp_f32 v11, v11
    v_exp_f32 v12, v12
    v_exp_f32 v13, v13
    v_exp_f32 v14, v14
    v_exp_f32 v15, v15
    v_exp_f32 v16, v16
    v_exp_f32 v17, v17
    v_smfmac_f32_32x32x32_bf16 v[32:47], v[120:123], v[8:15], v52
    v_exp_f32 v18, v18
    v_exp_f32 v19, v19
    v_exp_f32 v20, v20
    v_mfma_f32_32x32x16_bf16 v[0:15], v[136:139], v[48:51], 0
    v_exp_f32 v21, v21
    v_exp_f32 v22, v22
    v_exp_f32 v23, v23
    v_exp_f32 v24, v24
    v_exp_f32 v25, v25
    v_smfmac_f32_32x32x32_bf16 v[32:47], v[128:131], v[16:23], v52
    v_exp_f32 v26, v26
    v_exp_f32 v27, v27
    v_exp_f32 v28, v28
    v_exp_f32 v29, v29
    v_exp_f32 v30, v30
    v_exp_f32 v31, v31
    v_exp_f32 v0, v0
    v_exp_f32 v1, v1
    v_smfmac_f32_32x32x32_bf16 v[32:47], v[132:135], v[24:31], v52
    v_exp_f32 v2, v2
    v_exp_f32 v3, v3
    v_exp_f32 v4, v4
    v_mfma_f32_32x32x16_bf16 v[16:31], v[148:151], v[48:51], 0
    v_exp_f32 v5, v5
    v_exp_f32 v6, v6
    v_exp_f32 v7, v7
    v_exp_f32 v8, v8
    v_exp_f32 v9, v9
    v_smfmac_f32_32x32x32_bf16 v[32:47], v[140:143], v[0:7], v52
    v_exp_f32 v10, v10
    v_exp_f32 v11, v11
    v_exp_f32 v12, v12
    v_exp_f32 v13, v13
    v_exp_f32 v14, v14
    v_exp_f32 v15, v15
    v_exp_f32 v16, v16
    v_exp_f32 v17, v17
    v_smfmac_f32_32x32x32_bf16 v[32:47], v[144:147], v[8:15], v52
    v_exp_f32 v18, v18
    v_exp_f32 v19, v19
    v_exp_f32 v20, v20
    v_mfma_f32_32x32x16_bf16 v[0:15], v[160:163], v[48:51], 0
    v_exp_f32 v21, v21
    v_exp_f32 v22, v22
    v_exp_f32 v23, v23
    v_exp_f32 v24, v24
    v_exp_f32 v25, v25
    v_smfmac_f32_32x32x32_bf16 v[32:47], v[152:155], v[16:23], v52
    v_exp_f32 v26, v26
    v_exp_f32 v27, v27
    v_exp_f32 v28, v28
    v_exp_f32 v29, v29
    v_exp_f32 v30, v30
    v_exp_f32 v31, v31
    v_exp_f32 v0, v0
    v_exp_f32 v1, v1
    v_smfmac_f32_32x32x32_bf16 v[32:47], v[156:159], v[24:31], v52
    v_exp_f32 v2, v2
    v_exp_f32 v3, v3
    v_exp_f32 v4, v4
    v_mfma_f32_32x32x16_bf16 v[16:31], v[172:175], v[48:51], 0
    v_exp_f32 v5, v5
    v_exp_f32 v6, v6
    v_exp_f32 v7, v7
    v_exp_f32 v8, v8
    v_exp_f32 v9, v9
    v_smfmac_f32_32x32x32_bf16 v[32:47], v[164:167], v[0:7], v52
    v_exp_f32 v10, v10
    v_exp_f32 v11, v11
    v_exp_f32 v12, v12
    v_exp_f32 v13, v13
    v_exp_f32 v14, v14
    v_exp_f32 v15, v15
    v_exp_f32 v16, v16
    v_exp_f32 v17, v17
    v_smfmac_f32_32x32x32_bf16 v[32:47], v[168:171], v[8:15], v52
    v_exp_f32 v18, v18
    v_exp_f32 v19, v19
    v_exp_f32 v20, v20
    v_mfma_f32_32x32x16_bf16 v[0:15], v[184:187], v[48:51], 0
    v_exp_f32 v21, v21
    v_exp_f32 v22, v22
    v_exp_f32 v23, v23
    v_exp_f32 v24, v24
    v_exp_f32 v25, v25
    v_smfmac_f32_32x32x32_bf16 v[32:47], v[176:179], v[16:23], v52
    v_exp_f32 v26, v26
    v_exp_f32 v27, v27
    v_exp_f32 v28, v28
    v_exp_f32 v29, v29
    v_exp_f32 v30, v30
    v_exp_f32 v31, v31
    v_exp_f32 v0, v0
    v_exp_f32 v1, v1
    v_smfmac_f32_32x32x32_bf16 v[32:47], v[180:183], v[24:31], v52
    v_exp_f32 v2, v2
    v_exp_f32 v3, v3
    v_exp_f32 v4, v4
    v_mfma_f32_32x32x16_bf16 v[16:31], v[196:199], v[48:51], 0
    v_exp_f32 v5, v5
    v_exp_f32 v6, v6
    v_exp_f32 v7, v7
    v_exp_f32 v8, v8
    v_exp_f32 v9, v9
    v_smfmac_f32_32x32x32_bf16 v[32:47], v[188:191], v[0:7], v52
    v_exp_f32 v10, v10
    v_exp_f32 v11, v11
    v_exp_f32 v12, v12
    v_exp_f32 v13, v13
    v_exp_f32 v14, v14
    v_exp_f32 v15, v15
    v_exp_f32 v16, v16
    v_exp_f32 v17, v17
    v_smfmac_f32_32x32x32_bf16 v[32:47], v[192:195], v[8:15], v52
    v_exp_f32 v18, v18
    v_exp_f32 v19, v19
    v_exp_f32 v20, v20
    v_mfma_f32_32x32x16_bf16 v[0:15], v[208:211], v[48:51], 0
    v_exp_f32 v21, v21
    v_exp_f32 v22, v22
    v_exp_f32 v23, v23
    v_exp_f32 v24, v24
    v_exp_f32 v25, v25
    v_smfmac_f32_32x32x32_bf16 v[32:47], v[200:203], v[16:23], v52
    v_exp_f32 v26, v26
    v_exp_f32 v27, v27
    v_exp_f32 v28, v28
    v_exp_f32 v29, v29
    v_exp_f32 v30, v30
    v_exp_f32 v31, v31
    v_exp_f32 v0, v0
    v_exp_f32 v1, v1
    v_smfmac_f32_32x32x32_bf16 v[32:47], v[204:207], v[24:31], v52
    v_exp_f32 v2, v2
    v_exp_f32 v3, v3
    v_exp_f32 v4, v4
    v_mfma_f32_32x32x16_bf16 v[16:31], v[220:223], v[48:51], 0
    v_exp_f32 v5, v5
    v_exp_f32 v6, v6
    v_exp_f32 v7, v7
    v_exp_f32 v8, v8
    v_exp_f32 v9, v9
    v_smfmac_f32_32x32x32_bf16 v[32:47], v[212:215], v[0:7], v52
    v_exp_f32 v10, v10
    v_exp_f32 v11, v11
    v_exp_f32 v12, v12
    v_exp_f32 v13, v13
    v_exp_f32 v14, v14
    v_exp_f32 v15, v15
    v_exp_f32 v16, v16
    v_exp_f32 v17, v17
    v_smfmac_f32_32x32x32_bf16 v[32:47], v[216:219], v[8:15], v52
    v_exp_f32 v18, v18
    v_exp_f32 v19, v19
    v_exp_f32 v20, v20
    v_mfma_f32_32x32x16_bf16 v[0:15], v[232:235], v[48:51], 0
    v_exp_f32 v21, v21
    v_exp_f32 v22, v22
    v_exp_f32 v23, v23
    v_exp_f32 v24, v24
    v_exp_f32 v25, v25
    v_smfmac_f32_32x32x32_bf16 v[32:47], v[224:227], v[16:23], v52
    v_exp_f32 v26, v26
    v_exp_f32 v27, v27
    v_exp_f32 v28, v28
    v_exp_f32 v29, v29
    v_exp_f32 v30, v30
    v_exp_f32 v31, v31
    v_exp_f32 v0, v0
    v_exp_f32 v1, v1
    v_smfmac_f32_32x32x32_bf16 v[32:47], v[228:231], v[24:31], v52
    v_exp_f32 v2, v2
    v_exp_f32 v3, v3
    v_exp_f32 v4, v4
    v_mfma_f32_32x32x16_bf16 v[16:31], v[244:247], v[48:51], 0
    ds_read_b128 v[48:51], v53 offset:9728
    v_exp_f32 v5, v5
    v_exp_f32 v6, v6
    v_exp_f32 v7, v7
    v_exp_f32 v8, v8
    v_exp_f32 v9, v9
    v_smfmac_f32_32x32x32_bf16 v[32:47], v[236:239], v[0:7], v52
    v_exp_f32 v10, v10
    v_exp_f32 v11, v11
    v_exp_f32 v12, v12
    v_exp_f32 v13, v13
    v_exp_f32 v14, v14
    v_exp_f32 v15, v15
    v_exp_f32 v16, v16
    v_exp_f32 v17, v17
    v_smfmac_f32_32x32x32_bf16 v[32:47], v[240:243], v[8:15], v52
    v_exp_f32 v18, v18
    v_exp_f32 v19, v19
    v_exp_f32 v20, v20
    s_waitcnt lgkmcnt(0)
    v_mfma_f32_32x32x16_bf16 v[0:15], v[64:67], v[48:51], 0
    v_exp_f32 v21, v21
    v_exp_f32 v22, v22
    v_exp_f32 v23, v23
    v_exp_f32 v24, v24
    v_exp_f32 v25, v25
    v_smfmac_f32_32x32x32_bf16 v[32:47], v[248:251], v[16:23], v52
    v_exp_f32 v26, v26
    v_exp_f32 v27, v27
    v_exp_f32 v28, v28
    v_exp_f32 v29, v29
    v_exp_f32 v30, v30
    v_exp_f32 v31, v31
    v_exp_f32 v0, v0
    v_exp_f32 v1, v1
    v_smfmac_f32_32x32x32_bf16 v[32:47], v[252:255], v[24:31], v52
    v_exp_f32 v2, v2
    v_exp_f32 v3, v3
    v_exp_f32 v4, v4
    v_mfma_f32_32x32x16_bf16 v[16:31], v[76:79], v[48:51], 0
    v_exp_f32 v5, v5
    v_exp_f32 v6, v6
    v_exp_f32 v7, v7
    v_exp_f32 v8, v8
    v_exp_f32 v9, v9
    v_exp_f32 v10, v10
    v_exp_f32 v11, v11
    v_exp_f32 v12, v12
    ds_write_b128 v54, v[32:35] offset:37888
    ds_write_b128 v54, v[36:39] offset:38912
    ds_write_addtid_b32 v40 offset:39936
    ds_add_u32 v57, v52 offset:64
    v_mov_b64 v[32:33], 0
    v_mov_b64 v[34:35], 0
    v_mov_b64 v[36:37], 0
    v_mov_b64 v[38:39], 0
    v_mov_b32 v40, 0
    v_exp_f32 v13, v13
    v_exp_f32 v14, v14
    v_smfmac_f32_32x32x32_bf16 v[32:47], v[68:71], v[0:7], v52
    v_exp_f32 v15, v15
    v_exp_f32 v16, v16
    v_exp_f32 v17, v17
    v_smfmac_f32_32x32x32_bf16 v[32:47], v[72:75], v[8:15], v52
    v_exp_f32 v18, v18
    v_exp_f32 v19, v19
    v_exp_f32 v20, v20
    v_mfma_f32_32x32x16_bf16 v[0:15], v[88:91], v[48:51], 0
    v_exp_f32 v21, v21
    v_exp_f32 v22, v22
    v_exp_f32 v23, v23
    v_exp_f32 v24, v24
    v_exp_f32 v25, v25
    v_smfmac_f32_32x32x32_bf16 v[32:47], v[80:83], v[16:23], v52
    v_exp_f32 v26, v26
    v_exp_f32 v27, v27
    v_exp_f32 v28, v28
    v_exp_f32 v29, v29
    v_exp_f32 v30, v30
    v_exp_f32 v31, v31
    v_exp_f32 v0, v0
    v_exp_f32 v1, v1
    v_smfmac_f32_32x32x32_bf16 v[32:47], v[84:87], v[24:31], v52
    v_exp_f32 v2, v2
    v_exp_f32 v3, v3
    v_exp_f32 v4, v4
    v_mfma_f32_32x32x16_bf16 v[16:31], v[100:103], v[48:51], 0
    v_exp_f32 v5, v5
    v_exp_f32 v6, v6
    v_exp_f32 v7, v7
    v_exp_f32 v8, v8
    v_exp_f32 v9, v9
    v_smfmac_f32_32x32x32_bf16 v[32:47], v[92:95], v[0:7], v52
    v_exp_f32 v10, v10
    v_exp_f32 v11, v11
    v_exp_f32 v12, v12
    v_exp_f32 v13, v13
    v_exp_f32 v14, v14
    v_exp_f32 v15, v15
    v_exp_f32 v16, v16
    v_exp_f32 v17, v17
    v_smfmac_f32_32x32x32_bf16 v[32:47], v[96:99], v[8:15], v52
    v_exp_f32 v18, v18
    v_exp_f32 v19, v19
    v_exp_f32 v20, v20
    v_mfma_f32_32x32x16_bf16 v[0:15], v[112:115], v[48:51], 0
    v_exp_f32 v21, v21
    v_exp_f32 v22, v22
    v_exp_f32 v23, v23
    v_exp_f32 v24, v24
    v_exp_f32 v25, v25
    v_smfmac_f32_32x32x32_bf16 v[32:47], v[104:107], v[16:23], v52
    v_exp_f32 v26, v26
    v_exp_f32 v27, v27
    v_exp_f32 v28, v28
    v_exp_f32 v29, v29
    v_exp_f32 v30, v30
    v_exp_f32 v31, v31
    v_exp_f32 v0, v0
    v_exp_f32 v1, v1
    v_smfmac_f32_32x32x32_bf16 v[32:47], v[108:111], v[24:31], v52
    v_exp_f32 v2, v2
    v_exp_f32 v3, v3
    v_exp_f32 v4, v4
    v_mfma_f32_32x32x16_bf16 v[16:31], v[124:127], v[48:51], 0
    v_exp_f32 v5, v5
    v_exp_f32 v6, v6
    v_exp_f32 v7, v7
    v_exp_f32 v8, v8
    v_exp_f32 v9, v9
    v_smfmac_f32_32x32x32_bf16 v[32:47], v[116:119], v[0:7], v52
    v_exp_f32 v10, v10
    v_exp_f32 v11, v11
    v_exp_f32 v12, v12
    v_exp_f32 v13, v13
    v_exp_f32 v14, v14
    v_exp_f32 v15, v15
    v_exp_f32 v16, v16
    v_exp_f32 v17, v17
    v_smfmac_f32_32x32x32_bf16 v[32:47], v[120:123], v[8:15], v52
    v_exp_f32 v18, v18
    v_exp_f32 v19, v19
    v_exp_f32 v20, v20
    v_mfma_f32_32x32x16_bf16 v[0:15], v[136:139], v[48:51], 0
    v_exp_f32 v21, v21
    v_exp_f32 v22, v22
    v_exp_f32 v23, v23
    v_exp_f32 v24, v24
    v_exp_f32 v25, v25
    v_smfmac_f32_32x32x32_bf16 v[32:47], v[128:131], v[16:23], v52
    v_exp_f32 v26, v26
    v_exp_f32 v27, v27
    v_exp_f32 v28, v28
    v_exp_f32 v29, v29
    v_exp_f32 v30, v30
    v_exp_f32 v31, v31
    v_exp_f32 v0, v0
    v_exp_f32 v1, v1
    v_smfmac_f32_32x32x32_bf16 v[32:47], v[132:135], v[24:31], v52
    v_exp_f32 v2, v2
    v_exp_f32 v3, v3
    v_exp_f32 v4, v4
    v_mfma_f32_32x32x16_bf16 v[16:31], v[148:151], v[48:51], 0
    v_exp_f32 v5, v5
    v_exp_f32 v6, v6
    v_exp_f32 v7, v7
    v_exp_f32 v8, v8
    v_exp_f32 v9, v9
    v_smfmac_f32_32x32x32_bf16 v[32:47], v[140:143], v[0:7], v52
    v_exp_f32 v10, v10
    v_exp_f32 v11, v11
    v_exp_f32 v12, v12
    v_exp_f32 v13, v13
    v_exp_f32 v14, v14
    v_exp_f32 v15, v15
    v_exp_f32 v16, v16
    v_exp_f32 v17, v17
    v_smfmac_f32_32x32x32_bf16 v[32:47], v[144:147], v[8:15], v52
    v_exp_f32 v18, v18
    v_exp_f32 v19, v19
    v_exp_f32 v20, v20
    v_mfma_f32_32x32x16_bf16 v[0:15], v[160:163], v[48:51], 0
    v_exp_f32 v21, v21
    v_exp_f32 v22, v22
    v_exp_f32 v23, v23
    v_exp_f32 v24, v24
    v_exp_f32 v25, v25
    v_smfmac_f32_32x32x32_bf16 v[32:47], v[152:155], v[16:23], v52
    v_exp_f32 v26, v26
    v_exp_f32 v27, v27
    v_exp_f32 v28, v28
    v_exp_f32 v29, v29
    v_exp_f32 v30, v30
    v_exp_f32 v31, v31
    v_exp_f32 v0, v0
    v_exp_f32 v1, v1
    v_smfmac_f32_32x32x32_bf16 v[32:47], v[156:159], v[24:31], v52
    v_exp_f32 v2, v2
    v_exp_f32 v3, v3
    v_exp_f32 v4, v4
    v_mfma_f32_32x32x16_bf16 v[16:31], v[172:175], v[48:51], 0
    v_exp_f32 v5, v5
    v_exp_f32 v6, v6
    v_exp_f32 v7, v7
    v_exp_f32 v8, v8
    v_exp_f32 v9, v9
    v_smfmac_f32_32x32x32_bf16 v[32:47], v[164:167], v[0:7], v52
    v_exp_f32 v10, v10
    v_exp_f32 v11, v11
    v_exp_f32 v12, v12
    v_exp_f32 v13, v13
    v_exp_f32 v14, v14
    v_exp_f32 v15, v15
    v_exp_f32 v16, v16
    v_exp_f32 v17, v17
    v_smfmac_f32_32x32x32_bf16 v[32:47], v[168:171], v[8:15], v52
    v_exp_f32 v18, v18
    v_exp_f32 v19, v19
    v_exp_f32 v20, v20
    v_mfma_f32_32x32x16_bf16 v[0:15], v[184:187], v[48:51], 0
    v_exp_f32 v21, v21
    v_exp_f32 v22, v22
    v_exp_f32 v23, v23
    v_exp_f32 v24, v24
    v_exp_f32 v25, v25
    v_smfmac_f32_32x32x32_bf16 v[32:47], v[176:179], v[16:23], v52
    v_exp_f32 v26, v26
    v_exp_f32 v27, v27
    v_exp_f32 v28, v28
    v_exp_f32 v29, v29
    v_exp_f32 v30, v30
    v_exp_f32 v31, v31
    v_exp_f32 v0, v0
    v_exp_f32 v1, v1
    v_smfmac_f32_32x32x32_bf16 v[32:47], v[180:183], v[24:31], v52
    v_exp_f32 v2, v2
    v_exp_f32 v3, v3
    v_exp_f32 v4, v4
    v_mfma_f32_32x32x16_bf16 v[16:31], v[196:199], v[48:51], 0
    v_exp_f32 v5, v5
    v_exp_f32 v6, v6
    v_exp_f32 v7, v7
    v_exp_f32 v8, v8
    v_exp_f32 v9, v9
    v_smfmac_f32_32x32x32_bf16 v[32:47], v[188:191], v[0:7], v52
    v_exp_f32 v10, v10
    v_exp_f32 v11, v11
    v_exp_f32 v12, v12
    v_exp_f32 v13, v13
    v_exp_f32 v14, v14
    v_exp_f32 v15, v15
    v_exp_f32 v16, v16
    v_exp_f32 v17, v17
    v_smfmac_f32_32x32x32_bf16 v[32:47], v[192:195], v[8:15], v52
    v_exp_f32 v18, v18
    v_exp_f32 v19, v19
    v_exp_f32 v20, v20
    v_mfma_f32_32x32x16_bf16 v[0:15], v[208:211], v[48:51], 0
    v_exp_f32 v21, v21
    v_exp_f32 v22, v22
    v_exp_f32 v23, v23
    v_exp_f32 v24, v24
    v_exp_f32 v25, v25
    v_smfmac_f32_32x32x32_bf16 v[32:47], v[200:203], v[16:23], v52
    v_exp_f32 v26, v26
    v_exp_f32 v27, v27
    v_exp_f32 v28, v28
    v_exp_f32 v29, v29
    v_exp_f32 v30, v30
    v_exp_f32 v31, v31
    v_exp_f32 v0, v0
    v_exp_f32 v1, v1
    v_smfmac_f32_32x32x32_bf16 v[32:47], v[204:207], v[24:31], v52
    v_exp_f32 v2, v2
    v_exp_f32 v3, v3
    v_exp_f32 v4, v4
    v_mfma_f32_32x32x16_bf16 v[16:31], v[220:223], v[48:51], 0
    v_exp_f32 v5, v5
    v_exp_f32 v6, v6
    v_exp_f32 v7, v7
    v_exp_f32 v8, v8
    v_exp_f32 v9, v9
    v_smfmac_f32_32x32x32_bf16 v[32:47], v[212:215], v[0:7], v52
    v_exp_f32 v10, v10
    v_exp_f32 v11, v11
    v_exp_f32 v12, v12
    v_exp_f32 v13, v13
    v_exp_f32 v14, v14
    v_exp_f32 v15, v15
    v_exp_f32 v16, v16
    v_exp_f32 v17, v17
    v_smfmac_f32_32x32x32_bf16 v[32:47], v[216:219], v[8:15], v52
    v_exp_f32 v18, v18
    v_exp_f32 v19, v19
    v_exp_f32 v20, v20
    v_mfma_f32_32x32x16_bf16 v[0:15], v[232:235], v[48:51], 0
    ds_read_b32 v55, v53 offset:16
    v_exp_f32 v21, v21
    v_exp_f32 v22, v22
    v_exp_f32 v23, v23
    v_exp_f32 v24, v24
    v_exp_f32 v25, v25
    v_smfmac_f32_32x32x32_bf16 v[32:47], v[224:227], v[16:23], v52
    v_exp_f32 v26, v26
    v_exp_f32 v27, v27
    v_exp_f32 v28, v28
    v_exp_f32 v29, v29
    v_exp_f32 v30, v30
    v_exp_f32 v31, v31
    v_exp_f32 v0, v0
    v_exp_f32 v1, v1
    v_smfmac_f32_32x32x32_bf16 v[32:47], v[228:231], v[24:31], v52
    v_exp_f32 v2, v2
    v_exp_f32 v3, v3
    v_exp_f32 v4, v4
    v_mfma_f32_32x32x16_bf16 v[16:31], v[244:247], v[48:51], 0
    s_waitcnt lgkmcnt(0)
    v_readfirstlane_b32 s53, v55
    s_cmp_ge_u32 s53, EV_R3
    s_cbranch_scc0 gst_36
gbk_37:
    ds_read_b128 v[48:51], v53 offset:10752
    v_exp_f32 v5, v5
    v_exp_f32 v6, v6
    v_exp_f32 v7, v7
    v_exp_f32 v8, v8
    v_exp_f32 v9, v9
    v_smfmac_f32_32x32x32_bf16 v[32:47], v[236:239], v[0:7], v52
    v_exp_f32 v10, v10
    v_exp_f32 v11, v11
    v_exp_f32 v12, v12
    v_exp_f32 v13, v13
    v_exp_f32 v14, v14
    v_exp_f32 v15, v15
    v_exp_f32 v16, v16
    v_exp_f32 v17, v17
    v_smfmac_f32_32x32x32_bf16 v[32:47], v[240:243], v[8:15], v52
    v_exp_f32 v18, v18
    v_exp_f32 v19, v19
    v_exp_f32 v20, v20
    s_waitcnt lgkmcnt(0)
    v_mfma_f32_32x32x16_bf16 v[0:15], v[64:67], v[48:51], 0
    v_exp_f32 v21, v21
    v_exp_f32 v22, v22
    v_exp_f32 v23, v23
    v_exp_f32 v24, v24
    v_exp_f32 v25, v25
    v_smfmac_f32_32x32x32_bf16 v[32:47], v[248:251], v[16:23], v52
    v_exp_f32 v26, v26
    v_exp_f32 v27, v27
    v_exp_f32 v28, v28
    v_exp_f32 v29, v29
    v_exp_f32 v30, v30
    v_exp_f32 v31, v31
    v_exp_f32 v0, v0
    v_exp_f32 v1, v1
    v_smfmac_f32_32x32x32_bf16 v[32:47], v[252:255], v[24:31], v52
    v_exp_f32 v2, v2
    v_exp_f32 v3, v3
    v_exp_f32 v4, v4
    v_mfma_f32_32x32x16_bf16 v[16:31], v[76:79], v[48:51], 0
    v_exp_f32 v5, v5
    v_exp_f32 v6, v6
    v_exp_f32 v7, v7
    v_exp_f32 v8, v8
    v_exp_f32 v9, v9
    v_exp_f32 v10, v10
    v_exp_f32 v11, v11
    v_exp_f32 v12, v12
    ds_write_b128 v54, v[32:35] offset:47104
    ds_write_b128 v54, v[36:39] offset:48128
    ds_write_addtid_b32 v40 offset:49152
    ds_add_u32 v57, v52 offset:64
    v_mov_b64 v[32:33], 0
    v_mov_b64 v[34:35], 0
    v_mov_b64 v[36:37], 0
    v_mov_b64 v[38:39], 0
    v_mov_b32 v40, 0
    v_exp_f32 v13, v13
    v_exp_f32 v14, v14
    v_smfmac_f32_32x32x32_bf16 v[32:47], v[68:71], v[0:7], v52
    v_exp_f32 v15, v15
    v_exp_f32 v16, v16
    v_exp_f32 v17, v17
    v_smfmac_f32_32x32x32_bf16 v[32:47], v[72:75], v[8:15], v52
    v_exp_f32 v18, v18
    v_exp_f32 v19, v19
    v_exp_f32 v20, v20
    v_mfma_f32_32x32x16_bf16 v[0:15], v[88:91], v[48:51], 0
    v_exp_f32 v21, v21
    v_exp_f32 v22, v22
    v_exp_f32 v23, v23
    v_exp_f32 v24, v24
    v_exp_f32 v25, v25
    v_smfmac_f32_32x32x32_bf16 v[32:47], v[80:83], v[16:23], v52
    v_exp_f32 v26, v26
    v_exp_f32 v27, v27
    v_exp_f32 v28, v28
    v_exp_f32 v29, v29
    v_exp_f32 v30, v30
    v_exp_f32 v31, v31
    v_exp_f32 v0, v0
    v_exp_f32 v1, v1
    v_smfmac_f32_32x32x32_bf16 v[32:47], v[84:87], v[24:31], v52
    v_exp_f32 v2, v2
    v_exp_f32 v3, v3
    v_exp_f32 v4, v4
    v_mfma_f32_32x32x16_bf16 v[16:31], v[100:103], v[48:51], 0
    v_exp_f32 v5, v5
    v_exp_f32 v6, v6
    v_exp_f32 v7, v7
    v_exp_f32 v8, v8
    v_exp_f32 v9, v9
    v_smfmac_f32_32x32x32_bf16 v[32:47], v[92:95], v[0:7], v52
    v_exp_f32 v10, v10
    v_exp_f32 v11, v11
    v_exp_f32 v12, v12
    v_exp_f32 v13, v13
    v_exp_f32 v14, v14
    v_exp_f32 v15, v15
    v_exp_f32 v16, v16
    v_exp_f32 v17, v17
    v_smfmac_f32_32x32x32_bf16 v[32:47], v[96:99], v[8:15], v52
    v_exp_f32 v18, v18
    v_exp_f32 v19, v19
    v_exp_f32 v20, v20
    v_mfma_f32_32x32x16_bf16 v[0:15], v[112:115], v[48:51], 0
    v_exp_f32 v21, v21
    v_exp_f32 v22, v22
    v_exp_f32 v23, v23
    v_exp_f32 v24, v24
    v_exp_f32 v25, v25
    v_smfmac_f32_32x32x32_bf16 v[32:47], v[104:107], v[16:23], v52
    v_exp_f32 v26, v26
    v_exp_f32 v27, v27
    v_exp_f32 v28, v28
    v_exp_f32 v29, v29
    v_exp_f32 v30, v30
    v_exp_f32 v31, v31
    v_exp_f32 v0, v0
    v_exp_f32 v1, v1
    v_smfmac_f32_32x32x32_bf16 v[32:47], v[108:111], v[24:31], v52
    v_exp_f32 v2, v2
    v_exp_f32 v3, v3
    v_exp_f32 v4, v4
    v_mfma_f32_32x32x16_bf16 v[16:31], v[124:127], v[48:51], 0
    v_exp_f32 v5, v5
    v_exp_f32 v6, v6
    v_exp_f32 v7, v7
    v_exp_f32 v8, v8
    v_exp_f32 v9, v9
    v_smfmac_f32_32x32x32_bf16 v[32:47], v[116:119], v[0:7], v52
    v_exp_f32 v10, v10
    v_exp_f32 v11, v11
    v_exp_f32 v12, v12
    v_exp_f32 v13, v13
    v_exp_f32 v14, v14
    v_exp_f32 v15, v15
    v_exp_f32 v16, v16
    v_exp_f32 v17, v17
    v_smfmac_f32_32x32x32_bf16 v[32:47], v[120:123], v[8:15], v52
    v_exp_f32 v18, v18
    v_exp_f32 v19, v19
    v_exp_f32 v20, v20
    v_mfma_f32_32x32x16_bf16 v[0:15], v[136:139], v[48:51], 0
    v_exp_f32 v21, v21
    v_exp_f32 v22, v22
    v_exp_f32 v23, v23
    v_exp_f32 v24, v24
    v_exp_f32 v25, v25
    v_smfmac_f32_32x32x32_bf16 v[32:47], v[128:131], v[16:23], v52
    v_exp_f32 v26, v26
    v_exp_f32 v27, v27
    v_exp_f32 v28, v28
    v_exp_f32 v29, v29
    v_exp_f32 v30, v30
    v_exp_f32 v31, v31
    v_exp_f32 v0, v0
    v_exp_f32 v1, v1
    v_smfmac_f32_32x32x32_bf16 v[32:47], v[132:135], v[24:31], v52
    v_exp_f32 v2, v2
    v_exp_f32 v3, v3
    v_exp_f32 v4, v4
    v_mfma_f32_32x32x16_bf16 v[16:31], v[148:151], v[48:51], 0
    v_exp_f32 v5, v5
    v_exp_f32 v6, v6
    v_exp_f32 v7, v7
    v_exp_f32 v8, v8
    v_exp_f32 v9, v9
    v_smfmac_f32_32x32x32_bf16 v[32:47], v[140:143], v[0:7], v52
    v_exp_f32 v10, v10
    v_exp_f32 v11, v11
    v_exp_f32 v12, v12
    v_exp_f32 v13, v13
    v_exp_f32 v14, v14
    v_exp_f32 v15, v15
    v_exp_f32 v16, v16
    v_exp_f32 v17, v17
    v_smfmac_f32_32x32x32_bf16 v[32:47], v[144:147], v[8:15], v52
    v_exp_f32 v18, v18
    v_exp_f32 v19, v19
    v_exp_f32 v20, v20
    v_mfma_f32_32x32x16_bf16 v[0:15], v[160:163], v[48:51], 0
    v_exp_f32 v21, v21
    v_exp_f32 v22, v22
    s_add_u32 s68, s76, 393216
    buffer_load_dwordx4 v[64:67], v56, s[32:35], s68 offen offset:0 sc1
    v_exp_f32 v23, v23
    v_exp_f32 v24, v24
    v_exp_f32 v25, v25
    v_smfmac_f32_32x32x32_bf16 v[32:47], v[152:155], v[16:23], v52
    v_exp_f32 v26, v26
    v_exp_f32 v27, v27
    v_exp_f32 v28, v28
    v_exp_f32 v29, v29
    v_exp_f32 v30, v30
    s_add_u32 s69, s76, 425984
    buffer_load_dwordx4 v[68:71], v53, s[32:35], s69 offen offset:0 sc1
PAD3:
    s_cbranch_execz PADRET
    v_mov_b64 v[72:73], v[58:59]
    v_mov_b64 v[74:75], v[58:59]
    v_exp_f32 v31, v31
    v_exp_f32 v0, v0
    v_exp_f32 v1, v1
    v_smfmac_f32_32x32x32_bf16 v[32:47], v[156:159], v[24:31], v52
    v_exp_f32 v2, v2
    v_exp_f32 v3, v3
    v_exp_f32 v4, v4
    v_mfma_f32_32x32x16_bf16 v[16:31], v[172:175], v[48:51], 0
    v_exp_f32 v5, v5
    v_exp_f32 v6, v6
    buffer_load_dwordx4 v[76:79], v56, s[32:35], s68 offen offset:1024 sc1
    v_exp_f32 v7, v7
    v_exp_f32 v8, v8
    v_exp_f32 v9, v9
    v_smfmac_f32_32x32x32_bf16 v[32:47], v[164:167], v[0:7], v52
    v_exp_f32 v10, v10
    v_exp_f32 v11, v11
    v_exp_f32 v12, v12
    v_exp_f32 v13, v13
    v_exp_f32 v14, v14
    buffer_load_dwordx4 v[80:83], v53, s[32:35], s69 offen offset:1024 sc1
    v_mov_b64 v[84:85], v[58:59]
    v_mov_b64 v[86:87], v[58:59]
    v_exp_f32 v15, v15
    v_exp_f32 v16, v16
    v_exp_f32 v17, v17
    v_smfmac_f32_32x32x32_bf16 v[32:47], v[168:171], v[8:15], v52
    v_exp_f32 v18, v18
    v_exp_f32 v19, v19
    v_exp_f32 v20, v20
    v_mfma_f32_32x32x16_bf16 v[0:15], v[184:187], v[48:51], 0
    v_exp_f32 v21, v21
    v_exp_f32 v22, v22
    buffer_load_dwordx4 v[88:91], v56, s[32:35], s68 offen offset:2048 sc1
    v_exp_f32 v23, v23
    v_exp_f32 v24, v24
    v_exp_f32 v25, v25
    v_smfmac_f32_32x32x32_bf16 v[32:47], v[176:179], v[16:23], v52
    v_exp_f32 v26, v26
    v_exp_f32 v27, v27
    v_exp_f32 v28, v28
    v_exp_f32 v29, v29
    v_exp_f32 v30, v30
    buffer_load_dwordx4 v[92:95], v53, s[32:35], s69 offen offset:2048 sc1
    v_mov_b64 v[96:97], v[58:59]
    v_mov_b64 v[98:99], v[58:59]
    v_exp_f32 v31, v31
    v_exp_f32 v0, v0
    v_exp_f32 v1, v1
    v_smfmac_f32_32x32x32_bf16 v[32:47], v[180:183], v[24:31], v52
    v_exp_f32 v2, v2
    v_exp_f32 v3, v3
    v_exp_f32 v4, v4
    v_mfma_f32_32x32x16_bf16 v[16:31], v[196:199], v[48:51], 0
    v_exp_f32 v5, v5
    v_exp_f32 v6, v6
    buffer_load_dwordx4 v[100:103], v56, s[32:35], s68 offen offset:3072 sc1
    v_exp_f32 v7, v7
    v_exp_f32 v8, v8
    v_exp_f32 v9, v9
    v_smfmac_f32_32x32x32_bf16 v[32:47], v[188:191], v[0:7], v52
    v_exp_f32 v10, v10
    v_exp_f32 v11, v11
    v_exp_f32 v12, v12
    v_exp_f32 v13, v13
    v_exp_f32 v14, v14
    buffer_load_dwordx4 v[104:107], v53, s[32:35], s69 offen offset:3072 sc1
    v_mov_b64 v[108:109], v[58:59]
    v_mov_b64 v[110:111], v[58:59]
    v_exp_f32 v15, v15
    v_exp_f32 v16, v16
    v_exp_f32 v17, v17
    v_smfmac_f32_32x32x32_bf16 v[32:47], v[192:195], v[8:15], v52
    v_exp_f32 v18, v18
    v_exp_f32 v19, v19
    v_exp_f32 v20, v20
    v_mfma_f32_32x32x16_bf16 v[0:15], v[208:211], v[48:51], 0
    v_exp_f32 v21, v21
    v_exp_f32 v22, v22
    s_add_u32 s68, s76, 397312
    buffer_load_dwordx4 v[112:115], v56, s[32:35], s68 offen offset:0 sc1
    v_exp_f32 v23, v23
    v_exp_f32 v24, v24
    v_exp_f32 v25, v25
    v_smfmac_f32_32x32x32_bf16 v[32:47], v[200:203], v[16:23], v52
    v_exp_f32 v26, v26
    v_exp_f32 v27, v27
    v_exp_f32 v28, v28
    v_exp_f32 v29, v29
    v_exp_f32 v30, v30
    s_add_u32 s69, s76, 430080
    buffer_load_dwordx4 v[116:119], v53, s[32:35], s69 offen offset:0 sc1
    v_mov_b64 v[120:121], v[58:59]
    v_mov_b64 v[122:123], v[58:59]
    v_exp_f32 v31, v31
    v_exp_f32 v0, v0
    v_exp_f32 v1, v1
    v_smfmac_f32_32x32x32_bf16 v[32:47], v[204:207], v[24:31], v52
    v_exp_f32 v2, v2
    v_exp_f32 v3, v3
    v_exp_f32 v4, v4
    v_mfma_f32_32x32x16_bf16 v[16:31], v[220:223], v[48:51], 0
    v_exp_f32 v5, v5
    v_exp_f32 v6, v6
    buffer_load_dwordx4 v[124:127], v56, s[32:35], s68 offen offset:1024 sc1
    v_exp_f32 v7, v7
    v_exp_f32 v8, v8
    v_exp_f32 v9, v9
    v_smfmac_f32_32x32x32_bf16 v[32:47], v[212:215], v[0:7], v52
    v_exp_f32 v10, v10
    v_exp_f32 v11, v11
    v_exp_f32 v12, v12
    v_exp_f32 v13, v13
    v_exp_f32 v14, v14
    buffer_load_dwordx4 v[128:131], v53, s[32:35], s69 offen offset:1024 sc1
    v_mov_b64 v[132:133], v[58:59]
    v_mov_b64 v[134:135], v[58:59]
    v_exp_f32 v15, v15
    v_exp_f32 v16, v16
    v_exp_f32 v17, v17
    v_smfmac_f32_32x32x32_bf16 v[32:47], v[216:219], v[8:15], v52
    v_exp_f32 v18, v18
    v_exp_f32 v19, v19
    v_exp_f32 v20, v20
    v_mfma_f32_32x32x16_bf16 v[0:15], v[232:235], v[48:51], 0
    ds_read_b32 v55, v53 offset:16
    v_exp_f32 v21, v21
    v_exp_f32 v22, v22
    buffer_load_dwordx4 v[136:139], v56, s[32:35], s68 offen offset:2048 sc1
    v_exp_f32 v23, v23
    v_exp_f32 v24, v24
    v_exp_f32 v25, v25
    v_smfmac_f32_32x32x32_bf16 v[32:47], v[224:227], v[16:23], v52
    v_exp_f32 v26, v26
    v_exp_f32 v27, v27
    v_exp_f32 v28, v28
    v_exp_f32 v29, v29
    v_exp_f32 v30, v30
    buffer_load_dwordx4 v[140:143], v53, s[32:35], s69 offen offset:2048 sc1
    v_mov_b64 v[144:145], v[58:59]
    v_mov_b64 v[146:147], v[58:59]
    v_exp_f32 v31, v31
    v_exp_f32 v0, v0
    v_exp_f32 v1, v1
    v_smfmac_f32_32x32x32_bf16 v[32:47], v[228:231], v[24:31], v52
    v_exp_f32 v2, v2
    v_exp_f32 v3, v3
    v_exp_f32 v4, v4
    v_mfma_f32_32x32x16_bf16 v[16:31], v[244:247], v[48:51], 0
    s_waitcnt lgkmcnt(0)
    v_readfirstlane_b32 s53, v55
    s_cmp_ge_u32 s53, EV_Q8
    s_cbranch_scc0 gst_38
gbk_39:
    ds_read_b128 v[48:51], v53 offset:4608
    v_exp_f32 v5, v5
    v_exp_f32 v6, v6
    buffer_load_dwordx4 v[148:151], v56, s[32:35], s68 offen offset:3072 sc1
    v_exp_f32 v7, v7
    v_exp_f32 v8, v8
    v_exp_f32 v9, v9
    v_smfmac_f32_32x32x32_bf16 v[32:47], v[236:239], v[0:7], v52
    v_exp_f32 v10, v10
    v_exp_f32 v11, v11
    v_exp_f32 v12, v12
    v_exp_f32 v13, v13
    v_exp_f32 v14, v14
    buffer_load_dwordx4 v[152:155], v53, s[32:35], s69 offen offset:3072 sc1
    v_mov_b64 v[156:157], v[58:59]
    v_mov_b64 v[158:159], v[58:59]
    v_exp_f32 v15, v15
    v_exp_f32 v16, v16
    v_exp_f32 v17, v17
    v_smfmac_f32_32x32x32_bf16 v[32:47], v[240:243], v[8:15], v52
    v_exp_f32 v18, v18
    v_exp_f32 v19, v19
    v_exp_f32 v20, v20
    s_waitcnt vmcnt(8)
ck_40:
    v_max_u32 v55, v64, v68
    v_max3_u32 v55, v55, v70, v76
    v_max3_u32 v55, v55, v80, v82
    v_max3_u32 v55, v55, v88, v92
    v_max3_u32 v55, v55, v94, v100
    v_max3_u32 v55, v55, v104, v106
    v_cmp_eq_u32 vcc, -1, v55
    s_cbranch_vccnz ckrt_42
ckok_41:
    v_permlane16_swap_b32 v68, v72
    v_permlane16_swap_b32 v69, v73
    v_permlane16_swap_b32 v70, v74
    v_permlane16_swap_b32 v71, v75
    v_permlane16_swap_b32 v80, v84
    v_permlane16_swap_b32 v81, v85
    v_permlane16_swap_b32 v82, v86
    v_permlane16_swap_b32 v83, v87
    v_permlane16_swap_b32 v92, v96
    v_permlane16_swap_b32 v93, v97
    v_permlane16_swap_b32 v94, v98
    v_permlane16_swap_b32 v95, v99
    v_permlane16_swap_b32 v104, v108
    v_permlane16_swap_b32 v105, v109
    v_permlane16_swap_b32 v106, v110
    v_permlane16_swap_b32 v107, v111
    s_waitcnt lgkmcnt(0)
    v_mfma_f32_32x32x16_bf16 v[0:15], v[64:67], v[48:51], 0
    v_exp_f32 v21, v21
    v_exp_f32 v22, v22
    v_exp_f32 v23, v23
    v_exp_f32 v24, v24
    v_exp_f32 v25, v25
    v_smfmac_f32_32x32x32_bf16 v[32:47], v[248:251], v[16:23], v52
    v_exp_f32 v26, v26
    v_exp_f32 v27, v27
    v_exp_f32 v28, v28
    v_exp_f32 v29, v29
    v_exp_f32 v30, v30
    v_exp_f32 v31, v31
    v_exp_f32 v0, v0
    v_exp_f32 v1, v1
    v_smfmac_f32_32x32x32_bf16 v[32:47], v[252:255], v[24:31], v52
    v_exp_f32 v2, v2
    v_exp_f32 v3, v3
    v_exp_f32 v4, v4
    v_mfma_f32_32x32x16_bf16 v[16:31], v[76:79], v[48:51], 0
    v_exp_f32 v5, v5
    v_exp_f32 v6, v6
    v_exp_f32 v7, v7
    v_exp_f32 v8, v8
    v_exp_f32 v9, v9
    v_exp_f32 v10, v10
    v_exp_f32 v11, v11
    v_exp_f32 v12, v12
    ds_write_b128 v54, v[32:35] offset:56320
    ds_write_b128 v54, v[36:39] offset:57344
    ds_write_addtid_b32 v40 offset:58368
    ds_add_u32 v57, v52 offset:64
    v_mov_b64 v[32:33], 0
    v_mov_b64 v[34:35], 0
    v_mov_b64 v[36:37], 0
    v_mov_b64 v[38:39], 0
    v_mov_b32 v40, 0
    v_exp_f32 v13, v13
    v_exp_f32 v14, v14
    v_smfmac_f32_32x32x32_bf16 v[32:47], v[68:71], v[0:7], v52
    v_exp_f32 v15, v15
    v_exp_f32 v16, v16
    v_exp_f32 v17, v17
    v_smfmac_f32_32x32x32_bf16 v[32:47], v[72:75], v[8:15], v52
    v_exp_f32 v18, v18
    v_exp_f32 v19, v19
    v_exp_f32 v20, v20
    v_mfma_f32_32x32x16_bf16 v[0:15], v[88:91], v[48:51], 0
    v_exp_f32 v21, v21
    v_exp_f32 v22, v22
    v_exp_f32 v23, v23
    v_exp_f32 v24, v24
    v_exp_f32 v25, v25
    v_smfmac_f32_32x32x32_bf16 v[32:47], v[80:83], v[16:23], v52
    v_exp_f32 v26, v26
    v_exp_f32 v27, v27
    v_exp_f32 v28, v28
    v_exp_f32 v29, v29
    v_exp_f32 v30, v30
    v_exp_f32 v31, v31
    v_exp_f32 v0, v0
    v_exp_f32 v1, v1
    v_smfmac_f32_32x32x32_bf16 v[32:47], v[84:87], v[24:31], v52
    v_exp_f32 v2, v2
    v_exp_f32 v3, v3
    v_exp_f32 v4, v4
    v_mfma_f32_32x32x16_bf16 v[16:31], v[100:103], v[48:51], 0
    v_exp_f32 v5, v5
    v_exp_f32 v6, v6
    v_exp_f32 v7, v7
    v_exp_f32 v8, v8
    v_exp_f32 v9, v9
    v_smfmac_f32_32x32x32_bf16 v[32:47], v[92:95], v[0:7], v52
    v_exp_f32 v10, v10
    v_exp_f32 v11, v11
    v_exp_f32 v12, v12
    v_exp_f32 v13, v13
    v_exp_f32 v14, v14
    v_exp_f32 v15, v15
    v_exp_f32 v16, v16
    v_exp_f32 v17, v17
    v_smfmac_f32_32x32x32_bf16 v[32:47], v[96:99], v[8:15], v52
    v_exp_f32 v18, v18
    v_exp_f32 v19, v19
    v_exp_f32 v20, v20
    s_waitcnt vmcnt(0)
ck_43:
    v_max_u32 v55, v112, v116
    v_max3_u32 v55, v55, v118, v124
    v_max3_u32 v55, v55, v128, v130
    v_max3_u32 v55, v55, v136, v140
    v_max3_u32 v55, v55, v142, v148
    v_max3_u32 v55, v55, v152, v154
    v_cmp_eq_u32 vcc, -1, v55
    s_cbranch_vccnz ckrt_45
ckok_44:
    v_permlane16_swap_b32 v116, v120
    v_permlane16_swap_b32 v117, v121
    v_permlane16_swap_b32 v118, v122
    v_permlane16_swap_b32 v119, v123
    v_permlane16_swap_b32 v128, v132
    v_permlane16_swap_b32 v129, v133
    v_permlane16_swap_b32 v130, v134
    v_permlane16_swap_b32 v131, v135
    v_permlane16_swap_b32 v140, v144
    v_permlane16_swap_b32 v141, v145
    v_permlane16_swap_b32 v142, v146
    v_permlane16_swap_b32 v143, v147
    v_permlane16_swap_b32 v152, v156
    v_permlane16_swap_b32 v153, v157
    v_permlane16_swap_b32 v154, v158
    v_permlane16_swap_b32 v155, v159
    v_mfma_f32_32x32x16_bf16 v[0:15], v[112:115], v[48:51], 0
    v_exp_f32 v21, v21
    v_exp_f32 v22, v22
    v_exp_f32 v23, v23
    v_exp_f32 v24, v24
    v_exp_f32 v25, v25
    v_smfmac_f32_32x32x32_bf16 v[32:47], v[104:107], v[16:23], v52
    v_exp_f32 v26, v26
    v_exp_f32 v27, v27
    v_exp_f32 v28, v28
    v_exp_f32 v29, v29
    v_exp_f32 v30, v30
    v_exp_f32 v31, v31
    v_exp_f32 v0, v0
    v_exp_f32 v1, v1
    v_smfmac_f32_32x32x32_bf16 v[32:47], v[108:111], v[24:31], v52
    v_exp_f32 v2, v2
    v_exp_f32 v3, v3
    v_exp_f32 v4, v4
    v_mov_b64 v[168:169], v[58:59]
    v_mov_b64 v[170:171], v[58:59]
    v_mov_b64 v[180:181], v[58:59]
    v_mov_b64 v[182:183], v[58:59]
    v_mov_b64 v[192:193], v[58:59]
    v_mov_b64 v[194:195], v[58:59]
    v_mov_b64 v[204:205], v[58:59]
    v_mov_b64 v[206:207], v[58:59]
    v_mov_b64 v[216:217], v[58:59]
    v_mov_b64 v[218:219], v[58:59]
    v_mov_b64 v[228:229], v[58:59]
    v_mov_b64 v[230:231], v[58:59]
    v_mov_b64 v[240:241], v[58:59]
    v_mov_b64 v[242:243], v[58:59]
    v_mov_b64 v[252:253], v[58:59]
    v_mov_b64 v[254:255], v[58:59]
    v_mfma_f32_32x32x16_bf16 v[16:31], v[124:127], v[48:51], 0
    v_exp_f32 v5, v5
    v_exp_f32 v6, v6
    v_exp_f32 v7, v7
    v_exp_f32 v8, v8
    v_exp_f32 v9, v9
    v_smfmac_f32_32x32x32_bf16 v[32:47], v[116:119], v[0:7], v52
    v_exp_f32 v10, v10
    v_exp_f32 v11, v11
    v_exp_f32 v12, v12
    v_exp_f32 v13, v13
    v_exp_f32 v14, v14
    v_exp_f32 v15, v15
    v_exp_f32 v16, v16
    v_exp_f32 v17, v17
    v_smfmac_f32_32x32x32_bf16 v[32:47], v[120:123], v[8:15], v52
    v_exp_f32 v18, v18
    v_exp_f32 v19, v19
    v_exp_f32 v20, v20
    v_mfma_f32_32x32x16_bf16 v[0:15], v[136:139], v[48:51], 0
    v_exp_f32 v21, v21
    v_exp_f32 v22, v22
    v_exp_f32 v23, v23
    v_exp_f32 v24, v24
    v_exp_f32 v25, v25
    v_smfmac_f32_32x32x32_bf16 v[32:47], v[128:131], v[16:23], v52
    v_exp_f32 v26, v26
    v_exp_f32 v27, v27
    v_exp_f32 v28, v28
    v_exp_f32 v29, v29
    v_exp_f32 v30, v30
    v_exp_f32 v31, v31
    v_exp_f32 v0, v0
    v_exp_f32 v1, v1
    v_smfmac_f32_32x32x32_bf16 v[32:47], v[132:135], v[24:31], v52
    v_exp_f32 v2, v2
    v_exp_f32 v3, v3
    v_exp_f32 v4, v4
    v_mfma_f32_32x32x16_bf16 v[16:31], v[148:151], v[48:51], 0
    ds_read_b128 v[48:51], v53 offset:5632
    v_exp_f32 v5, v5
    v_exp_f32 v6, v6
    v_exp_f32 v7, v7
    v_exp_f32 v8, v8
    v_exp_f32 v9, v9
    v_smfmac_f32_32x32x32_bf16 v[32:47], v[140:143], v[0:7], v52
    v_exp_f32 v10, v10
    v_exp_f32 v11, v11
    v_exp_f32 v12, v12
    v_exp_f32 v13, v13
    v_exp_f32 v14, v14
    v_exp_f32 v15, v15
    v_exp_f32 v16, v16
    v_exp_f32 v17, v17
    v_smfmac_f32_32x32x32_bf16 v[32:47], v[144:147], v[8:15], v52
    v_exp_f32 v18, v18
    v_exp_f32 v19, v19
    v_exp_f32 v20, v20
    s_waitcnt lgkmcnt(0)
    v_mfma_f32_32x32x16_bf16 v[0:15], v[64:67], v[48:51], 0
    v_exp_f32 v21, v21
    v_exp_f32 v22, v22
    v_exp_f32 v23, v23
    v_exp_f32 v24, v24
    v_exp_f32 v25, v25
    v_smfmac_f32_32x32x32_bf16 v[32:47], v[152:155], v[16:23], v52
    v_exp_f32 v26, v26
    v_exp_f32 v27, v27
    v_exp_f32 v28, v28
    v_exp_f32 v29, v29
    v_exp_f32 v30, v30
    v_exp_f32 v31, v31
    v_exp_f32 v0, v0
    v_exp_f32 v1, v1
    v_smfmac_f32_32x32x32_bf16 v[32:47], v[156:159], v[24:31], v52
    v_exp_f32 v2, v2
    v_exp_f32 v3, v3
    v_exp_f32 v4, v4
    v_mfma_f32_32x32x16_bf16 v[16:31], v[76:79], v[48:51], 0
    v_exp_f32 v5, v5
    v_exp_f32 v6, v6
    v_exp_f32 v7, v7
    v_exp_f32 v8, v8
    v_exp_f32 v9, v9
    v_exp_f32 v10, v10
    v_exp_f32 v11, v11
    v_exp_f32 v12, v12
    ds_write_b128 v54, v[32:35] offset:37888
    ds_write_b128 v54, v[36:39] offset:38912
    ds_write_addtid_b32 v40 offset:39936
    v_mov_b64 v[32:33], 0
    v_mov_b64 v[34:35], 0
    v_mov_b64 v[36:37], 0
    v_mov_b64 v[38:39], 0
    v_mov_b32 v40, 0
    v_exp_f32 v13, v13
    v_exp_f32 v14, v14
    v_smfmac_f32_32x32x32_bf16 v[32:47], v[68:71], v[0:7], v52
    v_exp_f32 v15, v15
    v_exp_f32 v16, v16
    v_exp_f32 v17, v17
    v_smfmac_f32_32x32x32_bf16 v[32:47], v[72:75], v[8:15], v52
    v_exp_f32 v18, v18
    v_exp_f32 v19, v19
    v_exp_f32 v20, v20
    v_mfma_f32_32x32x16_bf16 v[0:15], v[88:91], v[48:51], 0
    v_exp_f32 v21, v21
    v_exp_f32 v22, v22
    v_exp_f32 v23, v23
    v_exp_f32 v24, v24
    v_exp_f32 v25, v25
    v_smfmac_f32_32x32x32_bf16 v[32:47], v[80:83], v[16:23], v52
    v_exp_f32 v26, v26
    v_exp_f32 v27, v27
    v_exp_f32 v28, v28
    v_exp_f32 v29, v29
    v_exp_f32 v30, v30
    v_exp_f32 v31, v31
    v_exp_f32 v0, v0
    v_exp_f32 v1, v1
    v_smfmac_f32_32x32x32_bf16 v[32:47], v[84:87], v[24:31], v52
    v_exp_f32 v2, v2
    v_exp_f32 v3, v3
    v_exp_f32 v4, v4
    v_mfma_f32_32x32x16_bf16 v[16:31], v[100:103], v[48:51], 0
    v_exp_f32 v5, v5
    v_exp_f32 v6, v6
    v_exp_f32 v7, v7
    v_exp_f32 v8, v8
    v_exp_f32 v9, v9
    v_smfmac_f32_32x32x32_bf16 v[32:47], v[92:95], v[0:7], v52
    v_exp_f32 v10, v10
    v_exp_f32 v11, v11
    v_exp_f32 v12, v12
    v_exp_f32 v13, v13
    v_exp_f32 v14, v14
    v_exp_f32 v15, v15
    v_exp_f32 v16, v16
    v_exp_f32 v17, v17
    v_smfmac_f32_32x32x32_bf16 v[32:47], v[96:99], v[8:15], v52
    v_exp_f32 v18, v18
    v_exp_f32 v19, v19
    v_exp_f32 v20, v20
    v_mfma_f32_32x32x16_bf16 v[0:15], v[112:115], v[48:51], 0
    v_exp_f32 v21, v21
    v_exp_f32 v22, v22
    v_exp_f32 v23, v23
    v_exp_f32 v24, v24
    v_exp_f32 v25, v25
    v_smfmac_f32_32x32x32_bf16 v[32:47], v[104:107], v[16:23], v52
    v_exp_f32 v26, v26
    v_exp_f32 v27, v27
    v_exp_f32 v28, v28
    v_exp_f32 v29, v29
    v_exp_f32 v30, v30
    v_exp_f32 v31, v31
    v_exp_f32 v0, v0
    v_exp_f32 v1, v1
    v_smfmac_f32_32x32x32_bf16 v[32:47], v[108:111], v[24:31], v52
    v_exp_f32 v2, v2
    v_exp_f32 v3, v3
    v_exp_f32 v4, v4
    v_mfma_f32_32x32x16_bf16 v[16:31], v[124:127], v[48:51], 0
    v_exp_f32 v5, v5
    v_exp_f32 v6, v6
    v_exp_f32 v7, v7
    v_exp_f32 v8, v8
    v_exp_f32 v9, v9
    v_smfmac_f32_32x32x32_bf16 v[32:47], v[116:119], v[0:7], v52
    v_exp_f32 v10, v10
    v_exp_f32 v11, v11
    v_exp_f32 v12, v12
    v_exp_f32 v13, v13
    v_exp_f32 v14, v14
    v_exp_f32 v15, v15
    v_exp_f32 v16, v16
    v_exp_f32 v17, v17
    v_smfmac_f32_32x32x32_bf16 v[32:47], v[120:123], v[8:15], v52
    v_exp_f32 v18, v18
    v_exp_f32 v19, v19
    v_exp_f32 v20, v20
    v_mfma_f32_32x32x16_bf16 v[0:15], v[136:139], v[48:51], 0
    ds_read_b32 v55, v53 offset:16
    v_exp_f32 v21, v21
    v_exp_f32 v22, v22
    v_exp_f32 v23, v23
    v_exp_f32 v24, v24
    v_exp_f32 v25, v25
    v_smfmac_f32_32x32x32_bf16 v[32:47], v[128:131], v[16:23], v52
    v_exp_f32 v26, v26
    v_exp_f32 v27, v27
    v_exp_f32 v28, v28
    v_exp_f32 v29, v29
    v_exp_f32 v30, v30
    v_exp_f32 v31, v31
    v_exp_f32 v0, v0
    v_exp_f32 v1, v1
    v_smfmac_f32_32x32x32_bf16 v[32:47], v[132:135], v[24:31], v52
    v_exp_f32 v2, v2
    v_exp_f32 v3, v3
    v_exp_f32 v4, v4
    v_mfma_f32_32x32x16_bf16 v[16:31], v[148:151], v[48:51], 0
    s_waitcnt lgkmcnt(0)
    v_readfirstlane_b32 s53, v55
    s_cmp_ge_u32 s53, EV_R7
    s_cbranch_scc0 gst_46
gbk_47:
    ds_read_b128 v[48:51], v53 offset:6656
    v_exp_f32 v5, v5
    v_exp_f32 v6, v6
    v_exp_f32 v7, v7
    v_exp_f32 v8, v8
    v_exp_f32 v9, v9
    v_smfmac_f32_32x32x32_bf16 v[32:47], v[140:143], v[0:7], v52
    v_exp_f32 v10, v10
    v_exp_f32 v11, v11
    v_exp_f32 v12, v12
    v_exp_f32 v13, v13
    v_exp_f32 v14, v14
    v_exp_f32 v15, v15
    v_exp_f32 v16, v16
    v_exp_f32 v17, v17
    v_smfmac_f32_32x32x32_bf16 v[32:47], v[144:147], v[8:15], v52
    v_exp_f32 v18, v18
    v_exp_f32 v19, v19
    v_exp_f32 v20, v20
    s_waitcnt lgkmcnt(0)
    v_mfma_f32_32x32x16_bf16 v[0:15], v[64:67], v[48:51], 0
    v_exp_f32 v21, v21
    v_exp_f32 v22, v22
    v_exp_f32 v23, v23
    v_exp_f32 v24, v24
    v_exp_f32 v25, v25
    v_smfmac_f32_32x32x32_bf16 v[32:47], v[152:155], v[16:23], v52
    v_exp_f32 v26, v26
    v_exp_f32 v27, v27
    v_exp_f32 v28, v28
    v_exp_f32 v29, v29
    v_exp_f32 v30, v30
    v_exp_f32 v31, v31
    v_exp_f32 v0, v0
    v_exp_f32 v1, v1
    v_smfmac_f32_32x32x32_bf16 v[32:47], v[156:159], v[24:31], v52
    v_exp_f32 v2, v2
    v_exp_f32 v3, v3
    v_exp_f32 v4, v4
    v_mfma_f32_32x32x16_bf16 v[16:31], v[76:79], v[48:51], 0
    v_exp_f32 v5, v5
    v_exp_f32 v6, v6
    v_exp_f32 v7, v7
    v_exp_f32 v8, v8
    v_exp_f32 v9, v9
    v_exp_f32 v10, v10
    v_exp_f32 v11, v11
    v_exp_f32 v12, v12
    ds_write_b128 v54, v[32:35] offset:47104
    ds_write_b128 v54, v[36:39] offset:48128
    ds_write_addtid_b32 v40 offset:49152
    v_mov_b64 v[32:33], 0
    v_mov_b64 v[34:35], 0
    v_mov_b64 v[36:37], 0
    v_mov_b64 v[38:39], 0
    v_mov_b32 v40, 0
    v_exp_f32 v13, v13
    v_exp_f32 v14, v14
    v_smfmac_f32_32x32x32_bf16 v[32:47], v[68:71], v[0:7], v52
    v_exp_f32 v15, v15
    v_exp_f32 v16, v16
    v_exp_f32 v17, v17
    v_smfmac_f32_32x32x32_bf16 v[32:47], v[72:75], v[8:15], v52
    v_exp_f32 v18, v18
    v_exp_f32 v19, v19
    v_exp_f32 v20, v20
    v_mfma_f32_32x32x16_bf16 v[0:15], v[88:91], v[48:51], 0
    v_exp_f32 v21, v21
    v_exp_f32 v22, v22
    v_exp_f32 v23, v23
    v_exp_f32 v24, v24
    v_exp_f32 v25, v25
    v_smfmac_f32_32x32x32_bf16 v[32:47], v[80:83], v[16:23], v52
    v_exp_f32 v26, v26
    v_exp_f32 v27, v27
    v_exp_f32 v28, v28
    v_exp_f32 v29, v29
    v_exp_f32 v30, v30
    v_exp_f32 v31, v31
    v_exp_f32 v0, v0
    v_exp_f32 v1, v1
    v_smfmac_f32_32x32x32_bf16 v[32:47], v[84:87], v[24:31], v52
    v_exp_f32 v2, v2
    v_exp_f32 v3, v3
    v_exp_f32 v4, v4
    v_mfma_f32_32x32x16_bf16 v[16:31], v[100:103], v[48:51], 0
    v_exp_f32 v5, v5
    v_exp_f32 v6, v6
    v_exp_f32 v7, v7
    v_exp_f32 v8, v8
    v_exp_f32 v9, v9
    v_smfmac_f32_32x32x32_bf16 v[32:47], v[92:95], v[0:7], v52
    v_exp_f32 v10, v10
    v_exp_f32 v11, v11
    v_exp_f32 v12, v12
    v_exp_f32 v13, v13
    v_exp_f32 v14, v14
    v_exp_f32 v15, v15
    v_exp_f32 v16, v16
    v_exp_f32 v17, v17
    v_smfmac_f32_32x32x32_bf16 v[32:47], v[96:99], v[8:15], v52
    v_exp_f32 v18, v18
    v_exp_f32 v19, v19
    v_exp_f32 v20, v20
    v_mfma_f32_32x32x16_bf16 v[0:15], v[112:115], v[48:51], 0
    v_exp_f32 v21, v21
    v_exp_f32 v22, v22
    v_exp_f32 v23, v23
    v_exp_f32 v24, v24
    v_exp_f32 v25, v25
    v_smfmac_f32_32x32x32_bf16 v[32:47], v[104:107], v[16:23], v52
    v_exp_f32 v26, v26
    v_exp_f32 v27, v27
    v_exp_f32 v28, v28
    v_exp_f32 v29, v29
    v_exp_f32 v30, v30
    v_exp_f32 v31, v31
    v_exp_f32 v0, v0
    v_exp_f32 v1, v1
    v_smfmac_f32_32x32x32_bf16 v[32:47], v[108:111], v[24:31], v52
    v_exp_f32 v2, v2
    v_exp_f32 v3, v3
    v_exp_f32 v4, v4
    v_mfma_f32_32x32x16_bf16 v[16:31], v[124:127], v[48:51], 0
    v_exp_f32 v5, v5
    v_exp_f32 v6, v6
    v_exp_f32 v7, v7
    v_exp_f32 v8, v8
    v_exp_f32 v9, v9
    v_smfmac_f32_32x32x32_bf16 v[32:47], v[116:119], v[0:7], v52
    v_exp_f32 v10, v10
    v_exp_f32 v11, v11
    v_exp_f32 v12, v12
    v_exp_f32 v13, v13
    v_exp_f32 v14, v14
    v_exp_f32 v15, v15
    v_exp_f32 v16, v16
    v_exp_f32 v17, v17
    v_smfmac_f32_32x32x32_bf16 v[32:47], v[120:123], v[8:15], v52
    v_exp_f32 v18, v18
    v_exp_f32 v19, v19
    v_exp_f32 v20, v20
    v_mfma_f32_32x32x16_bf16 v[0:15], v[136:139], v[48:51], 0
    v_exp_f32 v21, v21
    v_exp_f32 v22, v22
    v_exp_f32 v23, v23
    v_exp_f32 v24, v24
    v_exp_f32 v25, v25
    v_smfmac_f32_32x32x32_bf16 v[32:47], v[128:131], v[16:23], v52
    v_exp_f32 v26, v26
    v_exp_f32 v27, v27
    v_exp_f32 v28, v28
    v_exp_f32 v29, v29
    v_exp_f32 v30, v30
    v_exp_f32 v31, v31
    v_exp_f32 v0, v0
    v_exp_f32 v1, v1
    v_smfmac_f32_32x32x32_bf16 v[32:47], v[132:135], v[24:31], v52
    v_exp_f32 v2, v2
    v_exp_f32 v3, v3
    v_exp_f32 v4, v4
    v_mfma_f32_32x32x16_bf16 v[16:31], v[148:151], v[48:51], 0
    ds_read_b128 v[48:51], v53 offset:3584
    v_exp_f32 v5, v5
    v_exp_f32 v6, v6
    v_exp_f32 v7, v7
    v_exp_f32 v8, v8
    v_exp_f32 v9, v9
    v_smfmac_f32_32x32x32_bf16 v[32:47], v[140:143], v[0:7], v52
    v_exp_f32 v10, v10
    v_exp_f32 v11, v11
    v_exp_f32 v12, v12
    v_exp_f32 v13, v13
    v_exp_f32 v14, v14
    v_exp_f32 v15, v15
    v_exp_f32 v16, v16
    v_exp_f32 v17, v17
    v_smfmac_f32_32x32x32_bf16 v[32:47], v[144:147], v[8:15], v52
    v_exp_f32 v18, v18
    v_exp_f32 v19, v19
    v_exp_f32 v20, v20
    ds_read_b32 v55, v53 offset:32
    s_waitcnt lgkmcnt(0)
    v_mfma_f32_32x32x16_bf16 v[0:15], v[64:67], v[48:51], 0
    v_exp_f32 v21, v21
    v_exp_f32 v22, v22
    v_exp_f32 v23, v23
    v_exp_f32 v24, v24
    v_exp_f32 v25, v25
    v_smfmac_f32_32x32x32_bf16 v[32:47], v[152:155], v[16:23], v52
    v_exp_f32 v26, v26
    v_exp_f32 v27, v27
    v_exp_f32 v28, v28
    v_exp_f32 v29, v29
    v_exp_f32 v30, v30
    v_exp_f32 v31, v31
    v_exp_f32 v0, v0
    v_exp_f32 v1, v1
    v_smfmac_f32_32x32x32_bf16 v[32:47], v[156:159], v[24:31], v52
    v_exp_f32 v2, v2
    v_exp_f32 v3, v3
    v_exp_f32 v4, v4
    v_readfirstlane_b32 s53, v55
    s_lshl_b32 s38, s53, 28
    v_mfma_f32_32x32x16_bf16 v[16:31], v[76:79], v[48:51], 0
    v_exp_f32 v5, v5
    v_exp_f32 v6, v6
    s_add_u32 s68, s76, 458752
    buffer_load_dwordx4 v[160:163], v56, s[36:39], s68 offen offset:0 sc1
    v_exp_f32 v7, v7
    v_exp_f32 v8, v8
    v_exp_f32 v9, v9
    v_exp_f32 v10, v10
    v_exp_f32 v11, v11
    s_add_u32 s69, s76, 491520
    buffer_load_dwordx4 v[164:167], v53, s[36:39], s69 offen offset:0 sc1
    v_exp_f32 v12, v12
    ds_write_b128 v54, v[32:35] offset:56320
    ds_write_b128 v54, v[36:39] offset:57344
    ds_write_addtid_b32 v40 offset:58368
    v_mov_b64 v[32:33], 0
    v_mov_b64 v[34:35], 0
    v_mov_b64 v[36:37], 0
    v_mov_b64 v[38:39], 0
    v_mov_b32 v40, 0
    v_exp_f32 v13, v13
    v_exp_f32 v14, v14
    v_smfmac_f32_32x32x32_bf16 v[32:47], v[68:71], v[0:7], v52
    v_exp_f32 v15, v15
    v_exp_f32 v16, v16
    v_exp_f32 v17, v17
    v_smfmac_f32_32x32x32_bf16 v[32:47], v[72:75], v[8:15], v52
    v_exp_f32 v18, v18
    v_exp_f32 v19, v19
    v_exp_f32 v20, v20
    v_mfma_f32_32x32x16_bf16 v[0:15], v[88:91], v[48:51], 0
    v_exp_f32 v21, v21
    v_exp_f32 v22, v22
    buffer_load_dwordx4 v[172:175], v56, s[36:39], s68 offen offset:1024 sc1
    v_exp_f32 v23, v23
    v_exp_f32 v24, v24
    v_exp_f32 v25, v25
    v_smfmac_f32_32x32x32_bf16 v[32:47], v[80:83], v[16:23], v52
    v_exp_f32 v26, v26
    v_exp_f32 v27, v27
    v_exp_f32 v28, v28
    v_exp_f32 v29, v29
    v_exp_f32 v30, v30
    buffer_load_dwordx4 v[176:179], v53, s[36:39], s69 offen offset:1024 sc1
    v_exp_f32 v31, v31
    v_exp_f32 v0, v0
    v_exp_f32 v1, v1
    v_smfmac_f32_32x32x32_bf16 v[32:47], v[84:87], v[24:31], v52
    v_exp_f32 v2, v2
    v_exp_f32 v3, v3
    v_exp_f32 v4, v4
    v_mfma_f32_32x32x16_bf16 v[16:31], v[100:103], v[48:51], 0
    v_exp_f32 v5, v5
    v_exp_f32 v6, v6
    buffer_load_dwordx4 v[184:187], v56, s[36:39], s68 offen offset:2048 sc1
    v_exp_f32 v7, v7
    v_exp_f32 v8, v8
    v_exp_f32 v9, v9
    v_smfmac_f32_32x32x32_bf16 v[32:47], v[92:95], v[0:7], v52
    v_exp_f32 v10, v10
    v_exp_f32 v11, v11
    v_exp_f32 v12, v12
    v_exp_f32 v13, v13
    v_exp_f32 v14, v14
    buffer_load_dwordx4 v[188:191], v53, s[36:39], s69 offen offset:2048 sc1
    v_exp_f32 v15, v15
    v_exp_f32 v16, v16
    v_exp_f32 v17, v17
    v_smfmac_f32_32x32x32_bf16 v[32:47], v[96:99], v[8:15], v52
    v_exp_f32 v18, v18
    v_exp_f32 v19, v19
    v_exp_f32 v20, v20
    s_cmp_eq_u32 s38, 0
    s_cbranch_scc1 kst_48
kbk_49:
    v_mfma_f32_32x32x16_bf16 v[0:15], v[112:115], v[48:51], 0
    v_exp_f32 v21, v21
    v_exp_f32 v22, v22
    buffer_load_dwordx4 v[196:199], v56, s[36:39], s68 offen offset:3072 sc1
    v_exp_f32 v23, v23
    v_exp_f32 v24, v24
    v_exp_f32 v25, v25
    v_smfmac_f32_32x32x32_bf16 v[32:47], v[104:107], v[16:23], v52
    v_exp_f32 v26, v26
    v_exp_f32 v27, v27
    v_exp_f32 v28, v28
    v_exp_f32 v29, v29
    v_exp_f32 v30, v30
    buffer_load_dwordx4 v[200:203], v53, s[36:39], s69 offen offset:3072 sc1
    v_exp_f32 v31, v31
    v_exp_f32 v0, v0
    v_exp_f32 v1, v1
    v_smfmac_f32_32x32x32_bf16 v[32:47], v[108:111], v[24:31], v52
    v_exp_f32 v2, v2
    v_exp_f32 v3, v3
    v_exp_f32 v4, v4
    v_mfma_f32_32x32x16_bf16 v[16:31], v[124:127], v[48:51], 0
PAD4:
    s_cbranch_execz PADRET
    v_exp_f32 v5, v5
    v_exp_f32 v6, v6
    s_add_u32 s68, s76, 462848
    buffer_load_dwordx4 v[208:211], v56, s[36:39], s68 offen offset:0 sc1
    v_exp_f32 v7, v7
    v_exp_f32 v8, v8
    v_exp_f32 v9, v9
    v_smfmac_f32_32x32x32_bf16 v[32:47], v[116:119], v[0:7], v52
    v_exp_f32 v10, v10
    v_exp_f32 v11, v11
    v_exp_f32 v12, v12
    v_exp_f32 v13, v13
    v_exp_f32 v14, v14
    s_add_u32 s69, s76, 495616
    buffer_load_dwordx4 v[212:215], v53, s[36:39], s69 offen offset:0 sc1
    v_exp_f32 v15, v15
    v_exp_f32 v16, v16
    v_exp_f32 v17, v17
    v_smfmac_f32_32x32x32_bf16 v[32:47], v[120:123], v[8:15], v52
    v_exp_f32 v18, v18
    v_exp_f32 v19, v19
    v_exp_f32 v20, v20
    v_mfma_f32_32x32x16_bf16 v[0:15], v[136:139], v[48:51], 0
    v_exp_f32 v21, v21
    v_exp_f32 v22, v22
    buffer_load_dwordx4 v[220:223], v56, s[36:39], s68 offen offset:1024 sc1
    v_exp_f32 v23, v23
    v_exp_f32 v24, v24
    v_exp_f32 v25, v25
    v_smfmac_f32_32x32x32_bf16 v[32:47], v[128:131], v[16:23], v52
    v_exp_f32 v26, v26
    v_exp_f32 v27, v27
    v_exp_f32 v28, v28
    v_exp_f32 v29, v29
    v_exp_f32 v30, v30
    buffer_load_dwordx4 v[224:227], v53, s[36:39], s69 offen offset:1024 sc1
    v_exp_f32 v31, v31
    v_exp_f32 v0, v0
    v_exp_f32 v1, v1
    v_smfmac_f32_32x32x32_bf16 v[32:47], v[132:135], v[24:31], v52
    v_exp_f32 v2, v2
    v_exp_f32 v3, v3
    v_exp_f32 v4, v4
    v_mfma_f32_32x32x16_bf16 v[16:31], v[148:151], v[48:51], 0
    v_exp_f32 v5, v5
    v_exp_f32 v6, v6
    buffer_load_dwordx4 v[232:235], v56, s[36:39], s68 offen offset:2048 sc1
    v_exp_f32 v7, v7
    v_exp_f32 v8, v8
    v_exp_f32 v9, v9
    v_smfmac_f32_32x32x32_bf16 v[32:47], v[140:143], v[0:7], v52
    v_exp_f32 v10, v10
    v_exp_f32 v11, v11
    v_exp_f32 v12, v12
    v_exp_f32 v13, v13
    v_exp_f32 v14, v14
    buffer_load_dwordx4 v[236:239], v53, s[36:39], s69 offen offset:2048 sc1
    v_exp_f32 v15, v15
    v_exp_f32 v16, v16
    v_exp_f32 v17, v17
    v_smfmac_f32_32x32x32_bf16 v[32:47], v[144:147], v[8:15], v52
    v_exp_f32 v18, v18
    v_exp_f32 v19, v19
    v_exp_f32 v20, v20
    s_cmp_eq_u32 s38, 0
    s_cbranch_scc1 kst_50
kbk_51:
    s_waitcnt vmcnt(6)
ck_52:
    v_max_u32 v55, v160, v164
    v_max3_u32 v55, v55, v166, v172
    v_max3_u32 v55, v55, v176, v178
    v_max3_u32 v55, v55, v184, v188
    v_max3_u32 v55, v55, v190, v196
    v_max3_u32 v55, v55, v200, v202
    v_cmp_eq_u32 vcc, -1, v55
    s_cbranch_vccnz ckrt_54
ckok_53:
    v_permlane16_swap_b32 v164, v168
    v_permlane16_swap_b32 v165, v169
    v_permlane16_swap_b32 v166, v170
    v_permlane16_swap_b32 v167, v171
    v_permlane16_swap_b32 v176, v180
    v_permlane16_swap_b32 v177, v181
    v_permlane16_swap_b32 v178, v182
    v_permlane16_swap_b32 v179, v183
    v_permlane16_swap_b32 v188, v192
    v_permlane16_swap_b32 v189, v193
    v_permlane16_swap_b32 v190, v194
    v_permlane16_swap_b32 v191, v195
    v_permlane16_swap_b32 v200, v204
    v_permlane16_swap_b32 v201, v205
    v_permlane16_swap_b32 v202, v206
    v_permlane16_swap_b32 v203, v207
    v_mfma_f32_32x32x16_bf16 v[0:15], v[160:163], v[48:51], 0
    v_exp_f32 v21, v21
    v_exp_f32 v22, v22
    buffer_load_dwordx4 v[244:247], v56, s[36:39], s68 offen offset:3072 sc1
    v_exp_f32 v23, v23
    v_exp_f32 v24, v24
    v_exp_f32 v25, v25
    v_smfmac_f32_32x32x32_bf16 v[32:47], v[152:155], v[16:23], v52
    v_exp_f32 v26, v26
    v_exp_f32 v27, v27
    v_exp_f32 v28, v28
    v_exp_f32 v29, v29
    v_exp_f32 v30, v30
    buffer_load_dwordx4 v[248:251], v53, s[36:39], s69 offen offset:3072 sc1
    v_exp_f32 v31, v31
    v_exp_f32 v0, v0
    v_exp_f32 v1, v1
    v_smfmac_f32_32x32x32_bf16 v[32:47], v[156:159], v[24:31], v52
    v_exp_f32 v2, v2
    v_exp_f32 v3, v3
    v_exp_f32 v4, v4
    v_mfma_f32_32x32x16_bf16 v[16:31], v[172:175], v[48:51], 0
    v_exp_f32 v5, v5
    v_exp_f32 v6, v6
    v_exp_f32 v7, v7
    v_exp_f32 v8, v8
    v_exp_f32 v9, v9
    v_smfmac_f32_32x32x32_bf16 v[32:47], v[164:167], v[0:7], v52
    v_exp_f32 v10, v10
    v_exp_f32 v11, v11
    v_exp_f32 v12, v12
    v_exp_f32 v13, v13
    v_exp_f32 v14, v14
    v_exp_f32 v15, v15
    v_exp_f32 v16, v16
    v_exp_f32 v17, v17
    v_smfmac_f32_32x32x32_bf16 v[32:47], v[168:171], v[8:15], v52
    v_exp_f32 v18, v18
    v_exp_f32 v19, v19
    v_exp_f32 v20, v20
    v_mfma_f32_32x32x16_bf16 v[0:15], v[184:187], v[48:51], 0
    v_exp_f32 v21, v21
    v_exp_f32 v22, v22
    v_exp_f32 v23, v23
    v_exp_f32 v24, v24
    v_exp_f32 v25, v25
    v_smfmac_f32_32x32x32_bf16 v[32:47], v[176:179], v[16:23], v52
    v_exp_f32 v26, v26
    v_exp_f32 v27, v27
    v_exp_f32 v28, v28
    v_exp_f32 v29, v29
    v_exp_f32 v30, v30
    v_exp_f32 v31, v31
    v_exp_f32 v0, v0
    v_exp_f32 v1, v1
    v_smfmac_f32_32x32x32_bf16 v[32:47], v[180:183], v[24:31], v52
    v_exp_f32 v2, v2
    v_exp_f32 v3, v3
    v_exp_f32 v4, v4
    v_mfma_f32_32x32x16_bf16 v[16:31], v[196:199], v[48:51], 0
    v_exp_f32 v5, v5
    v_exp_f32 v6, v6
    v_exp_f32 v7, v7
    v_exp_f32 v8, v8
    v_exp_f32 v9, v9
    v_smfmac_f32_32x32x32_bf16 v[32:47], v[188:191], v[0:7], v52
    v_exp_f32 v10, v10
    v_exp_f32 v11, v11
    v_exp_f32 v12, v12
    v_exp_f32 v13, v13
    v_exp_f32 v14, v14
    v_exp_f32 v15, v15
    v_exp_f32 v16, v16
    v_exp_f32 v17, v17
    v_smfmac_f32_32x32x32_bf16 v[32:47], v[192:195], v[8:15], v52
    v_exp_f32 v18, v18
    v_exp_f32 v19, v19
    v_exp_f32 v20, v20
    s_waitcnt vmcnt(0)
ck_55:
    v_max_u32 v55, v208, v212
    v_max3_u32 v55, v55, v214, v220
    v_max3_u32 v55, v55, v224, v226
    v_max3_u32 v55, v55, v232, v236
    v_max3_u32 v55, v55, v238, v244
    v_max3_u32 v55, v55, v248, v250
    v_cmp_eq_u32 vcc, -1, v55
    s_cbranch_vccnz ckrt_57
ckok_56:
    v_permlane16_swap_b32 v212, v216
    v_permlane16_swap_b32 v213, v217
    v_permlane16_swap_b32 v214, v218
    v_permlane16_swap_b32 v215, v219
    v_permlane16_swap_b32 v224, v228
    v_permlane16_swap_b32 v225, v229
    v_permlane16_swap_b32 v226, v230
    v_permlane16_swap_b32 v227, v231
    v_permlane16_swap_b32 v236, v240
    v_permlane16_swap_b32 v237, v241
    v_permlane16_swap_b32 v238, v242
    v_permlane16_swap_b32 v239, v243
    v_permlane16_swap_b32 v248, v252
    v_permlane16_swap_b32 v249, v253
    v_permlane16_swap_b32 v250, v254
    v_permlane16_swap_b32 v251, v255
    v_mfma_f32_32x32x16_bf16 v[0:15], v[208:211], v[48:51], 0
    v_exp_f32 v21, v21
    v_exp_f32 v22, v22
    v_exp_f32 v23, v23
    v_exp_f32 v24, v24
    v_exp_f32 v25, v25
    v_smfmac_f32_32x32x32_bf16 v[32:47], v[200:203], v[16:23], v52
    v_exp_f32 v26, v26
    v_exp_f32 v27, v27
    v_exp_f32 v28, v28
    v_exp_f32 v29, v29
    v_exp_f32 v30, v30
    v_exp_f32 v31, v31
    v_exp_f32 v0, v0
    v_exp_f32 v1, v1
    v_smfmac_f32_32x32x32_bf16 v[32:47], v[204:207], v[24:31], v52
    v_exp_f32 v2, v2
    v_exp_f32 v3, v3
    v_exp_f32 v4, v4
    v_mfma_f32_32x32x16_bf16 v[16:31], v[220:223], v[48:51], 0
    v_exp_f32 v5, v5
    v_exp_f32 v6, v6
    v_exp_f32 v7, v7
    v_exp_f32 v8, v8
    v_exp_f32 v9, v9
    v_smfmac_f32_32x32x32_bf16 v[32:47], v[212:215], v[0:7], v52
    v_exp_f32 v10, v10
    v_exp_f32 v11, v11
    v_exp_f32 v12, v12
    v_exp_f32 v13, v13
    v_exp_f32 v14, v14
    v_exp_f32 v15, v15
    v_exp_f32 v16, v16
    v_exp_f32 v17, v17
    v_smfmac_f32_32x32x32_bf16 v[32:47], v[216:219], v[8:15], v52
    v_exp_f32 v18, v18
    v_exp_f32 v19, v19
    v_exp_f32 v20, v20
    v_mfma_f32_32x32x16_bf16 v[0:15], v[232:235], v[48:51], 0
    v_exp_f32 v21, v21
    v_exp_f32 v22, v22
    v_exp_f32 v23, v23
    v_exp_f32 v24, v24
    v_exp_f32 v25, v25
    v_smfmac_f32_32x32x32_bf16 v[32:47], v[224:227], v[16:23], v52
    v_exp_f32 v26, v26
    v_exp_f32 v27, v27
    v_exp_f32 v28, v28
    v_exp_f32 v29, v29
    v_exp_f32 v30, v30
    v_exp_f32 v31, v31
    v_exp_f32 v0, v0
    v_exp_f32 v1, v1
    v_smfmac_f32_32x32x32_bf16 v[32:47], v[228:231], v[24:31], v52
    v_exp_f32 v2, v2
    v_exp_f32 v3, v3
    v_exp_f32 v4, v4
    v_mfma_f32_32x32x16_bf16 v[16:31], v[244:247], v[48:51], 0
    ds_read_b128 v[48:51], v53 offset:4608
    v_exp_f32 v5, v5
    v_exp_f32 v6, v6
    v_exp_f32 v7, v7
    v_exp_f32 v8, v8
    v_exp_f32 v9, v9
    v_smfmac_f32_32x32x32_bf16 v[32:47], v[236:239], v[0:7], v52
    v_exp_f32 v10, v10
    v_exp_f32 v11, v11
    v_exp_f32 v12, v12
    v_exp_f32 v13, v13
    v_exp_f32 v14, v14
    v_exp_f32 v15, v15
    v_exp_f32 v16, v16
    v_exp_f32 v17, v17
    v_smfmac_f32_32x32x32_bf16 v[32:47], v[240:243], v[8:15], v52
    v_exp_f32 v18, v18
    v_exp_f32 v19, v19
    v_exp_f32 v20, v20
    s_waitcnt lgkmcnt(0)
    v_mfma_f32_32x32x16_bf16 v[0:15], v[160:163], v[48:51], 0
    v_exp_f32 v21, v21
    v_exp_f32 v22, v22
    v_exp_f32 v23, v23
    v_exp_f32 v24, v24
    v_exp_f32 v25, v25
    v_smfmac_f32_32x32x32_bf16 v[32:47], v[248:251], v[16:23], v52
    v_exp_f32 v26, v26
    v_exp_f32 v27, v27
    v_exp_f32 v28, v28
    v_exp_f32 v29, v29
    v_exp_f32 v30, v30
    v_exp_f32 v31, v31
    v_exp_f32 v0, v0
    v_exp_f32 v1, v1
    v_smfmac_f32_32x32x32_bf16 v[32:47], v[252:255], v[24:31], v52
    v_exp_f32 v2, v2
    v_exp_f32 v3, v3
    v_exp_f32 v4, v4
    v_mfma_f32_32x32x16_bf16 v[16:31], v[172:175], v[48:51], 0
    v_exp_f32 v5, v5
    v_exp_f32 v6, v6
    v_exp_f32 v7, v7
    v_exp_f32 v8, v8
    v_exp_f32 v9, v9
    v_exp_f32 v10, v10
    v_exp_f32 v11, v11
    v_exp_f32 v12, v12
    ds_write_b128 v54, v[32:35] offset:28672
    ds_write_b128 v54, v[36:39] offset:29696
    ds_write_addtid_b32 v40 offset:30720
    ds_add_u32 v57, v52 offset:64
    ds_read_b128 v[32:35], v54 offset:37888
    ds_read_b128 v[36:39], v54 offset:38912
    ds_read_addtid_b32 v40 offset:39936
    v_exp_f32 v13, v13
    v_exp_f32 v14, v14
    v_exp_f32 v15, v15
    s_waitcnt lgkmcnt(0)
    s_nop 0
    v_smfmac_f32_32x32x32_bf16 v[32:47], v[164:167], v[0:7], v52
    v_exp_f32 v16, v16
    v_exp_f32 v17, v17
    v_exp_f32 v18, v18
    v_smfmac_f32_32x32x32_bf16 v[32:47], v[168:171], v[8:15], v52
    v_exp_f32 v19, v19
    v_exp_f32 v20, v20
    v_mfma_f32_32x32x16_bf16 v[0:15], v[184:187], v[48:51], 0
    v_exp_f32 v21, v21
    v_exp_f32 v22, v22
    v_exp_f32 v23, v23
    v_exp_f32 v24, v24
    v_exp_f32 v25, v25
    v_smfmac_f32_32x32x32_bf16 v[32:47], v[176:179], v[16:23], v52
    v_exp_f32 v26, v26
    v_exp_f32 v27, v27
    v_exp_f32 v28, v28
    v_exp_f32 v29, v29
    v_exp_f32 v30, v30
    v_exp_f32 v31, v31
    v_exp_f32 v0, v0
    v_exp_f32 v1, v1
    v_smfmac_f32_32x32x32_bf16 v[32:47], v[180:183], v[24:31], v52
    v_exp_f32 v2, v2
    v_exp_f32 v3, v3
    v_exp_f32 v4, v4
    v_mfma_f32_32x32x16_bf16 v[16:31], v[196:199], v[48:51], 0
    v_exp_f32 v5, v5
    v_exp_f32 v6, v6
    v_exp_f32 v7, v7
    v_exp_f32 v8, v8
    v_exp_f32 v9, v9
    v_smfmac_f32_32x32x32_bf16 v[32:47], v[188:191], v[0:7], v52
    v_exp_f32 v10, v10
    v_exp_f32 v11, v11
    v_exp_f32 v12, v12
    v_exp_f32 v13, v13
    v_exp_f32 v14, v14
    v_exp_f32 v15, v15
    v_exp_f32 v16, v16
    v_exp_f32 v17, v17
    v_smfmac_f32_32x32x32_bf16 v[32:47], v[192:195], v[8:15], v52
    v_exp_f32 v18, v18
    v_exp_f32 v19, v19
    v_exp_f32 v20, v20
    v_mfma_f32_32x32x16_bf16 v[0:15], v[208:211], v[48:51], 0
    v_exp_f32 v21, v21
    v_exp_f32 v22, v22
    v_exp_f32 v23, v23
    v_exp_f32 v24, v24
    v_exp_f32 v25, v25
    v_smfmac_f32_32x32x32_bf16 v[32:47], v[200:203], v[16:23], v52
    v_exp_f32 v26, v26
    v_exp_f32 v27, v27
    v_exp_f32 v28, v28
    v_exp_f32 v29, v29
    v_exp_f32 v30, v30
    v_exp_f32 v31, v31
    v_exp_f32 v0, v0
    v_exp_f32 v1, v1
    v_smfmac_f32_32x32x32_bf16 v[32:47], v[204:207], v[24:31], v52
    v_exp_f32 v2, v2
    v_exp_f32 v3, v3
    v_exp_f32 v4, v4
    v_mfma_f32_32x32x16_bf16 v[16:31], v[220:223], v[48:51], 0
    v_exp_f32 v5, v5
    v_exp_f32 v6, v6
    v_exp_f32 v7, v7
    v_exp_f32 v8, v8
    v_exp_f32 v9, v9
    v_smfmac_f32_32x32x32_bf16 v[32:47], v[212:215], v[0:7], v52
    v_exp_f32 v10, v10
    v_exp_f32 v11, v11
    v_exp_f32 v12, v12
    v_exp_f32 v13, v13
    v_exp_f32 v14, v14
    v_exp_f32 v15, v15
    v_exp_f32 v16, v16
    v_exp_f32 v17, v17
    v_smfmac_f32_32x32x32_bf16 v[32:47], v[216:219], v[8:15], v52
    v_exp_f32 v18, v18
    v_exp_f32 v19, v19
    v_exp_f32 v20, v20
    v_mfma_f32_32x32x16_bf16 v[0:15], v[232:235], v[48:51], 0
    v_exp_f32 v21, v21
    v_exp_f32 v22, v22
    v_exp_f32 v23, v23
    v_exp_f32 v24, v24
    v_exp_f32 v25, v25
    v_smfmac_f32_32x32x32_bf16 v[32:47], v[224:227], v[16:23], v52
    v_exp_f32 v26, v26
    v_exp_f32 v27, v27
    v_exp_f32 v28, v28
    v_exp_f32 v29, v29
    v_exp_f32 v30, v30
    v_exp_f32 v31, v31
    v_exp_f32 v0, v0
    v_exp_f32 v1, v1
    v_smfmac_f32_32x32x32_bf16 v[32:47], v[228:231], v[24:31], v52
    v_exp_f32 v2, v2
    v_exp_f32 v3, v3
    v_exp_f32 v4, v4
    v_mfma_f32_32x32x16_bf16 v[16:31], v[244:247], v[48:51], 0
    ds_read_b128 v[48:51], v53 offset:5632
    v_exp_f32 v5, v5
    v_exp_f32 v6, v6
    v_exp_f32 v7, v7
    v_exp_f32 v8, v8
    v_exp_f32 v9, v9
    v_smfmac_f32_32x32x32_bf16 v[32:47], v[236:239], v[0:7], v52
    v_exp_f32 v10, v10
    v_exp_f32 v11, v11
    v_exp_f32 v12, v12
    v_exp_f32 v13, v13
    v_exp_f32 v14, v14
    v_exp_f32 v15, v15
    v_exp_f32 v16, v16
    v_exp_f32 v17, v17
    v_smfmac_f32_32x32x32_bf16 v[32:47], v[240:243], v[8:15], v52
    v_exp_f32 v18, v18
    v_exp_f32 v19, v19
    v_exp_f32 v20, v20
    s_waitcnt lgkmcnt(0)
    v_mfma_f32_32x32x16_bf16 v[0:15], v[160:163], v[48:51], 0
    v_exp_f32 v21, v21
    v_exp_f32 v22, v22
    v_exp_f32 v23, v23
    v_exp_f32 v24, v24
    v_exp_f32 v25, v25
    v_smfmac_f32_32x32x32_bf16 v[32:47], v[248:251], v[16:23], v52
    v_exp_f32 v26, v26
    v_exp_f32 v27, v27
    v_exp_f32 v28, v28
    v_exp_f32 v29, v29
    v_exp_f32 v30, v30
    v_exp_f32 v31, v31
    v_exp_f32 v0, v0
    v_exp_f32 v1, v1
    v_smfmac_f32_32x32x32_bf16 v[32:47], v[252:255], v[24:31], v52
    v_exp_f32 v2, v2
    v_exp_f32 v3, v3
    v_exp_f32 v4, v4
    v_mfma_f32_32x32x16_bf16 v[16:31], v[172:175], v[48:51], 0
    v_exp_f32 v5, v5
    v_exp_f32 v6, v6
    v_exp_f32 v7, v7
    v_exp_f32 v8, v8
    v_exp_f32 v9, v9
    v_exp_f32 v10, v10
    v_exp_f32 v11, v11
    v_exp_f32 v12, v12
    ds_write_b128 v54, v[32:35] offset:37888
    ds_write_b128 v54, v[36:39] offset:38912
    ds_write_addtid_b32 v40 offset:39936
    ds_add_u32 v57, v52 offset:64
    ds_read_b128 v[32:35], v54 offset:47104
    ds_read_b128 v[36:39], v54 offset:48128
    ds_read_addtid_b32 v40 offset:49152
    v_exp_f32 v13, v13
    v_exp_f32 v14, v14
    v_exp_f32 v15, v15
    s_waitcnt lgkmcnt(0)
    s_nop 0
    v_smfmac_f32_32x32x32_bf16 v[32:47], v[164:167], v[0:7], v52
    v_exp_f32 v16, v16
    v_exp_f32 v17, v17
    v_exp_f32 v18, v18
    v_smfmac_f32_32x32x32_bf16 v[32:47], v[168:171], v[8:15], v52
    v_exp_f32 v19, v19
    v_exp_f32 v20, v20
    v_mfma_f32_32x32x16_bf16 v[0:15], v[184:187], v[48:51], 0
    v_exp_f32 v21, v21
    v_exp_f32 v22, v22
    v_exp_f32 v23, v23
    v_exp_f32 v24, v24
    v_exp_f32 v25, v25
    v_smfmac_f32_32x32x32_bf16 v[32:47], v[176:179], v[16:23], v52
    v_exp_f32 v26, v26
    v_exp_f32 v27, v27
    v_exp_f32 v28, v28
    v_exp_f32 v29, v29
    v_exp_f32 v30, v30
    v_exp_f32 v31, v31
    v_exp_f32 v0, v0
    v_exp_f32 v1, v1
    v_smfmac_f32_32x32x32_bf16 v[32:47], v[180:183], v[24:31], v52
    v_exp_f32 v2, v2
    v_exp_f32 v3, v3
    v_exp_f32 v4, v4
    v_mfma_f32_32x32x16_bf16 v[16:31], v[196:199], v[48:51], 0
    v_exp_f32 v5, v5
    v_exp_f32 v6, v6
    v_exp_f32 v7, v7
    v_exp_f32 v8, v8
    v_exp_f32 v9, v9
    v_smfmac_f32_32x32x32_bf16 v[32:47], v[188:191], v[0:7], v52
    v_exp_f32 v10, v10
    v_exp_f32 v11, v11
    v_exp_f32 v12, v12
    v_exp_f32 v13, v13
    v_exp_f32 v14, v14
    v_exp_f32 v15, v15
    v_exp_f32 v16, v16
    v_exp_f32 v17, v17
    v_smfmac_f32_32x32x32_bf16 v[32:47], v[192:195], v[8:15], v52
    v_exp_f32 v18, v18
    v_exp_f32 v19, v19
    v_exp_f32 v20, v20
    v_mfma_f32_32x32x16_bf16 v[0:15], v[208:211], v[48:51], 0
    v_exp_f32 v21, v21
    v_exp_f32 v22, v22
    v_exp_f32 v23, v23
    v_exp_f32 v24, v24
    v_exp_f32 v25, v25
    v_smfmac_f32_32x32x32_bf16 v[32:47], v[200:203], v[16:23], v52
    v_exp_f32 v26, v26
    v_exp_f32 v27, v27
    v_exp_f32 v28, v28
    v_exp_f32 v29, v29
    v_exp_f32 v30, v30
    v_exp_f32 v31, v31
    v_exp_f32 v0, v0
    v_exp_f32 v1, v1
    v_smfmac_f32_32x32x32_bf16 v[32:47], v[204:207], v[24:31], v52
    v_exp_f32 v2, v2
    v_exp_f32 v3, v3
    v_exp_f32 v4, v4
    v_mfma_f32_32x32x16_bf16 v[16:31], v[220:223], v[48:51], 0
    v_exp_f32 v5, v5
    v_exp_f32 v6, v6
    v_exp_f32 v7, v7
    v_exp_f32 v8, v8
    v_exp_f32 v9, v9
    v_smfmac_f32_32x32x32_bf16 v[32:47], v[212:215], v[0:7], v52
    v_exp_f32 v10, v10
    v_exp_f32 v11, v11
    v_exp_f32 v12, v12
    v_exp_f32 v13, v13
    v_exp_f32 v14, v14
    v_exp_f32 v15, v15
    v_exp_f32 v16, v16
    v_exp_f32 v17, v17
    v_smfmac_f32_32x32x32_bf16 v[32:47], v[216:219], v[8:15], v52
    v_exp_f32 v18, v18
    v_exp_f32 v19, v19
    v_exp_f32 v20, v20
    v_mfma_f32_32x32x16_bf16 v[0:15], v[232:235], v[48:51], 0
    v_exp_f32 v21, v21
    v_exp_f32 v22, v22
    v_exp_f32 v23, v23
    v_exp_f32 v24, v24
    v_exp_f32 v25, v25
    v_smfmac_f32_32x32x32_bf16 v[32:47], v[224:227], v[16:23], v52
    v_exp_f32 v26, v26
    v_exp_f32 v27, v27
    v_exp_f32 v28, v28
    v_exp_f32 v29, v29
    v_exp_f32 v30, v30
    v_exp_f32 v31, v31
    v_exp_f32 v0, v0
    v_exp_f32 v1, v1
    v_smfmac_f32_32x32x32_bf16 v[32:47], v[228:231], v[24:31], v52
    v_exp_f32 v2, v2
    v_exp_f32 v3, v3
    v_exp_f32 v4, v4
    v_mfma_f32_32x32x16_bf16 v[16:31], v[244:247], v[48:51], 0
    ds_read_b128 v[48:51], v53 offset:6656
    v_exp_f32 v5, v5
    v_exp_f32 v6, v6
    v_exp_f32 v7, v7
    v_exp_f32 v8, v8
    v_exp_f32 v9, v9
    v_smfmac_f32_32x32x32_bf16 v[32:47], v[236:239], v[0:7], v52
    v_exp_f32 v10, v10
    v_exp_f32 v11, v11
    v_exp_f32 v12, v12
    v_exp_f32 v13, v13
    v_exp_f32 v14, v14
    v_exp_f32 v15, v15
    v_exp_f32 v16, v16
    v_exp_f32 v17, v17
    v_smfmac_f32_32x32x32_bf16 v[32:47], v[240:243], v[8:15], v52
    v_exp_f32 v18, v18
    v_exp_f32 v19, v19
    v_exp_f32 v20, v20
    s_waitcnt lgkmcnt(0)
    v_mfma_f32_32x32x16_bf16 v[0:15], v[160:163], v[48:51], 0
    v_exp_f32 v21, v21
    v_exp_f32 v22, v22
    v_exp_f32 v23, v23
    v_exp_f32 v24, v24
    v_exp_f32 v25, v25
    v_smfmac_f32_32x32x32_bf16 v[32:47], v[248:251], v[16:23], v52
    v_exp_f32 v26, v26
    v_exp_f32 v27, v27
    v_exp_f32 v28, v28
    v_exp_f32 v29, v29
    v_exp_f32 v30, v30
    v_exp_f32 v31, v31
    v_exp_f32 v0, v0
    v_exp_f32 v1, v1
    v_smfmac_f32_32x32x32_bf16 v[32:47], v[252:255], v[24:31], v52
    v_exp_f32 v2, v2
    v_exp_f32 v3, v3
    v_exp_f32 v4, v4
    v_mfma_f32_32x32x16_bf16 v[16:31], v[172:175], v[48:51], 0
    v_exp_f32 v5, v5
    v_exp_f32 v6, v6
    v_exp_f32 v7, v7
    v_exp_f32 v8, v8
    v_exp_f32 v9, v9
    v_exp_f32 v10, v10
    v_exp_f32 v11, v11
    v_exp_f32 v12, v12
    ds_write_b128 v54, v[32:35] offset:47104
    ds_write_b128 v54, v[36:39] offset:48128
    ds_write_addtid_b32 v40 offset:49152
    ds_add_u32 v57, v52 offset:64
    ds_read_b128 v[32:35], v54 offset:56320
    ds_read_b128 v[36:39], v54 offset:57344
    ds_read_addtid_b32 v40 offset:58368
    v_exp_f32 v13, v13
    v_exp_f32 v14, v14
    v_exp_f32 v15, v15
    s_waitcnt lgkmcnt(0)
    s_nop 0
    v_smfmac_f32_32x32x32_bf16 v[32:47], v[164:167], v[0:7], v52
    v_exp_f32 v16, v16
    v_exp_f32 v17, v17
    v_exp_f32 v18, v18
    v_smfmac_f32_32x32x32_bf16 v[32:47], v[168:171], v[8:15], v52
    v_exp_f32 v19, v19
    v_exp_f32 v20, v20
    v_mfma_f32_32x32x16_bf16 v[0:15], v[184:187], v[48:51], 0
    v_exp_f32 v21, v21
    v_exp_f32 v22, v22
    v_exp_f32 v23, v23
    v_exp_f32 v24, v24
    v_exp_f32 v25, v25
    v_smfmac_f32_32x32x32_bf16 v[32:47], v[176:179], v[16:23], v52
    v_exp_f32 v26, v26
    v_exp_f32 v27, v27
    v_exp_f32 v28, v28
    v_exp_f32 v29, v29
    v_exp_f32 v30, v30
    v_exp_f32 v31, v31
    v_exp_f32 v0, v0
    v_exp_f32 v1, v1
    v_smfmac_f32_32x32x32_bf16 v[32:47], v[180:183], v[24:31], v52
    v_exp_f32 v2, v2
    v_exp_f32 v3, v3
    v_exp_f32 v4, v4
    v_mfma_f32_32x32x16_bf16 v[16:31], v[196:199], v[48:51], 0
    v_exp_f32 v5, v5
    v_exp_f32 v6, v6
    v_exp_f32 v7, v7
    v_exp_f32 v8, v8
    v_exp_f32 v9, v9
    v_smfmac_f32_32x32x32_bf16 v[32:47], v[188:191], v[0:7], v52
    v_exp_f32 v10, v10
    v_exp_f32 v11, v11
    v_exp_f32 v12, v12
    v_exp_f32 v13, v13
    v_exp_f32 v14, v14
    v_exp_f32 v15, v15
    v_exp_f32 v16, v16
    v_exp_f32 v17, v17
    v_smfmac_f32_32x32x32_bf16 v[32:47], v[192:195], v[8:15], v52
    v_exp_f32 v18, v18
    v_exp_f32 v19, v19
    v_exp_f32 v20, v20
    v_mfma_f32_32x32x16_bf16 v[0:15], v[208:211], v[48:51], 0
    v_exp_f32 v21, v21
    v_exp_f32 v22, v22
    v_exp_f32 v23, v23
    v_exp_f32 v24, v24
    v_exp_f32 v25, v25
    v_smfmac_f32_32x32x32_bf16 v[32:47], v[200:203], v[16:23], v52
    v_exp_f32 v26, v26
    v_exp_f32 v27, v27
    v_exp_f32 v28, v28
    v_exp_f32 v29, v29
    v_exp_f32 v30, v30
    v_exp_f32 v31, v31
    v_exp_f32 v0, v0
    v_exp_f32 v1, v1
    v_smfmac_f32_32x32x32_bf16 v[32:47], v[204:207], v[24:31], v52
    v_exp_f32 v2, v2
    v_exp_f32 v3, v3
    v_exp_f32 v4, v4
    v_mfma_f32_32x32x16_bf16 v[16:31], v[220:223], v[48:51], 0
    v_exp_f32 v5, v5
    v_exp_f32 v6, v6
    v_exp_f32 v7, v7
    v_exp_f32 v8, v8
    v_exp_f32 v9, v9
    v_smfmac_f32_32x32x32_bf16 v[32:47], v[212:215], v[0:7], v52
    v_exp_f32 v10, v10
    v_exp_f32 v11, v11
    v_exp_f32 v12, v12
    v_exp_f32 v13, v13
    v_exp_f32 v14, v14
    v_exp_f32 v15, v15
    v_exp_f32 v16, v16
    v_exp_f32 v17, v17
    v_smfmac_f32_32x32x32_bf16 v[32:47], v[216:219], v[8:15], v52
    v_exp_f32 v18, v18
    v_exp_f32 v19, v19
    v_exp_f32 v20, v20
    v_mfma_f32_32x32x16_bf16 v[0:15], v[232:235], v[48:51], 0
    ds_read_b32 v55, v53 offset:16
    v_exp_f32 v21, v21
    v_exp_f32 v22, v22
    v_exp_f32 v23, v23
    v_exp_f32 v24, v24
    v_exp_f32 v25, v25
    v_smfmac_f32_32x32x32_bf16 v[32:47], v[224:227], v[16:23], v52
    v_exp_f32 v26, v26
    v_exp_f32 v27, v27
    v_exp_f32 v28, v28
    v_exp_f32 v29, v29
    v_exp_f32 v30, v30
    v_exp_f32 v31, v31
    v_exp_f32 v0, v0
    v_exp_f32 v1, v1
    v_smfmac_f32_32x32x32_bf16 v[32:47], v[228:231], v[24:31], v52
    v_exp_f32 v2, v2
    v_exp_f32 v3, v3
    v_exp_f32 v4, v4
    v_mfma_f32_32x32x16_bf16 v[16:31], v[244:247], v[48:51], 0
    s_waitcnt lgkmcnt(0)
    v_readfirstlane_b32 s53, v55
    s_cmp_ge_u32 s53, EV_Q12
    s_cbranch_scc0 gst_58
gbk_59:
    ds_read_b128 v[48:51], v53 offset:7680
    v_exp_f32 v5, v5
    v_exp_f32 v6, v6
    v_exp_f32 v7, v7
    v_exp_f32 v8, v8
    v_exp_f32 v9, v9
    v_smfmac_f32_32x32x32_bf16 v[32:47], v[236:239], v[0:7], v52
    v_exp_f32 v10, v10
    v_exp_f32 v11, v11
    v_exp_f32 v12, v12
    v_exp_f32 v13, v13
    v_exp_f32 v14, v14
    v_exp_f32 v15, v15
    v_exp_f32 v16, v16
    v_exp_f32 v17, v17
    v_smfmac_f32_32x32x32_bf16 v[32:47], v[240:243], v[8:15], v52
    v_exp_f32 v18, v18
    v_exp_f32 v19, v19
    v_exp_f32 v20, v20
    s_waitcnt lgkmcnt(0)
    v_mfma_f32_32x32x16_bf16 v[0:15], v[64:67], v[48:51], 0
    v_exp_f32 v21, v21
    v_exp_f32 v22, v22
    v_exp_f32 v23, v23
    v_exp_f32 v24, v24
    v_exp_f32 v25, v25
    v_smfmac_f32_32x32x32_bf16 v[32:47], v[248:251], v[16:23], v52
    v_exp_f32 v26, v26
    v_exp_f32 v27, v27
    v_exp_f32 v28, v28
    v_exp_f32 v29, v29
    v_exp_f32 v30, v30
    v_exp_f32 v31, v31
    v_exp_f32 v0, v0
    v_exp_f32 v1, v1
    v_smfmac_f32_32x32x32_bf16 v[32:47], v[252:255], v[24:31], v52
    v_exp_f32 v2, v2
    v_exp_f32 v3, v3
    v_exp_f32 v4, v4
    v_mfma_f32_32x32x16_bf16 v[16:31], v[76:79], v[48:51], 0
    v_exp_f32 v5, v5
    v_exp_f32 v6, v6
    v_exp_f32 v7, v7
    v_exp_f32 v8, v8
    v_exp_f32 v9, v9
    v_exp_f32 v10, v10
    v_exp_f32 v11, v11
    v_exp_f32 v12, v12
    ds_write_b128 v54, v[32:35] offset:56320
    ds_write_b128 v54, v[36:39] offset:57344
    ds_write_addtid_b32 v40 offset:58368
    ds_add_u32 v57, v52 offset:64
    v_mov_b64 v[32:33], 0
    v_mov_b64 v[34:35], 0
    v_mov_b64 v[36:37], 0
    v_mov_b64 v[38:39], 0
    v_mov_b32 v40, 0
    v_exp_f32 v13, v13
    v_exp_f32 v14, v14
    v_smfmac_f32_32x32x32_bf16 v[32:47], v[68:71], v[0:7], v52
    v_exp_f32 v15, v15
    v_exp_f32 v16, v16
    v_exp_f32 v17, v17
    v_smfmac_f32_32x32x32_bf16 v[32:47], v[72:75], v[8:15], v52
    v_exp_f32 v18, v18
    v_exp_f32 v19, v19
    v_exp_f32 v20, v20
    v_mfma_f32_32x32x16_bf16 v[0:15], v[88:91], v[48:51], 0
    v_exp_f32 v21, v21
    v_exp_f32 v22, v22
    v_exp_f32 v23, v23
    v_exp_f32 v24, v24
    v_exp_f32 v25, v25
    v_smfmac_f32_32x32x32_bf16 v[32:47], v[80:83], v[16:23], v52
    v_exp_f32 v26, v26
    v_exp_f32 v27, v27
    v_exp_f32 v28, v28
    v_exp_f32 v29, v29
    v_exp_f32 v30, v30
    v_exp_f32 v31, v31
    v_exp_f32 v0, v0
    v_exp_f32 v1, v1
    v_smfmac_f32_32x32x32_bf16 v[32:47], v[84:87], v[24:31], v52
    v_exp_f32 v2, v2
    v_exp_f32 v3, v3
    v_exp_f32 v4, v4
    v_mfma_f32_32x32x16_bf16 v[16:31], v[100:103], v[48:51], 0
    v_exp_f32 v5, v5
    v_exp_f32 v6, v6
    v_exp_f32 v7, v7
    v_exp_f32 v8, v8
    v_exp_f32 v9, v9
    v_smfmac_f32_32x32x32_bf16 v[32:47], v[92:95], v[0:7], v52
    v_exp_f32 v10, v10
    v_exp_f32 v11, v11
    v_exp_f32 v12, v12
    v_exp_f32 v13, v13
    v_exp_f32 v14, v14
    v_exp_f32 v15, v15
    v_exp_f32 v16, v16
    v_exp_f32 v17, v17
    v_smfmac_f32_32x32x32_bf16 v[32:47], v[96:99], v[8:15], v52
    v_exp_f32 v18, v18
    v_exp_f32 v19, v19
    v_exp_f32 v20, v20
    v_mfma_f32_32x32x16_bf16 v[0:15], v[112:115], v[48:51], 0
    v_exp_f32 v21, v21
    v_exp_f32 v22, v22
    v_exp_f32 v23, v23
PAD5:
    s_cbranch_execz PADRET
    v_exp_f32 v24, v24
    v_exp_f32 v25, v25
    v_smfmac_f32_32x32x32_bf16 v[32:47], v[104:107], v[16:23], v52
    v_exp_f32 v26, v26
    v_exp_f32 v27, v27
    v_exp_f32 v28, v28
    v_exp_f32 v29, v29
    v_exp_f32 v30, v30
    v_exp_f32 v31, v31
    v_exp_f32 v0, v0
    v_exp_f32 v1, v1
    v_smfmac_f32_32x32x32_bf16 v[32:47], v[108:111], v[24:31], v52
    v_exp_f32 v2, v2
    v_exp_f32 v3, v3
    v_exp_f32 v4, v4
    v_mfma_f32_32x32x16_bf16 v[16:31], v[124:127], v[48:51], 0
    v_exp_f32 v5, v5
    v_exp_f32 v6, v6
    v_exp_f32 v7, v7
    v_exp_f32 v8, v8
    v_exp_f32 v9, v9
    v_smfmac_f32_32x32x32_bf16 v[32:47], v[116:119], v[0:7], v52
    v_exp_f32 v10, v10
    v_exp_f32 v11, v11
    v_exp_f32 v12, v12
    v_exp_f32 v13, v13
    v_exp_f32 v14, v14
    v_exp_f32 v15, v15
    v_exp_f32 v16, v16
    v_exp_f32 v17, v17
    v_smfmac_f32_32x32x32_bf16 v[32:47], v[120:123], v[8:15], v52
    v_exp_f32 v18, v18
    v_exp_f32 v19, v19
    v_exp_f32 v20, v20
    v_mfma_f32_32x32x16_bf16 v[0:15], v[136:139], v[48:51], 0
    v_exp_f32 v21, v21
    v_exp_f32 v22, v22
    v_exp_f32 v23, v23
    v_exp_f32 v24, v24
    v_exp_f32 v25, v25
    v_smfmac_f32_32x32x32_bf16 v[32:47], v[128:131], v[16:23], v52
    v_exp_f32 v26, v26
    v_exp_f32 v27, v27
    v_exp_f32 v28, v28
    v_exp_f32 v29, v29
    v_exp_f32 v30, v30
    v_exp_f32 v31, v31
    v_exp_f32 v0, v0
    v_exp_f32 v1, v1
    v_smfmac_f32_32x32x32_bf16 v[32:47], v[132:135], v[24:31], v52
    v_exp_f32 v2, v2
    v_exp_f32 v3, v3
    v_exp_f32 v4, v4
    v_mfma_f32_32x32x16_bf16 v[16:31], v[148:151], v[48:51], 0
    v_exp_f32 v5, v5
    v_exp_f32 v6, v6
    v_exp_f32 v7, v7
    v_exp_f32 v8, v8
    v_exp_f32 v9, v9
    v_smfmac_f32_32x32x32_bf16 v[32:47], v[140:143], v[0:7], v52
    v_exp_f32 v10, v10
    v_exp_f32 v11, v11
    v_exp_f32 v12, v12
    v_exp_f32 v13, v13
    v_exp_f32 v14, v14
    v_exp_f32 v15, v15
    v_exp_f32 v16, v16
    v_exp_f32 v17, v17
    v_smfmac_f32_32x32x32_bf16 v[32:47], v[144:147], v[8:15], v52
    v_exp_f32 v18, v18
    v_exp_f32 v19, v19
    v_exp_f32 v20, v20
    v_mfma_f32_32x32x16_bf16 v[0:15], v[160:163], v[48:51], 0
    v_exp_f32 v21, v21
    v_exp_f32 v22, v22
    v_exp_f32 v23, v23
    v_exp_f32 v24, v24
    v_exp_f32 v25, v25
    v_smfmac_f32_32x32x32_bf16 v[32:47], v[152:155], v[16:23], v52
    v_exp_f32 v26, v26
    v_exp_f32 v27, v27
    v_exp_f32 v28, v28
    v_exp_f32 v29, v29
    v_exp_f32 v30, v30
    v_exp_f32 v31, v31
    v_exp_f32 v0, v0
    v_exp_f32 v1, v1
    v_smfmac_f32_32x32x32_bf16 v[32:47], v[156:159], v[24:31], v52
    v_exp_f32 v2, v2
    v_exp_f32 v3, v3
    v_exp_f32 v4, v4
    v_mfma_f32_32x32x16_bf16 v[16:31], v[172:175], v[48:51], 0
    v_exp_f32 v5, v5
    v_exp_f32 v6, v6
    v_exp_f32 v7, v7
    v_exp_f32 v8, v8
    v_exp_f32 v9, v9
    v_smfmac_f32_32x32x32_bf16 v[32:47], v[164:167], v[0:7], v52
    v_exp_f32 v10, v10
    v_exp_f32 v11, v11
    v_exp_f32 v12, v12
    v_exp_f32 v13, v13
    v_exp_f32 v14, v14
    v_exp_f32 v15, v15
    v_exp_f32 v16, v16
    v_exp_f32 v17, v17
    v_smfmac_f32_32x32x32_bf16 v[32:47], v[168:171], v[8:15], v52
    v_exp_f32 v18, v18
    v_exp_f32 v19, v19
    v_exp_f32 v20, v20
    v_mfma_f32_32x32x16_bf16 v[0:15], v[184:187], v[48:51], 0
    v_exp_f32 v21, v21
    v_exp_f32 v22, v22
    v_exp_f32 v23, v23
    v_exp_f32 v24, v24
    v_exp_f32 v25, v25
    v_smfmac_f32_32x32x32_bf16 v[32:47], v[176:179], v[16:23], v52
    v_exp_f32 v26, v26
    v_exp_f32 v27, v27
    v_exp_f32 v28, v28
    v_exp_f32 v29, v29
    v_exp_f32 v30, v30
    v_exp_f32 v31, v31
    v_exp_f32 v0, v0
    v_exp_f32 v1, v1
    v_smfmac_f32_32x32x32_bf16 v[32:47], v[180:183], v[24:31], v52
    v_exp_f32 v2, v2
    v_exp_f32 v3, v3
    v_exp_f32 v4, v4
    v_mfma_f32_32x32x16_bf16 v[16:31], v[196:199], v[48:51], 0
    v_exp_f32 v5, v5
    v_exp_f32 v6, v6
    v_exp_f32 v7, v7
    v_exp_f32 v8, v8
    v_exp_f32 v9, v9
    v_smfmac_f32_32x32x32_bf16 v[32:47], v[188:191], v[0:7], v52
    v_exp_f32 v10, v10
    v_exp_f32 v11, v11
    v_exp_f32 v12, v12
    v_exp_f32 v13, v13
    v_exp_f32 v14, v14
    v_exp_f32 v15, v15
    v_exp_f32 v16, v16
    v_exp_f32 v17, v17
    v_smfmac_f32_32x32x32_bf16 v[32:47], v[192:195], v[8:15], v52
    v_exp_f32 v18, v18
    v_exp_f32 v19, v19
    v_exp_f32 v20, v20
    v_mfma_f32_32x32x16_bf16 v[0:15], v[208:211], v[48:51], 0
    v_exp_f32 v21, v21
    v_exp_f32 v22, v22
    v_exp_f32 v23, v23
    v_exp_f32 v24, v24
    v_exp_f32 v25, v25
    v_smfmac_f32_32x32x32_bf16 v[32:47], v[200:203], v[16:23], v52
    v_exp_f32 v26, v26
    v_exp_f32 v27, v27
    v_exp_f32 v28, v28
    v_exp_f32 v29, v29
    v_exp_f32 v30, v30
    v_exp_f32 v31, v31
    v_exp_f32 v0, v0
    v_exp_f32 v1, v1
    v_smfmac_f32_32x32x32_bf16 v[32:47], v[204:207], v[24:31], v52
    v_exp_f32 v2, v2
    v_exp_f32 v3, v3
    v_exp_f32 v4, v4
    v_mfma_f32_32x32x16_bf16 v[16:31], v[220:223], v[48:51], 0
    v_exp_f32 v5, v5
    v_exp_f32 v6, v6
    v_exp_f32 v7, v7
    v_exp_f32 v8, v8
    v_exp_f32 v9, v9
    v_smfmac_f32_32x32x32_bf16 v[32:47], v[212:215], v[0:7], v52
    v_exp_f32 v10, v10
    v_exp_f32 v11, v11
    v_exp_f32 v12, v12
    v_exp_f32 v13, v13
    v_exp_f32 v14, v14
    v_exp_f32 v15, v15
    v_exp_f32 v16, v16
    v_exp_f32 v17, v17
    v_smfmac_f32_32x32x32_bf16 v[32:47], v[216:219], v[8:15], v52
    v_exp_f32 v18, v18
    v_exp_f32 v19, v19
    v_exp_f32 v20, v20
    v_mfma_f32_32x32x16_bf16 v[0:15], v[232:235], v[48:51], 0
    ds_read_b32 v55, v53 offset:16
    v_exp_f32 v21, v21
    v_exp_f32 v22, v22
    v_exp_f32 v23, v23
    v_exp_f32 v24, v24
    v_exp_f32 v25, v25
    v_smfmac_f32_32x32x32_bf16 v[32:47], v[224:227], v[16:23], v52
    v_exp_f32 v26, v26
    v_exp_f32 v27, v27
    v_exp_f32 v28, v28
    v_exp_f32 v29, v29
    v_exp_f32 v30, v30
    v_exp_f32 v31, v31
    v_exp_f32 v0, v0
    v_exp_f32 v1, v1
    v_smfmac_f32_32x32x32_bf16 v[32:47], v[228:231], v[24:31], v52
    v_exp_f32 v2, v2
    v_exp_f32 v3, v3
    v_exp_f32 v4, v4
    v_mfma_f32_32x32x16_bf16 v[16:31], v[244:247], v[48:51], 0
    s_waitcnt lgkmcnt(0)
    v_readfirstlane_b32 s53, v55
    s_cmp_ge_u32 s53, EV_R11
    s_cbranch_scc0 gst_60
gbk_61:
    ds_read_b128 v[48:51], v53 offset:8704
    v_exp_f32 v5, v5
    v_exp_f32 v6, v6
    v_exp_f32 v7, v7
    v_exp_f32 v8, v8
    v_exp_f32 v9, v9
    v_smfmac_f32_32x32x32_bf16 v[32:47], v[236:239], v[0:7], v52
    v_exp_f32 v10, v10
    v_exp_f32 v11, v11
    v_exp_f32 v12, v12
    v_exp_f32 v13, v13
    v_exp_f32 v14, v14
    v_exp_f32 v15, v15
    v_exp_f32 v16, v16
    v_exp_f32 v17, v17
    v_smfmac_f32_32x32x32_bf16 v[32:47], v[240:243], v[8:15], v52
    v_exp_f32 v18, v18
    v_exp_f32 v19, v19
    v_exp_f32 v20, v20
    s_waitcnt lgkmcnt(0)
    v_mfma_f32_32x32x16_bf16 v[0:15], v[64:67], v[48:51], 0
    v_exp_f32 v21, v21
    v_exp_f32 v22, v22
    v_exp_f32 v23, v23
    v_exp_f32 v24, v24
    v_exp_f32 v25, v25
    v_smfmac_f32_32x32x32_bf16 v[32:47], v[248:251], v[16:23], v52
    v_exp_f32 v26, v26
    v_exp_f32 v27, v27
    v_exp_f32 v28, v28
    v_exp_f32 v29, v29
    v_exp_f32 v30, v30
    v_exp_f32 v31, v31
    v_exp_f32 v0, v0
    v_exp_f32 v1, v1
    v_smfmac_f32_32x32x32_bf16 v[32:47], v[252:255], v[24:31], v52
    v_exp_f32 v2, v2
    v_exp_f32 v3, v3
    v_exp_f32 v4, v4
    v_mfma_f32_32x32x16_bf16 v[16:31], v[76:79], v[48:51], 0
    v_exp_f32 v5, v5
    v_exp_f32 v6, v6
    v_exp_f32 v7, v7
    v_exp_f32 v8, v8
    v_exp_f32 v9, v9
    v_exp_f32 v10, v10
    v_exp_f32 v11, v11
    v_exp_f32 v12, v12
    ds_write_b128 v54, v[32:35] offset:28672
    ds_write_b128 v54, v[36:39] offset:29696
    ds_write_addtid_b32 v40 offset:30720
    ds_add_u32 v57, v52 offset:64
    v_mov_b64 v[32:33], 0
    v_mov_b64 v[34:35], 0
    v_mov_b64 v[36:37], 0
    v_mov_b64 v[38:39], 0
    v_mov_b32 v40, 0
    v_exp_f32 v13, v13
    v_exp_f32 v14, v14
    v_smfmac_f32_32x32x32_bf16 v[32:47], v[68:71], v[0:7], v52
    v_exp_f32 v15, v15
    v_exp_f32 v16, v16
    v_exp_f32 v17, v17
    v_smfmac_f32_32x32x32_bf16 v[32:47], v[72:75], v[8:15], v52
    v_exp_f32 v18, v18
    v_exp_f32 v19, v19
    v_exp_f32 v20, v20
    v_mfma_f32_32x32x16_bf16 v[0:15], v[88:91], v[48:51], 0
    v_exp_f32 v21, v21
    v_exp_f32 v22, v22
    v_exp_f32 v23, v23
    v_exp_f32 v24, v24
    v_exp_f32 v25, v25
    v_smfmac_f32_32x32x32_bf16 v[32:47], v[80:83], v[16:23], v52
    v_exp_f32 v26, v26
    v_exp_f32 v27, v27
    v_exp_f32 v28, v28
    v_exp_f32 v29, v29
    v_exp_f32 v30, v30
    v_exp_f32 v31, v31
    v_exp_f32 v0, v0
    v_exp_f32 v1, v1
    v_smfmac_f32_32x32x32_bf16 v[32:47], v[84:87], v[24:31], v52
    v_exp_f32 v2, v2
    v_exp_f32 v3, v3
    v_exp_f32 v4, v4
    v_mfma_f32_32x32x16_bf16 v[16:31], v[100:103], v[48:51], 0
    v_exp_f32 v5, v5
    v_exp_f32 v6, v6
    v_exp_f32 v7, v7
    v_exp_f32 v8, v8
    v_exp_f32 v9, v9
    v_smfmac_f32_32x32x32_bf16 v[32:47], v[92:95], v[0:7], v52
    v_exp_f32 v10, v10
    v_exp_f32 v11, v11
    v_exp_f32 v12, v12
    v_exp_f32 v13, v13
    v_exp_f32 v14, v14
    v_exp_f32 v15, v15
    v_exp_f32 v16, v16
    v_exp_f32 v17, v17
    v_smfmac_f32_32x32x32_bf16 v[32:47], v[96:99], v[8:15], v52
    v_exp_f32 v18, v18
    v_exp_f32 v19, v19
    v_exp_f32 v20, v20
    v_mfma_f32_32x32x16_bf16 v[0:15], v[112:115], v[48:51], 0
    v_exp_f32 v21, v21
    v_exp_f32 v22, v22
    v_exp_f32 v23, v23
    v_exp_f32 v24, v24
    v_exp_f32 v25, v25
    v_smfmac_f32_32x32x32_bf16 v[32:47], v[104:107], v[16:23], v52
    v_exp_f32 v26, v26
    v_exp_f32 v27, v27
    v_exp_f32 v28, v28
    v_exp_f32 v29, v29
    v_exp_f32 v30, v30
    v_exp_f32 v31, v31
    v_exp_f32 v0, v0
    v_exp_f32 v1, v1
    v_smfmac_f32_32x32x32_bf16 v[32:47], v[108:111], v[24:31], v52
    v_exp_f32 v2, v2
    v_exp_f32 v3, v3
    v_exp_f32 v4, v4
    v_mfma_f32_32x32x16_bf16 v[16:31], v[124:127], v[48:51], 0
    v_exp_f32 v5, v5
    v_exp_f32 v6, v6
    v_exp_f32 v7, v7
    v_exp_f32 v8, v8
    v_exp_f32 v9, v9
    v_smfmac_f32_32x32x32_bf16 v[32:47], v[116:119], v[0:7], v52
    v_exp_f32 v10, v10
    v_exp_f32 v11, v11
    v_exp_f32 v12, v12
    v_exp_f32 v13, v13
    v_exp_f32 v14, v14
    v_exp_f32 v15, v15
    v_exp_f32 v16, v16
    v_exp_f32 v17, v17
    v_smfmac_f32_32x32x32_bf16 v[32:47], v[120:123], v[8:15], v52
    v_exp_f32 v18, v18
    v_exp_f32 v19, v19
    v_exp_f32 v20, v20
    v_mfma_f32_32x32x16_bf16 v[0:15], v[136:139], v[48:51], 0
    v_exp_f32 v21, v21
    v_exp_f32 v22, v22
    v_exp_f32 v23, v23
    v_exp_f32 v24, v24
    v_exp_f32 v25, v25
    v_smfmac_f32_32x32x32_bf16 v[32:47], v[128:131], v[16:23], v52
    v_exp_f32 v26, v26
    v_exp_f32 v27, v27
    v_exp_f32 v28, v28
    v_exp_f32 v29, v29
    v_exp_f32 v30, v30
    v_exp_f32 v31, v31
    v_exp_f32 v0, v0
    v_exp_f32 v1, v1
    v_smfmac_f32_32x32x32_bf16 v[32:47], v[132:135], v[24:31], v52
    v_exp_f32 v2, v2
    v_exp_f32 v3, v3
    v_exp_f32 v4, v4
    v_mfma_f32_32x32x16_bf16 v[16:31], v[148:151], v[48:51], 0
    v_exp_f32 v5, v5
    v_exp_f32 v6, v6
    v_exp_f32 v7, v7
    v_exp_f32 v8, v8
    v_exp_f32 v9, v9
    v_smfmac_f32_32x32x32_bf16 v[32:47], v[140:143], v[0:7], v52
    v_exp_f32 v10, v10
    v_exp_f32 v11, v11
    v_exp_f32 v12, v12
    v_exp_f32 v13, v13
    v_exp_f32 v14, v14
    v_exp_f32 v15, v15
    v_exp_f32 v16, v16
    v_exp_f32 v17, v17
    v_smfmac_f32_32x32x32_bf16 v[32:47], v[144:147], v[8:15], v52
    v_exp_f32 v18, v18
    v_exp_f32 v19, v19
    v_exp_f32 v20, v20
    v_mfma_f32_32x32x16_bf16 v[0:15], v[160:163], v[48:51], 0
    v_exp_f32 v21, v21
    v_exp_f32 v22, v22
    v_exp_f32 v23, v23
    v_exp_f32 v24, v24
    v_exp_f32 v25, v25
    v_smfmac_f32_32x32x32_bf16 v[32:47], v[152:155], v[16:23], v52
    v_exp_f32 v26, v26
    v_exp_f32 v27, v27
    v_exp_f32 v28, v28
    v_exp_f32 v29, v29
    v_exp_f32 v30, v30
    v_exp_f32 v31, v31
    v_exp_f32 v0, v0
    v_exp_f32 v1, v1
    v_smfmac_f32_32x32x32_bf16 v[32:47], v[156:159], v[24:31], v52
    v_exp_f32 v2, v2
    v_exp_f32 v3, v3
    v_exp_f32 v4, v4
    v_mfma_f32_32x32x16_bf16 v[16:31], v[172:175], v[48:51], 0
    v_exp_f32 v5, v5
    v_exp_f32 v6, v6
    v_exp_f32 v7, v7
    v_exp_f32 v8, v8
    v_exp_f32 v9, v9
    v_smfmac_f32_32x32x32_bf16 v[32:47], v[164:167], v[0:7], v52
    v_exp_f32 v10, v10
    v_exp_f32 v11, v11
    v_exp_f32 v12, v12
    v_exp_f32 v13, v13
    v_exp_f32 v14, v14
    v_exp_f32 v15, v15
    v_exp_f32 v16, v16
    v_exp_f32 v17, v17
    v_smfmac_f32_32x32x32_bf16 v[32:47], v[168:171], v[8:15], v52
    v_exp_f32 v18, v18
    v_exp_f32 v19, v19
    v_exp_f32 v20, v20
    v_mfma_f32_32x32x16_bf16 v[0:15], v[184:187], v[48:51], 0
    v_exp_f32 v21, v21
    v_exp_f32 v22, v22
    v_exp_f32 v23, v23
    v_exp_f32 v24, v24
    v_exp_f32 v25, v25
    v_smfmac_f32_32x32x32_bf16 v[32:47], v[176:179], v[16:23], v52
    v_exp_f32 v26, v26
    v_exp_f32 v27, v27
    v_exp_f32 v28, v28
    v_exp_f32 v29, v29
    v_exp_f32 v30, v30
    v_exp_f32 v31, v31
    v_exp_f32 v0, v0
    v_exp_f32 v1, v1
    v_smfmac_f32_32x32x32_bf16 v[32:47], v[180:183], v[24:31], v52
    v_exp_f32 v2, v2
    v_exp_f32 v3, v3
    v_exp_f32 v4, v4
    v_mfma_f32_32x32x16_bf16 v[16:31], v[196:199], v[48:51], 0
    v_exp_f32 v5, v5
    v_exp_f32 v6, v6
    v_exp_f32 v7, v7
    v_exp_f32 v8, v8
    v_exp_f32 v9, v9
    v_smfmac_f32_32x32x32_bf16 v[32:47], v[188:191], v[0:7], v52
    v_exp_f32 v10, v10
    v_exp_f32 v11, v11
    v_exp_f32 v12, v12
    v_exp_f32 v13, v13
    v_exp_f32 v14, v14
    v_exp_f32 v15, v15
    v_exp_f32 v16, v16
    v_exp_f32 v17, v17
    v_smfmac_f32_32x32x32_bf16 v[32:47], v[192:195], v[8:15], v52
    v_exp_f32 v18, v18
    v_exp_f32 v19, v19
    v_exp_f32 v20, v20
    v_mfma_f32_32x32x16_bf16 v[0:15], v[208:211], v[48:51], 0
    v_exp_f32 v21, v21
    v_exp_f32 v22, v22
    v_exp_f32 v23, v23
    v_exp_f32 v24, v24
    v_exp_f32 v25, v25
    v_smfmac_f32_32x32x32_bf16 v[32:47], v[200:203], v[16:23], v52
    v_exp_f32 v26, v26
    v_exp_f32 v27, v27
    v_exp_f32 v28, v28
    v_exp_f32 v29, v29
    v_exp_f32 v30, v30
    v_exp_f32 v31, v31
    v_exp_f32 v0, v0
    v_exp_f32 v1, v1
    v_smfmac_f32_32x32x32_bf16 v[32:47], v[204:207], v[24:31], v52
    v_exp_f32 v2, v2
    v_exp_f32 v3, v3
    v_exp_f32 v4, v4
    v_mfma_f32_32x32x16_bf16 v[16:31], v[220:223], v[48:51], 0
    v_exp_f32 v5, v5
    v_exp_f32 v6, v6
    v_exp_f32 v7, v7
    v_exp_f32 v8, v8
    v_exp_f32 v9, v9
    v_smfmac_f32_32x32x32_bf16 v[32:47], v[212:215], v[0:7], v52
    v_exp_f32 v10, v10
    v_exp_f32 v11, v11
    v_exp_f32 v12, v12
    v_exp_f32 v13, v13
    v_exp_f32 v14, v14
    v_exp_f32 v15, v15
    v_exp_f32 v16, v16
    v_exp_f32 v17, v17
    v_smfmac_f32_32x32x32_bf16 v[32:47], v[216:219], v[8:15], v52
    v_exp_f32 v18, v18
    v_exp_f32 v19, v19
    v_exp_f32 v20, v20
    v_mfma_f32_32x32x16_bf16 v[0:15], v[232:235], v[48:51], 0
    v_exp_f32 v21, v21
    v_exp_f32 v22, v22
    v_exp_f32 v23, v23
    v_exp_f32 v24, v24
    v_exp_f32 v25, v25
    v_smfmac_f32_32x32x32_bf16 v[32:47], v[224:227], v[16:23], v52
    v_exp_f32 v26, v26
    v_exp_f32 v27, v27
    v_exp_f32 v28, v28
    v_exp_f32 v29, v29
    v_exp_f32 v30, v30
    v_exp_f32 v31, v31
    v_exp_f32 v0, v0
    v_exp_f32 v1, v1
    v_smfmac_f32_32x32x32_bf16 v[32:47], v[228:231], v[24:31], v52
    v_exp_f32 v2, v2
    v_exp_f32 v3, v3
    v_exp_f32 v4, v4
    v_mfma_f32_32x32x16_bf16 v[16:31], v[244:247], v[48:51], 0
    ds_read_b128 v[48:51], v53 offset:9728
    v_exp_f32 v5, v5
    v_exp_f32 v6, v6
    v_exp_f32 v7, v7
    v_exp_f32 v8, v8
    v_exp_f32 v9, v9
    v_smfmac_f32_32x32x32_bf16 v[32:47], v[236:239], v[0:7], v52
    v_exp_f32 v10, v10
    v_exp_f32 v11, v11
    v_exp_f32 v12, v12
    v_exp_f32 v13, v13
    v_exp_f32 v14, v14
    v_exp_f32 v15, v15
    v_exp_f32 v16, v16
    v_exp_f32 v17, v17
    v_smfmac_f32_32x32x32_bf16 v[32:47], v[240:243], v[8:15], v52
    v_exp_f32 v18, v18
    v_exp_f32 v19, v19
    v_exp_f32 v20, v20
    s_waitcnt lgkmcnt(0)
    v_mfma_f32_32x32x16_bf16 v[0:15], v[64:67], v[48:51], 0
    v_exp_f32 v21, v21
    v_exp_f32 v22, v22
    v_exp_f32 v23, v23
    v_exp_f32 v24, v24
    v_exp_f32 v25, v25
    v_smfmac_f32_32x32x32_bf16 v[32:47], v[248:251], v[16:23], v52
    v_exp_f32 v26, v26
    v_exp_f32 v27, v27
    v_exp_f32 v28, v28
    v_exp_f32 v29, v29
    v_exp_f32 v30, v30
    v_exp_f32 v31, v31
    v_exp_f32 v0, v0
    v_exp_f32 v1, v1
    v_smfmac_f32_32x32x32_bf16 v[32:47], v[252:255], v[24:31], v52
    v_exp_f32 v2, v2
    v_exp_f32 v3, v3
    v_exp_f32 v4, v4
    v_mfma_f32_32x32x16_bf16 v[16:31], v[76:79], v[48:51], 0
    v_exp_f32 v5, v5
    v_exp_f32 v6, v6
    v_exp_f32 v7, v7
    v_exp_f32 v8, v8
    v_exp_f32 v9, v9
    v_exp_f32 v10, v10
    v_exp_f32 v11, v11
    v_exp_f32 v12, v12
    ds_write_b128 v54, v[32:35] offset:37888
    ds_write_b128 v54, v[36:39] offset:38912
    ds_write_addtid_b32 v40 offset:39936
    ds_add_u32 v57, v52 offset:64
    v_mov_b64 v[32:33], 0
    v_mov_b64 v[34:35], 0
    v_mov_b64 v[36:37], 0
    v_mov_b64 v[38:39], 0
    v_mov_b32 v40, 0
    v_exp_f32 v13, v13
    v_exp_f32 v14, v14
    v_smfmac_f32_32x32x32_bf16 v[32:47], v[68:71], v[0:7], v52
    v_exp_f32 v15, v15
    v_exp_f32 v16, v16
    v_exp_f32 v17, v17
    v_smfmac_f32_32x32x32_bf16 v[32:47], v[72:75], v[8:15], v52
    v_exp_f32 v18, v18
    v_exp_f32 v19, v19
    v_exp_f32 v20, v20
    v_mfma_f32_32x32x16_bf16 v[0:15], v[88:91], v[48:51], 0
    v_exp_f32 v21, v21
    v_exp_f32 v22, v22
    v_exp_f32 v23, v23
    v_exp_f32 v24, v24
    v_exp_f32 v25, v25
    v_smfmac_f32_32x32x32_bf16 v[32:47], v[80:83], v[16:23], v52
    v_exp_f32 v26, v26
    v_exp_f32 v27, v27
    v_exp_f32 v28, v28
    v_exp_f32 v29, v29
    v_exp_f32 v30, v30
    v_exp_f32 v31, v31
    v_exp_f32 v0, v0
    v_exp_f32 v1, v1
    v_smfmac_f32_32x32x32_bf16 v[32:47], v[84:87], v[24:31], v52
    v_exp_f32 v2, v2
    v_exp_f32 v3, v3
    v_exp_f32 v4, v4
    v_mfma_f32_32x32x16_bf16 v[16:31], v[100:103], v[48:51], 0
    v_exp_f32 v5, v5
    v_exp_f32 v6, v6
    v_exp_f32 v7, v7
    v_exp_f32 v8, v8
    v_exp_f32 v9, v9
    v_smfmac_f32_32x32x32_bf16 v[32:47], v[92:95], v[0:7], v52
    v_exp_f32 v10, v10
    v_exp_f32 v11, v11
    v_exp_f32 v12, v12
    v_exp_f32 v13, v13
    v_exp_f32 v14, v14
    v_exp_f32 v15, v15
    v_exp_f32 v16, v16
    v_exp_f32 v17, v17
    v_smfmac_f32_32x32x32_bf16 v[32:47], v[96:99], v[8:15], v52
    v_exp_f32 v18, v18
    v_exp_f32 v19, v19
    v_exp_f32 v20, v20
    v_mfma_f32_32x32x16_bf16 v[0:15], v[112:115], v[48:51], 0
    v_exp_f32 v21, v21
    v_exp_f32 v22, v22
    v_exp_f32 v23, v23
    v_exp_f32 v24, v24
    v_exp_f32 v25, v25
    v_smfmac_f32_32x32x32_bf16 v[32:47], v[104:107], v[16:23], v52
    v_exp_f32 v26, v26
    v_exp_f32 v27, v27
    v_exp_f32 v28, v28
    v_exp_f32 v29, v29
    v_exp_f32 v30, v30
    v_exp_f32 v31, v31
    v_exp_f32 v0, v0
    v_exp_f32 v1, v1
    v_smfmac_f32_32x32x32_bf16 v[32:47], v[108:111], v[24:31], v52
    v_exp_f32 v2, v2
    v_exp_f32 v3, v3
    v_exp_f32 v4, v4
    v_mfma_f32_32x32x16_bf16 v[16:31], v[124:127], v[48:51], 0
    v_exp_f32 v5, v5
    v_exp_f32 v6, v6
    v_exp_f32 v7, v7
    v_exp_f32 v8, v8
    v_exp_f32 v9, v9
    v_smfmac_f32_32x32x32_bf16 v[32:47], v[116:119], v[0:7], v52
    v_exp_f32 v10, v10
    v_exp_f32 v11, v11
    v_exp_f32 v12, v12
    v_exp_f32 v13, v13
    v_exp_f32 v14, v14
    v_exp_f32 v15, v15
    v_exp_f32 v16, v16
    v_exp_f32 v17, v17
    v_smfmac_f32_32x32x32_bf16 v[32:47], v[120:123], v[8:15], v52
    v_exp_f32 v18, v18
    v_exp_f32 v19, v19
    v_exp_f32 v20, v20
    v_mfma_f32_32x32x16_bf16 v[0:15], v[136:139], v[48:51], 0
    v_exp_f32 v21, v21
    v_exp_f32 v22, v22
    v_exp_f32 v23, v23
    v_exp_f32 v24, v24
    v_exp_f32 v25, v25
    v_smfmac_f32_32x32x32_bf16 v[32:47], v[128:131], v[16:23], v52
    v_exp_f32 v26, v26
    v_exp_f32 v27, v27
    v_exp_f32 v28, v28
    v_exp_f32 v29, v29
    v_exp_f32 v30, v30
    v_exp_f32 v31, v31
    v_exp_f32 v0, v0
    v_exp_f32 v1, v1
    v_smfmac_f32_32x32x32_bf16 v[32:47], v[132:135], v[24:31], v52
    v_exp_f32 v2, v2
    v_exp_f32 v3, v3
    v_exp_f32 v4, v4
    v_mfma_f32_32x32x16_bf16 v[16:31], v[148:151], v[48:51], 0
    v_exp_f32 v5, v5
    v_exp_f32 v6, v6
    v_exp_f32 v7, v7
    v_exp_f32 v8, v8
    v_exp_f32 v9, v9
    v_smfmac_f32_32x32x32_bf16 v[32:47], v[140:143], v[0:7], v52
    v_exp_f32 v10, v10
    v_exp_f32 v11, v11
    v_exp_f32 v12, v12
    v_exp_f32 v13, v13
    v_exp_f32 v14, v14
    v_exp_f32 v15, v15
    v_exp_f32 v16, v16
    v_exp_f32 v17, v17
    v_smfmac_f32_32x32x32_bf16 v[32:47], v[144:147], v[8:15], v52
    v_exp_f32 v18, v18
    v_exp_f32 v19, v19
    v_exp_f32 v20, v20
    v_mfma_f32_32x32x16_bf16 v[0:15], v[160:163], v[48:51], 0
    v_exp_f32 v21, v21
    v_exp_f32 v22, v22
    v_exp_f32 v23, v23
    v_exp_f32 v24, v24
    v_exp_f32 v25, v25
    v_smfmac_f32_32x32x32_bf16 v[32:47], v[152:155], v[16:23], v52
    v_exp_f32 v26, v26
    v_exp_f32 v27, v27
    v_exp_f32 v28, v28
    v_exp_f32 v29, v29
    v_exp_f32 v30, v30
    v_exp_f32 v31, v31
    v_exp_f32 v0, v0
    v_exp_f32 v1, v1
    v_smfmac_f32_32x32x32_bf16 v[32:47], v[156:159], v[24:31], v52
    v_exp_f32 v2, v2
    v_exp_f32 v3, v3
    v_exp_f32 v4, v4
    v_mfma_f32_32x32x16_bf16 v[16:31], v[172:175], v[48:51], 0
    v_exp_f32 v5, v5
    v_exp_f32 v6, v6
    v_exp_f32 v7, v7
    v_exp_f32 v8, v8
    v_exp_f32 v9, v9
    v_smfmac_f32_32x32x32_bf16 v[32:47], v[164:167], v[0:7], v52
    v_exp_f32 v10, v10
    v_exp_f32 v11, v11
    v_exp_f32 v12, v12
    v_exp_f32 v13, v13
    v_exp_f32 v14, v14
    v_exp_f32 v15, v15
    v_exp_f32 v16, v16
    v_exp_f32 v17, v17
    v_smfmac_f32_32x32x32_bf16 v[32:47], v[168:171], v[8:15], v52
    v_exp_f32 v18, v18
    v_exp_f32 v19, v19
    v_exp_f32 v20, v20
    v_mfma_f32_32x32x16_bf16 v[0:15], v[184:187], v[48:51], 0
    v_exp_f32 v21, v21
    v_exp_f32 v22, v22
    v_exp_f32 v23, v23
    v_exp_f32 v24, v24
    v_exp_f32 v25, v25
    v_smfmac_f32_32x32x32_bf16 v[32:47], v[176:179], v[16:23], v52
    v_exp_f32 v26, v26
    v_exp_f32 v27, v27
    v_exp_f32 v28, v28
    v_exp_f32 v29, v29
    v_exp_f32 v30, v30
    v_exp_f32 v31, v31
    v_exp_f32 v0, v0
    v_exp_f32 v1, v1
    v_smfmac_f32_32x32x32_bf16 v[32:47], v[180:183], v[24:31], v52
    v_exp_f32 v2, v2
    v_exp_f32 v3, v3
    v_exp_f32 v4, v4
    v_mfma_f32_32x32x16_bf16 v[16:31], v[196:199], v[48:51], 0
    v_exp_f32 v5, v5
    v_exp_f32 v6, v6
    v_exp_f32 v7, v7
    v_exp_f32 v8, v8
    v_exp_f32 v9, v9
    v_smfmac_f32_32x32x32_bf16 v[32:47], v[188:191], v[0:7], v52
    v_exp_f32 v10, v10
    v_exp_f32 v11, v11
    v_exp_f32 v12, v12
    v_exp_f32 v13, v13
    v_exp_f32 v14, v14
    v_exp_f32 v15, v15
    v_exp_f32 v16, v16
    v_exp_f32 v17, v17
    v_smfmac_f32_32x32x32_bf16 v[32:47], v[192:195], v[8:15], v52
    v_exp_f32 v18, v18
    v_exp_f32 v19, v19
    v_exp_f32 v20, v20
    v_mfma_f32_32x32x16_bf16 v[0:15], v[208:211], v[48:51], 0
    v_exp_f32 v21, v21
    v_exp_f32 v22, v22
    v_exp_f32 v23, v23
    v_exp_f32 v24, v24
    v_exp_f32 v25, v25
    v_smfmac_f32_32x32x32_bf16 v[32:47], v[200:203], v[16:23], v52
    v_exp_f32 v26, v26
    v_exp_f32 v27, v27
    v_exp_f32 v28, v28
    v_exp_f32 v29, v29
    v_exp_f32 v30, v30
    v_exp_f32 v31, v31
    v_exp_f32 v0, v0
    v_exp_f32 v1, v1
    v_smfmac_f32_32x32x32_bf16 v[32:47], v[204:207], v[24:31], v52
    v_exp_f32 v2, v2
    v_exp_f32 v3, v3
    v_exp_f32 v4, v4
    v_mfma_f32_32x32x16_bf16 v[16:31], v[220:223], v[48:51], 0
    v_exp_f32 v5, v5
    v_exp_f32 v6, v6
    v_exp_f32 v7, v7
    v_exp_f32 v8, v8
    v_exp_f32 v9, v9
    v_smfmac_f32_32x32x32_bf16 v[32:47], v[212:215], v[0:7], v52
    v_exp_f32 v10, v10
    v_exp_f32 v11, v11
    v_exp_f32 v12, v12
    v_exp_f32 v13, v13
    v_exp_f32 v14, v14
    v_exp_f32 v15, v15
    v_exp_f32 v16, v16
    v_exp_f32 v17, v17
    v_smfmac_f32_32x32x32_bf16 v[32:47], v[216:219], v[8:15], v52
    v_exp_f32 v18, v18
    v_exp_f32 v19, v19
    v_exp_f32 v20, v20
    v_mfma_f32_32x32x16_bf16 v[0:15], v[232:235], v[48:51], 0
    v_exp_f32 v21, v21
    v_exp_f32 v22, v22
    v_exp_f32 v23, v23
    v_exp_f32 v24, v24
    v_exp_f32 v25, v25
    v_smfmac_f32_32x32x32_bf16 v[32:47], v[224:227], v[16:23], v52
    v_exp_f32 v26, v26
    v_exp_f32 v27, v27
    v_exp_f32 v28, v28
    v_exp_f32 v29, v29
    v_exp_f32 v30, v30
    v_exp_f32 v31, v31
    v_exp_f32 v0, v0
    v_exp_f32 v1, v1
    v_smfmac_f32_32x32x32_bf16 v[32:47], v[228:231], v[24:31], v52
    v_exp_f32 v2, v2
    v_exp_f32 v3, v3
    v_exp_f32 v4, v4
    v_mfma_f32_32x32x16_bf16 v[16:31], v[244:247], v[48:51], 0
    ds_read_b128 v[48:51], v53 offset:10752
    v_exp_f32 v5, v5
    v_exp_f32 v6, v6
    v_exp_f32 v7, v7
    v_exp_f32 v8, v8
    v_exp_f32 v9, v9
    v_smfmac_f32_32x32x32_bf16 v[32:47], v[236:239], v[0:7], v52
    v_exp_f32 v10, v10
    v_exp_f32 v11, v11
    v_exp_f32 v12, v12
    v_exp_f32 v13, v13
    v_exp_f32 v14, v14
    v_exp_f32 v15, v15
    v_exp_f32 v16, v16
    v_exp_f32 v17, v17
    v_smfmac_f32_32x32x32_bf16 v[32:47], v[240:243], v[8:15], v52
    v_exp_f32 v18, v18
    v_exp_f32 v19, v19
    v_exp_f32 v20, v20
    s_waitcnt lgkmcnt(0)
    v_mfma_f32_32x32x16_bf16 v[0:15], v[64:67], v[48:51], 0
    v_exp_f32 v21, v21
    v_exp_f32 v22, v22
    v_exp_f32 v23, v23
    v_exp_f32 v24, v24
    v_exp_f32 v25, v25
    v_smfmac_f32_32x32x32_bf16 v[32:47], v[248:251], v[16:23], v52
    v_exp_f32 v26, v26
    v_exp_f32 v27, v27
    v_exp_f32 v28, v28
    v_exp_f32 v29, v29
    v_exp_f32 v30, v30
    v_exp_f32 v31, v31
    v_exp_f32 v0, v0
    v_exp_f32 v1, v1
    v_smfmac_f32_32x32x32_bf16 v[32:47], v[252:255], v[24:31], v52
PAD6:
    s_cbranch_execz PADRET
    v_exp_f32 v2, v2
    v_exp_f32 v3, v3
    v_exp_f32 v4, v4
    v_mfma_f32_32x32x16_bf16 v[16:31], v[76:79], v[48:51], 0
    v_exp_f32 v5, v5
    v_exp_f32 v6, v6
    v_exp_f32 v7, v7
    v_exp_f32 v8, v8
    v_exp_f32 v9, v9
    v_exp_f32 v10, v10
    v_exp_f32 v11, v11
    v_exp_f32 v12, v12
    ds_write_b128 v54, v[32:35] offset:47104
    ds_write_b128 v54, v[36:39] offset:48128
    ds_write_addtid_b32 v40 offset:49152
    ds_add_u32 v57, v52 offset:64
    v_mov_b64 v[32:33], 0
    v_mov_b64 v[34:35], 0
    v_mov_b64 v[36:37], 0
    v_mov_b64 v[38:39], 0
    v_mov_b32 v40, 0
    v_exp_f32 v13, v13
    v_exp_f32 v14, v14
    v_smfmac_f32_32x32x32_bf16 v[32:47], v[68:71], v[0:7], v52
    v_exp_f32 v15, v15
    v_exp_f32 v16, v16
    v_exp_f32 v17, v17
    v_smfmac_f32_32x32x32_bf16 v[32:47], v[72:75], v[8:15], v52
    v_exp_f32 v18, v18
    v_exp_f32 v19, v19
    v_exp_f32 v20, v20
    v_mfma_f32_32x32x16_bf16 v[0:15], v[88:91], v[48:51], 0
    v_exp_f32 v21, v21
    v_exp_f32 v22, v22
    v_exp_f32 v23, v23
    v_exp_f32 v24, v24
    v_exp_f32 v25, v25
    v_smfmac_f32_32x32x32_bf16 v[32:47], v[80:83], v[16:23], v52
    v_exp_f32 v26, v26
    v_exp_f32 v27, v27
    v_exp_f32 v28, v28
    v_exp_f32 v29, v29
    v_exp_f32 v30, v30
    v_exp_f32 v31, v31
    v_exp_f32 v0, v0
    v_exp_f32 v1, v1
    v_smfmac_f32_32x32x32_bf16 v[32:47], v[84:87], v[24:31], v52
    v_exp_f32 v2, v2
    v_exp_f32 v3, v3
    v_exp_f32 v4, v4
    v_mfma_f32_32x32x16_bf16 v[16:31], v[100:103], v[48:51], 0
    v_exp_f32 v5, v5
    v_exp_f32 v6, v6
    v_exp_f32 v7, v7
    v_exp_f32 v8, v8
    v_exp_f32 v9, v9
    v_smfmac_f32_32x32x32_bf16 v[32:47], v[92:95], v[0:7], v52
    v_exp_f32 v10, v10
    v_exp_f32 v11, v11
    v_exp_f32 v12, v12
    v_exp_f32 v13, v13
    v_exp_f32 v14, v14
    v_exp_f32 v15, v15
    v_exp_f32 v16, v16
    v_exp_f32 v17, v17
    v_smfmac_f32_32x32x32_bf16 v[32:47], v[96:99], v[8:15], v52
    v_exp_f32 v18, v18
    v_exp_f32 v19, v19
    v_exp_f32 v20, v20
    v_mfma_f32_32x32x16_bf16 v[0:15], v[112:115], v[48:51], 0
    v_exp_f32 v21, v21
    v_exp_f32 v22, v22
    v_exp_f32 v23, v23
    v_exp_f32 v24, v24
    v_exp_f32 v25, v25
    v_smfmac_f32_32x32x32_bf16 v[32:47], v[104:107], v[16:23], v52
    v_exp_f32 v26, v26
    v_exp_f32 v27, v27
    v_exp_f32 v28, v28
    v_exp_f32 v29, v29
    v_exp_f32 v30, v30
    v_exp_f32 v31, v31
    v_exp_f32 v0, v0
    v_exp_f32 v1, v1
    v_smfmac_f32_32x32x32_bf16 v[32:47], v[108:111], v[24:31], v52
    v_exp_f32 v2, v2
    v_exp_f32 v3, v3
    v_exp_f32 v4, v4
    v_mfma_f32_32x32x16_bf16 v[16:31], v[124:127], v[48:51], 0
    v_exp_f32 v5, v5
    v_exp_f32 v6, v6
    v_exp_f32 v7, v7
    v_exp_f32 v8, v8
    v_exp_f32 v9, v9
    v_smfmac_f32_32x32x32_bf16 v[32:47], v[116:119], v[0:7], v52
    v_exp_f32 v10, v10
    v_exp_f32 v11, v11
    v_exp_f32 v12, v12
    v_exp_f32 v13, v13
    v_exp_f32 v14, v14
    v_exp_f32 v15, v15
    v_exp_f32 v16, v16
    v_exp_f32 v17, v17
    v_smfmac_f32_32x32x32_bf16 v[32:47], v[120:123], v[8:15], v52
    v_exp_f32 v18, v18
    v_exp_f32 v19, v19
    v_exp_f32 v20, v20
    v_mfma_f32_32x32x16_bf16 v[0:15], v[136:139], v[48:51], 0
    v_exp_f32 v21, v21
    v_exp_f32 v22, v22
    v_exp_f32 v23, v23
    v_exp_f32 v24, v24
    v_exp_f32 v25, v25
    v_smfmac_f32_32x32x32_bf16 v[32:47], v[128:131], v[16:23], v52
    v_exp_f32 v26, v26
    v_exp_f32 v27, v27
    v_exp_f32 v28, v28
    v_exp_f32 v29, v29
    v_exp_f32 v30, v30
    v_exp_f32 v31, v31
    v_exp_f32 v0, v0
    v_exp_f32 v1, v1
    v_smfmac_f32_32x32x32_bf16 v[32:47], v[132:135], v[24:31], v52
    v_exp_f32 v2, v2
    v_exp_f32 v3, v3
    v_exp_f32 v4, v4
    v_mfma_f32_32x32x16_bf16 v[16:31], v[148:151], v[48:51], 0
    v_exp_f32 v5, v5
    v_exp_f32 v6, v6
    v_exp_f32 v7, v7
    v_exp_f32 v8, v8
    v_exp_f32 v9, v9
    v_smfmac_f32_32x32x32_bf16 v[32:47], v[140:143], v[0:7], v52
    v_exp_f32 v10, v10
    v_exp_f32 v11, v11
    v_exp_f32 v12, v12
    v_exp_f32 v13, v13
    v_exp_f32 v14, v14
    v_exp_f32 v15, v15
    v_exp_f32 v16, v16
    v_exp_f32 v17, v17
    v_smfmac_f32_32x32x32_bf16 v[32:47], v[144:147], v[8:15], v52
    v_exp_f32 v18, v18
    v_exp_f32 v19, v19
    v_exp_f32 v20, v20
    v_mfma_f32_32x32x16_bf16 v[0:15], v[160:163], v[48:51], 0
    v_exp_f32 v21, v21
    v_exp_f32 v22, v22
    v_exp_f32 v23, v23
    v_exp_f32 v24, v24
    v_exp_f32 v25, v25
    v_smfmac_f32_32x32x32_bf16 v[32:47], v[152:155], v[16:23], v52
    v_exp_f32 v26, v26
    v_exp_f32 v27, v27
    v_exp_f32 v28, v28
    v_exp_f32 v29, v29
    v_exp_f32 v30, v30
    v_exp_f32 v31, v31
    v_exp_f32 v0, v0
    v_exp_f32 v1, v1
    v_smfmac_f32_32x32x32_bf16 v[32:47], v[156:159], v[24:31], v52
    v_exp_f32 v2, v2
    v_exp_f32 v3, v3
    v_exp_f32 v4, v4
    v_mfma_f32_32x32x16_bf16 v[16:31], v[172:175], v[48:51], 0
    v_exp_f32 v5, v5
    v_exp_f32 v6, v6
    v_exp_f32 v7, v7
    v_exp_f32 v8, v8
    v_exp_f32 v9, v9
    v_smfmac_f32_32x32x32_bf16 v[32:47], v[164:167], v[0:7], v52
    v_exp_f32 v10, v10
    v_exp_f32 v11, v11
    v_exp_f32 v12, v12
    v_exp_f32 v13, v13
    v_exp_f32 v14, v14
    v_exp_f32 v15, v15
    v_exp_f32 v16, v16
    v_exp_f32 v17, v17
    v_smfmac_f32_32x32x32_bf16 v[32:47], v[168:171], v[8:15], v52
    v_exp_f32 v18, v18
    v_exp_f32 v19, v19
    v_exp_f32 v20, v20
    v_mfma_f32_32x32x16_bf16 v[0:15], v[184:187], v[48:51], 0
    v_exp_f32 v21, v21
    v_exp_f32 v22, v22
    v_exp_f32 v23, v23
    v_exp_f32 v24, v24
    v_exp_f32 v25, v25
    v_smfmac_f32_32x32x32_bf16 v[32:47], v[176:179], v[16:23], v52
    v_exp_f32 v26, v26
    v_exp_f32 v27, v27
    v_exp_f32 v28, v28
    v_exp_f32 v29, v29
    v_exp_f32 v30, v30
    v_exp_f32 v31, v31
    v_exp_f32 v0, v0
    v_exp_f32 v1, v1
    v_smfmac_f32_32x32x32_bf16 v[32:47], v[180:183], v[24:31], v52
    v_exp_f32 v2, v2
    v_exp_f32 v3, v3
    v_exp_f32 v4, v4
    v_mfma_f32_32x32x16_bf16 v[16:31], v[196:199], v[48:51], 0
    v_exp_f32 v5, v5
    v_exp_f32 v6, v6
    v_exp_f32 v7, v7
    v_exp_f32 v8, v8
    v_exp_f32 v9, v9
    v_smfmac_f32_32x32x32_bf16 v[32:47], v[188:191], v[0:7], v52
    v_exp_f32 v10, v10
    v_exp_f32 v11, v11
    v_exp_f32 v12, v12
    v_exp_f32 v13, v13
    v_exp_f32 v14, v14
    v_exp_f32 v15, v15
    v_exp_f32 v16, v16
    v_exp_f32 v17, v17
    v_smfmac_f32_32x32x32_bf16 v[32:47], v[192:195], v[8:15], v52
    v_exp_f32 v18, v18
    v_exp_f32 v19, v19
    v_exp_f32 v20, v20
    v_mfma_f32_32x32x16_bf16 v[0:15], v[208:211], v[48:51], 0
    v_exp_f32 v21, v21
    v_exp_f32 v22, v22
    v_exp_f32 v23, v23
    v_exp_f32 v24, v24
    v_exp_f32 v25, v25
    v_smfmac_f32_32x32x32_bf16 v[32:47], v[200:203], v[16:23], v52
    v_exp_f32 v26, v26
    v_exp_f32 v27, v27
    v_exp_f32 v28, v28
    v_exp_f32 v29, v29
    v_exp_f32 v30, v30
    v_exp_f32 v31, v31
    v_exp_f32 v0, v0
    v_exp_f32 v1, v1
    v_smfmac_f32_32x32x32_bf16 v[32:47], v[204:207], v[24:31], v52
    v_exp_f32 v2, v2
    v_exp_f32 v3, v3
    v_exp_f32 v4, v4
    v_mfma_f32_32x32x16_bf16 v[16:31], v[220:223], v[48:51], 0
    v_exp_f32 v5, v5
    v_exp_f32 v6, v6
    v_exp_f32 v7, v7
    v_exp_f32 v8, v8
    v_exp_f32 v9, v9
    v_smfmac_f32_32x32x32_bf16 v[32:47], v[212:215], v[0:7], v52
    v_exp_f32 v10, v10
    v_exp_f32 v11, v11
    v_exp_f32 v12, v12
    v_exp_f32 v13, v13
    v_exp_f32 v14, v14
    v_exp_f32 v15, v15
    v_exp_f32 v16, v16
    v_exp_f32 v17, v17
    v_smfmac_f32_32x32x32_bf16 v[32:47], v[216:219], v[8:15], v52
    v_exp_f32 v18, v18
    v_exp_f32 v19, v19
    v_exp_f32 v20, v20
    v_mfma_f32_32x32x16_bf16 v[0:15], v[232:235], v[48:51], 0
    v_exp_f32 v21, v21
    v_exp_f32 v22, v22
    v_exp_f32 v23, v23
    v_exp_f32 v24, v24
    v_exp_f32 v25, v25
    v_smfmac_f32_32x32x32_bf16 v[32:47], v[224:227], v[16:23], v52
    v_exp_f32 v26, v26
    v_exp_f32 v27, v27
    v_exp_f32 v28, v28
    v_exp_f32 v29, v29
    v_exp_f32 v30, v30
    v_exp_f32 v31, v31
    v_exp_f32 v0, v0
    v_exp_f32 v1, v1
    v_smfmac_f32_32x32x32_bf16 v[32:47], v[228:231], v[24:31], v52
    v_exp_f32 v2, v2
    v_exp_f32 v3, v3
    v_exp_f32 v4, v4
    v_mfma_f32_32x32x16_bf16 v[16:31], v[244:247], v[48:51], 0
    v_exp_f32 v5, v5
    v_exp_f32 v6, v6
    v_exp_f32 v7, v7
    v_exp_f32 v8, v8
    v_exp_f32 v9, v9
    v_smfmac_f32_32x32x32_bf16 v[32:47], v[236:239], v[0:7], v52
    v_exp_f32 v10, v10
    v_exp_f32 v11, v11
    v_exp_f32 v12, v12
    v_exp_f32 v13, v13
    v_exp_f32 v14, v14
    v_exp_f32 v15, v15
    v_exp_f32 v16, v16
    v_exp_f32 v17, v17
    v_smfmac_f32_32x32x32_bf16 v[32:47], v[240:243], v[8:15], v52
    v_exp_f32 v18, v18
    v_exp_f32 v19, v19
    v_exp_f32 v20, v20
    v_exp_f32 v21, v21
    v_exp_f32 v22, v22
    v_exp_f32 v23, v23
    v_exp_f32 v24, v24
    v_exp_f32 v25, v25
    v_smfmac_f32_32x32x32_bf16 v[32:47], v[248:251], v[16:23], v52
    v_exp_f32 v26, v26
    v_exp_f32 v27, v27
    v_exp_f32 v28, v28
    v_exp_f32 v29, v29
    v_exp_f32 v30, v30
    v_exp_f32 v31, v31
    s_nop 0
    s_setprio 3
    v_smfmac_f32_32x32x32_bf16 v[32:47], v[252:255], v[24:31], v52
    s_nop 0
    s_nop 0
    s_nop 0
    s_nop 0
    s_nop 0
    s_nop 0
    s_nop 0
    s_nop 0
    s_nop 0
    s_nop 0
    s_nop 0
    s_nop 0
    ds_write_b128 v54, v[32:35] offset:56320
    ds_write_b128 v54, v[36:39] offset:57344
    ds_write_addtid_b32 v40 offset:58368
    s_waitcnt lgkmcnt(0)
    s_barrier
EXIT:
    s_endpgm
ckrt_18:
    s_sub_i32 s52, s52, 1
    s_cmp_gt_i32 s52, 0
    s_cbranch_scc0 ckok_17
    s_sleep 4
    buffer_load_dword v57, v60, s[32:35], s70 offen sc1
    s_waitcnt vmcnt(0)
    s_branch ck_16
ckrt_21:
    s_sub_i32 s52, s52, 1
    s_cmp_gt_i32 s52, 0
    s_cbranch_scc0 ckok_20
    s_sleep 2
    s_xor_b32 s77, s79, 262144
    s_add_u32 s78, s77, 32768
    buffer_load_dwordx4 v[64:67], v56, s[32:35], s77 offen offset:0 sc1
    buffer_load_dwordx4 v[68:71], v53, s[32:35], s78 offen offset:0 sc1
    buffer_load_dwordx4 v[76:79], v56, s[32:35], s77 offen offset:1024 sc1
    buffer_load_dwordx4 v[80:83], v53, s[32:35], s78 offen offset:1024 sc1
    buffer_load_dwordx4 v[88:91], v56, s[32:35], s77 offen offset:2048 sc1
    buffer_load_dwordx4 v[92:95], v53, s[32:35], s78 offen offset:2048 sc1
    buffer_load_dwordx4 v[100:103], v56, s[32:35], s77 offen offset:3072 sc1
    buffer_load_dwordx4 v[104:107], v53, s[32:35], s78 offen offset:3072 sc1
    s_waitcnt vmcnt(0)
    s_branch ck_19
ckrt_25:
    s_sub_i32 s52, s52, 1
    s_cmp_gt_i32 s52, 0
    s_cbranch_scc0 ckok_24
    s_sleep 2
    s_xor_b32 s77, s79, 266240
    s_add_u32 s78, s77, 32768
    buffer_load_dwordx4 v[112:115], v56, s[32:35], s77 offen offset:0 sc1
    buffer_load_dwordx4 v[116:119], v53, s[32:35], s78 offen offset:0 sc1
    buffer_load_dwordx4 v[124:127], v56, s[32:35], s77 offen offset:1024 sc1
    buffer_load_dwordx4 v[128:131], v53, s[32:35], s78 offen offset:1024 sc1
    buffer_load_dwordx4 v[136:139], v56, s[32:35], s77 offen offset:2048 sc1
    buffer_load_dwordx4 v[140:143], v53, s[32:35], s78 offen offset:2048 sc1
    buffer_load_dwordx4 v[148:151], v56, s[32:35], s77 offen offset:3072 sc1
    buffer_load_dwordx4 v[152:155], v53, s[32:35], s78 offen offset:3072 sc1
    s_waitcnt vmcnt(0)
    s_branch ck_23
ckrt_28:
    s_sub_i32 s52, s52, 1
    s_cmp_gt_i32 s52, 0
    s_cbranch_scc0 ckok_27
    s_sleep 2
    s_xor_b32 s77, s79, 327680
    s_add_u32 s78, s77, 32768
    buffer_load_dwordx4 v[160:163], v56, s[32:35], s77 offen offset:0 sc1
    buffer_load_dwordx4 v[164:167], v53, s[32:35], s78 offen offset:0 sc1
    buffer_load_dwordx4 v[172:175], v56, s[32:35], s77 offen offset:1024 sc1
    buffer_load_dwordx4 v[176:179], v53, s[32:35], s78 offen offset:1024 sc1
    buffer_load_dwordx4 v[184:187], v56, s[32:35], s77 offen offset:2048 sc1
    buffer_load_dwordx4 v[188:191], v53, s[32:35], s78 offen offset:2048 sc1
    buffer_load_dwordx4 v[196:199], v56, s[32:35], s77 offen offset:3072 sc1
    buffer_load_dwordx4 v[200:203], v53, s[32:35], s78 offen offset:3072 sc1
    s_waitcnt vmcnt(0)
    s_branch ck_26
ckrt_31:
    s_sub_i32 s52, s52, 1
    s_cmp_gt_i32 s52, 0
    s_cbranch_scc0 ckok_30
    s_sleep 2
    s_xor_b32 s77, s79, 331776
    s_add_u32 s78, s77, 32768
    buffer_load_dwordx4 v[208:211], v56, s[32:35], s77 offen offset:0 sc1
    buffer_load_dwordx4 v[212:215], v53, s[32:35], s78 offen offset:0 sc1
    buffer_load_dwordx4 v[220:223], v56, s[32:35], s77 offen offset:1024 sc1
    buffer_load_dwordx4 v[224:227], v53, s[32:35], s78 offen offset:1024 sc1
    buffer_load_dwordx4 v[232:235], v56, s[32:35], s77 offen offset:2048 sc1
    buffer_load_dwordx4 v[236:239], v53, s[32:35], s78 offen offset:2048 sc1
    buffer_load_dwordx4 v[244:247], v56, s[32:35], s77 offen offset:3072 sc1
    buffer_load_dwordx4 v[248:251], v53, s[32:35], s78 offen offset:3072 sc1
    s_waitcnt vmcnt(0)
    s_branch ck_29
gst_32:
gw_62:
    ds_read_b32 v55, v53 offset:16
    s_sub_i32 s52, s52, 1
    s_waitcnt lgkmcnt(0)
    v_readfirstlane_b32 s53, v55
    s_cmp_lt_u32 s53, EV_Q2
    s_cselect_b32 s53, s52, 0
    s_cmp_gt_i32 s53, 0
    s_cbranch_scc1 gw_62
    s_branch gbk_33
gst_34:
gw_63:
    ds_read_b32 v55, v53 offset:16
    s_sub_i32 s52, s52, 1
    s_waitcnt lgkmcnt(0)
    v_readfirstlane_b32 s53, v55
    s_cmp_lt_u32 s53, EV_R1
    s_cselect_b32 s53, s52, 0
    s_cmp_gt_i32 s53, 0
    s_cbranch_scc1 gw_63
    s_branch gbk_35
gst_36:
gw_64:
    ds_read_b32 v55, v53 offset:16
    s_sub_i32 s52, s52, 1
    s_waitcnt lgkmcnt(0)
    v_readfirstlane_b32 s53, v55
    s_cmp_lt_u32 s53, EV_R3
    s_cselect_b32 s53, s52, 0
    s_cmp_gt_i32 s53, 0
    s_cbranch_scc1 gw_64
    s_branch gbk_37
gst_38:
gw_65:
    ds_read_b32 v55, v53 offset:16
    s_sub_i32 s52, s52, 1
    s_waitcnt lgkmcnt(0)
    v_readfirstlane_b32 s53, v55
    s_cmp_lt_u32 s53, EV_Q8
    s_cselect_b32 s53, s52, 0
    s_cmp_gt_i32 s53, 0
    s_cbranch_scc1 gw_65
    s_branch gbk_39
ckrt_42:
    s_sub_i32 s52, s52, 1
    s_cmp_gt_i32 s52, 0
    s_cbranch_scc0 ckok_41
    s_sleep 2
    s_add_u32 s77, s76, 393216
    s_add_u32 s78, s76, 425984
    buffer_load_dwordx4 v[64:67], v56, s[32:35], s77 offen offset:0 sc1
    buffer_load_dwordx4 v[68:71], v53, s[32:35], s78 offen offset:0 sc1
    buffer_load_dwordx4 v[76:79], v56, s[32:35], s77 offen offset:1024 sc1
    buffer_load_dwordx4 v[80:83], v53, s[32:35], s78 offen offset:1024 sc1
    buffer_load_dwordx4 v[88:91], v56, s[32:35], s77 offen offset:2048 sc1
    buffer_load_dwordx4 v[92:95], v53, s[32:35], s78 offen offset:2048 sc1
    buffer_load_dwordx4 v[100:103], v56, s[32:35], s77 offen offset:3072 sc1
    buffer_load_dwordx4 v[104:107], v53, s[32:35], s78 offen offset:3072 sc1
    s_waitcnt vmcnt(0)
    s_branch ck_40
ckrt_45:
    s_sub_i32 s52, s52, 1
    s_cmp_gt_i32 s52, 0
    s_cbranch_scc0 ckok_44
    s_sleep 2
    s_add_u32 s77, s76, 397312
    s_add_u32 s78, s76, 430080
    buffer_load_dwordx4 v[112:115], v56, s[32:35], s77 offen offset:0 sc1
    buffer_load_dwordx4 v[116:119], v53, s[32:35], s78 offen offset:0 sc1
    buffer_load_dwordx4 v[124:127], v56, s[32:35], s77 offen offset:1024 sc1
    buffer_load_dwordx4 v[128:131], v53, s[32:35], s78 offen offset:1024 sc1
    buffer_load_dwordx4 v[136:139], v56, s[32:35], s77 offen offset:2048 sc1
    buffer_load_dwordx4 v[140:143], v53, s[32:35], s78 offen offset:2048 sc1
    buffer_load_dwordx4 v[148:151], v56, s[32:35], s77 offen offset:3072 sc1
    buffer_load_dwordx4 v[152:155], v53, s[32:35], s78 offen offset:3072 sc1
    s_waitcnt vmcnt(0)
    s_branch ck_43
gst_46:
gw_66:
    ds_read_b32 v55, v53 offset:16
    s_sub_i32 s52, s52, 1
    s_waitcnt lgkmcnt(0)
    v_readfirstlane_b32 s53, v55
    s_cmp_lt_u32 s53, EV_R7
    s_cselect_b32 s53, s52, 0
    s_cmp_gt_i32 s53, 0
    s_cbranch_scc1 gw_66
    s_branch gbk_47
kst_48:
    ds_read_b32 v55, v53 offset:32
    s_waitcnt lgkmcnt(0)
    v_readfirstlane_b32 s53, v55
    s_cmp_eq_u32 s53, 0
    s_cbranch_scc1 kbk_49
    s_mov_b32 s38, 268435456
    s_add_u32 s68, s76, 458752
    buffer_load_dwordx4 v[160:163], v56, s[32:35], s68 offen offset:0 sc1
    s_add_u32 s69, s76, 491520
    buffer_load_dwordx4 v[164:167], v53, s[32:35], s69 offen offset:0 sc1
    buffer_load_dwordx4 v[172:175], v56, s[32:35], s68 offen offset:1024 sc1
    buffer_load_dwordx4 v[176:179], v53, s[32:35], s69 offen offset:1024 sc1
    buffer_load_dwordx4 v[184:187], v56, s[32:35], s68 offen offset:2048 sc1
    buffer_load_dwordx4 v[188:191], v53, s[32:35], s69 offen offset:2048 sc1
    s_branch kbk_49
kst_50:
gw_67:
    ds_read_b32 v55, v53 offset:32
    s_sub_i32 s52, s52, 1
    s_waitcnt lgkmcnt(0)
    v_readfirstlane_b32 s53, v55
    s_cmp_lt_u32 s53, 1
    s_cselect_b32 s53, s52, 0
    s_cmp_gt_i32 s53, 0
    s_cbranch_scc1 gw_67
    s_mov_b32 s38, 268435456
    s_add_u32 s68, s76, 458752
    buffer_load_dwordx4 v[160:163], v56, s[32:35], s68 offen offset:0 sc1
    s_add_u32 s69, s76, 491520
    buffer_load_dwordx4 v[164:167], v53, s[32:35], s69 offen offset:0 sc1
    buffer_load_dwordx4 v[172:175], v56, s[32:35], s68 offen offset:1024 sc1
    buffer_load_dwordx4 v[176:179], v53, s[32:35], s69 offen offset:1024 sc1
    buffer_load_dwordx4 v[184:187], v56, s[32:35], s68 offen offset:2048 sc1
    buffer_load_dwordx4 v[188:191], v53, s[32:35], s69 offen offset:2048 sc1
    buffer_load_dwordx4 v[196:199], v56, s[32:35], s68 offen offset:3072 sc1
    buffer_load_dwordx4 v[200:203], v53, s[32:35], s69 offen offset:3072 sc1
    s_add_u32 s68, s76, 462848
    buffer_load_dwordx4 v[208:211], v56, s[32:35], s68 offen offset:0 sc1
    s_add_u32 s69, s76, 495616
    buffer_load_dwordx4 v[212:215], v53, s[32:35], s69 offen offset:0 sc1
    buffer_load_dwordx4 v[220:223], v56, s[32:35], s68 offen offset:1024 sc1
    buffer_load_dwordx4 v[224:227], v53, s[32:35], s69 offen offset:1024 sc1
    buffer_load_dwordx4 v[232:235], v56, s[32:35], s68 offen offset:2048 sc1
    buffer_load_dwordx4 v[236:239], v53, s[32:35], s69 offen offset:2048 sc1
    s_branch kbk_51
ckrt_54:
    s_sub_i32 s52, s52, 1
    s_cmp_gt_i32 s52, 0
    s_cbranch_scc0 ckok_53
    s_sleep 2
    s_add_u32 s77, s76, 458752
    s_add_u32 s78, s76, 491520
    buffer_load_dwordx4 v[160:163], v56, s[32:35], s77 offen offset:0 sc1
    buffer_load_dwordx4 v[164:167], v53, s[32:35], s78 offen offset:0 sc1
    buffer_load_dwordx4 v[172:175], v56, s[32:35], s77 offen offset:1024 sc1
    buffer_load_dwordx4 v[176:179], v53, s[32:35], s78 offen offset:1024 sc1
    buffer_load_dwordx4 v[184:187], v56, s[32:35], s77 offen offset:2048 sc1
    buffer_load_dwordx4 v[188:191], v53, s[32:35], s78 offen offset:2048 sc1
    buffer_load_dwordx4 v[196:199], v56, s[32:35], s77 offen offset:3072 sc1
    buffer_load_dwordx4 v[200:203], v53, s[32:35], s78 offen offset:3072 sc1
    s_waitcnt vmcnt(0)
    s_branch ck_52
ckrt_57:
    s_sub_i32 s52, s52, 1
    s_cmp_gt_i32 s52, 0
    s_cbranch_scc0 ckok_56
    s_sleep 2
    s_add_u32 s77, s76, 462848
    s_add_u32 s78, s76, 495616
    buffer_load_dwordx4 v[208:211], v56, s[32:35], s77 offen offset:0 sc1
    buffer_load_dwordx4 v[212:215], v53, s[32:35], s78 offen offset:0 sc1
    buffer_load_dwordx4 v[220:223], v56, s[32:35], s77 offen offset:1024 sc1
    buffer_load_dwordx4 v[224:227], v53, s[32:35], s78 offen offset:1024 sc1
    buffer_load_dwordx4 v[232:235], v56, s[32:35], s77 offen offset:2048 sc1
    buffer_load_dwordx4 v[236:239], v53, s[32:35], s78 offen offset:2048 sc1
    buffer_load_dwordx4 v[244:247], v56, s[32:35], s77 offen offset:3072 sc1
    buffer_load_dwordx4 v[248:251], v53, s[32:35], s78 offen offset:3072 sc1
    s_waitcnt vmcnt(0)
    s_branch ck_55
gst_58:
gw_68:
    ds_read_b32 v55, v53 offset:16
    s_sub_i32 s52, s52, 1
    s_waitcnt lgkmcnt(0)
    v_readfirstlane_b32 s53, v55
    s_cmp_lt_u32 s53, EV_Q12
    s_cselect_b32 s53, s52, 0
    s_cmp_gt_i32 s53, 0
    s_cbranch_scc1 gw_68
    s_branch gbk_59
gst_60:
gw_69:
    ds_read_b32 v55, v53 offset:16
    s_sub_i32 s52, s52, 1
    s_waitcnt lgkmcnt(0)
    v_readfirstlane_b32 s53, v55
    s_cmp_lt_u32 s53, EV_R11
    s_cselect_b32 s53, s52, 0
    s_cmp_gt_i32 s53, 0
    s_cbranch_scc1 gw_69
    s_branch gbk_61
H_MAIN:
gw_70:
    ds_read_b32 v141, v129 offset:16
    s_sub_i32 s52, s52, 1
    s_waitcnt lgkmcnt(0)
    v_readfirstlane_b32 s53, v141
    s_cmp_lt_u32 s53, 8
    s_cselect_b32 s53, s52, 0
    s_cmp_gt_i32 s53, 0
    s_cbranch_scc1 gw_70
gw_71:
    s_sleep 1
    ds_read_b32 v141, v129 offset:48
    s_sub_i32 s52, s52, 1
    s_waitcnt lgkmcnt(0)
    v_readfirstlane_b32 s53, v141
    s_cmp_lt_u32 s53, 4
    s_cselect_b32 s53, s52, 0
    s_cmp_gt_i32 s53, 0
    s_cbranch_scc1 gw_71
    s_xor_b32 s53, s87, 0
    s_add_u32 m0, s66, s53
    s_xor_b32 s53, s68, 128
    buffer_load_dwordx4 v148, s[40:43], s53 offen offset:0 lds
    buffer_load_dwordx4 v149, s[40:43], s53 offen offset:1024 lds
    buffer_load_dwordx4 v150, s[40:43], s53 offen offset:2048 lds
    buffer_load_dwordx4 v151, s[40:43], s53 offen offset:3072 lds
    s_xor_b32 s53, s87, 4096
    s_add_u32 m0, s66, s53
    s_xor_b32 s53, s68, 32896
    buffer_load_dwordx4 v148, s[40:43], s53 offen offset:0 lds
    buffer_load_dwordx4 v149, s[40:43], s53 offen offset:1024 lds
    buffer_load_dwordx4 v150, s[40:43], s53 offen offset:2048 lds
    buffer_load_dwordx4 v151, s[40:43], s53 offen offset:3072 lds
    s_xor_b32 s53, s87, 8192
    s_add_u32 m0, s66, s53
    s_xor_b32 s53, s68, 65664
    buffer_load_dwordx4 v148, s[40:43], s53 offen offset:0 lds
    buffer_load_dwordx4 v149, s[40:43], s53 offen offset:1024 lds
    buffer_load_dwordx4 v150, s[40:43], s53 offen offset:2048 lds
    buffer_load_dwordx4 v151, s[40:43], s53 offen offset:3072 lds
    s_waitcnt vmcnt(8)
    s_xor_b32 s53, s87, 12288
    s_add_u32 m0, s66, s53
    s_xor_b32 s53, s68, 98432
    buffer_load_dwordx4 v148, s[40:43], s53 offen offset:0 lds
    buffer_load_dwordx4 v149, s[40:43], s53 offen offset:1024 lds
    buffer_load_dwordx4 v150, s[40:43], s53 offen offset:2048 lds
    buffer_load_dwordx4 v151, s[40:43], s53 offen offset:3072 lds
    s_branch TCH
TCHB:
    s_waitcnt vmcnt(0)
    s_mov_b64 exec, 2
    ds_add_u32 v129, v128 offset:0
    s_mov_b64 exec, -1
    global_load_dwordx4 v[176:179], v248, s[22:23] offset:0
    global_load_dwordx4 v[180:183], v248, s[22:23] offset:1024
    global_load_dwordx4 v[184:187], v248, s[22:23] offset:2048
    global_load_dwordx4 v[188:191], v248, s[22:23] offset:3072
    global_load_ushort v192, v249, s[24:25]
gw_72:
    ds_read_b32 v141, v129 offset:16
    s_sub_i32 s52, s52, 1
    s_waitcnt lgkmcnt(0)
    v_readfirstlane_b32 s53, v141
    s_cmp_lt_u32 s53, 12
    s_cselect_b32 s53, s52, 0
    s_cmp_gt_i32 s53, 0
    s_cbranch_scc1 gw_72
    ds_read_b64_tr_b16 v[64:65], v152 offset:0
    ds_read_b64_tr_b16 v[66:67], v152 offset:512
    ds_read_b128 v[196:199], v130 offset:11776
    ds_read_b128 v[200:203], v130 offset:47104
    ds_read_b64_tr_b16 v[68:69], v152 offset:4096
    ds_read_b64_tr_b16 v[70:71], v152 offset:4608
    ds_read_b128 v[204:207], v130 offset:11840
    ds_read_b128 v[208:211], v130 offset:47168
    ds_read_b64_tr_b16 v[72:73], v152 offset:8192
    ds_read_b64_tr_b16 v[74:75], v152 offset:8704
    ds_read_b128 v[212:215], v130 offset:11904
    ds_read_b128 v[216:219], v130 offset:47232
    s_waitcnt lgkmcnt(8)
    v_mfma_f32_16x16x32_bf16 v[228:231], v[64:67], v[196:199], 0
    v_mfma_f32_16x16x32_bf16 v[232:235], v[64:67], v[200:203], 0
    ds_read_b64_tr_b16 v[76:77], v152 offset:12288
    ds_read_b64_tr_b16 v[78:79], v152 offset:12800
    ds_read_b128 v[220:223], v130 offset:11968
    ds_read_b128 v[224:227], v130 offset:47296
    s_waitcnt lgkmcnt(8)
    v_mfma_f32_16x16x32_bf16 v[228:231], v[68:71], v[204:207], v[228:231]
    v_mfma_f32_16x16x32_bf16 v[232:235], v[68:71], v[208:211], v[232:235]
    ds_read_b64_tr_b16 v[80:81], v152 offset:24576
    ds_read_b64_tr_b16 v[82:83], v152 offset:25088
    ds_read_b128 v[196:199], v130 offset:12032
    ds_read_b128 v[200:203], v130 offset:47360
    s_waitcnt lgkmcnt(8)
    v_mfma_f32_16x16x32_bf16 v[228:231], v[72:75], v[212:215], v[228:231]
    v_mfma_f32_16x16x32_bf16 v[232:235], v[72:75], v[216:219], v[232:235]
    ds_read_b64_tr_b16 v[84:85], v152 offset:28672
    ds_read_b64_tr_b16 v[86:87], v152 offset:29184
    ds_read_b128 v[204:207], v130 offset:12096
    ds_read_b128 v[208:211], v130 offset:47424
    s_waitcnt lgkmcnt(8)
    v_mfma_f32_16x16x32_bf16 v[228:231], v[76:79], v[220:223], v[228:231]
    v_mfma_f32_16x16x32_bf16 v[232:235], v[76:79], v[224:227], v[232:235]
    ds_read_b64_tr_b16 v[88:89], v152 offset:32768
    ds_read_b64_tr_b16 v[90:91], v152 offset:33280
    ds_read_b128 v[212:215], v130 offset:12160
    ds_read_b128 v[216:219], v130 offset:47488
    s_waitcnt lgkmcnt(8)
    v_mfma_f32_16x16x32_bf16 v[228:231], v[80:83], v[196:199], v[228:231]
    v_mfma_f32_16x16x32_bf16 v[232:235], v[80:83], v[200:203], v[232:235]
    ds_read_b64_tr_b16 v[92:93], v152 offset:36864
    ds_read_b64_tr_b16 v[94:95], v152 offset:37376
    ds_read_b128 v[220:223], v130 offset:12224
    ds_read_b128 v[224:227], v130 offset:47552
    s_waitcnt lgkmcnt(8)
    v_mfma_f32_16x16x32_bf16 v[228:231], v[84:87], v[204:207], v[228:231]
    v_mfma_f32_16x16x32_bf16 v[232:235], v[84:87], v[208:211], v[232:235]
    ds_read_b64_tr_b16 v[96:97], v153 offset:0
    ds_read_b64_tr_b16 v[98:99], v153 offset:512
    ds_read_b128 v[196:199], v130 offset:12288
    ds_read_b128 v[200:203], v130 offset:47616
    s_waitcnt lgkmcnt(8)
    v_mfma_f32_16x16x32_bf16 v[228:231], v[88:91], v[212:215], v[228:231]
    v_mfma_f32_16x16x32_bf16 v[232:235], v[88:91], v[216:219], v[232:235]
    ds_read_b64_tr_b16 v[100:101], v153 offset:4096
    ds_read_b64_tr_b16 v[102:103], v153 offset:4608
    ds_read_b128 v[204:207], v130 offset:12352
    ds_read_b128 v[208:211], v130 offset:47680
    s_waitcnt lgkmcnt(8)
    v_mfma_f32_16x16x32_bf16 v[228:231], v[92:95], v[220:223], v[228:231]
    v_mfma_f32_16x16x32_bf16 v[232:235], v[92:95], v[224:227], v[232:235]
    ds_read_b64_tr_b16 v[104:105], v153 offset:8192
    ds_read_b64_tr_b16 v[106:107], v153 offset:8704
    ds_read_b128 v[212:215], v130 offset:12416
    ds_read_b128 v[216:219], v130 offset:47744
    s_waitcnt lgkmcnt(8)
    v_mfma_f32_16x16x32_bf16 v[228:231], v[96:99], v[196:199], v[228:231]
    v_mfma_f32_16x16x32_bf16 v[232:235], v[96:99], v[200:203], v[232:235]
    ds_read_b64_tr_b16 v[108:109], v153 offset:12288
    ds_read_b64_tr_b16 v[110:111], v153 offset:12800
    ds_read_b128 v[220:223], v130 offset:12480
    ds_read_b128 v[224:227], v130 offset:47808
    buffer_load_dword v166, v194, s[32:35], s69 offen sc1
    buffer_load_dword v167, v164, s[32:35], s70 offen sc1
    buffer_load_dword v168, v165, s[32:35], s71 offen sc1
    s_waitcnt lgkmcnt(8)
    v_mfma_f32_16x16x32_bf16 v[228:231], v[100:103], v[204:207], v[228:231]
    v_mfma_f32_16x16x32_bf16 v[232:235], v[100:103], v[208:211], v[232:235]
    ds_read_b64_tr_b16 v[112:113], v153 offset:24576
    ds_read_b64_tr_b16 v[114:115], v153 offset:25088
    ds_read_b128 v[196:199], v130 offset:12544
    ds_read_b128 v[200:203], v130 offset:47872
    s_waitcnt lgkmcnt(8)
    v_mfma_f32_16x16x32_bf16 v[228:231], v[104:107], v[212:215], v[228:231]
    v_mfma_f32_16x16x32_bf16 v[232:235], v[104:107], v[216:219], v[232:235]
    ds_read_b64_tr_b16 v[116:117], v153 offset:28672
    ds_read_b64_tr_b16 v[118:119], v153 offset:29184
    ds_read_b128 v[204:207], v130 offset:12608
    ds_read_b128 v[208:211], v130 offset:47936
    s_waitcnt lgkmcnt(8)
    v_mfma_f32_16x16x32_bf16 v[228:231], v[108:111], v[220:223], v[228:231]
    v_mfma_f32_16x16x32_bf16 v[232:235], v[108:111], v[224:227], v[232:235]
    ds_read_b64_tr_b16 v[120:121], v153 offset:32768
    ds_read_b64_tr_b16 v[122:123], v153 offset:33280
PAD7:
    s_cbranch_execz PADRET
    ds_read_b128 v[212:215], v130 offset:12672
    ds_read_b128 v[216:219], v130 offset:48000
    s_waitcnt lgkmcnt(8)
    v_mfma_f32_16x16x32_bf16 v[228:231], v[112:115], v[196:199], v[228:231]
    v_mfma_f32_16x16x32_bf16 v[232:235], v[112:115], v[200:203], v[232:235]
    ds_read_b64_tr_b16 v[124:125], v153 offset:36864
    ds_read_b64_tr_b16 v[126:127], v153 offset:37376
    ds_read_b128 v[220:223], v130 offset:12736
    ds_read_b128 v[224:227], v130 offset:48064
    s_waitcnt lgkmcnt(8)
    v_mfma_f32_16x16x32_bf16 v[228:231], v[116:119], v[204:207], v[228:231]
    v_mfma_f32_16x16x32_bf16 v[232:235], v[116:119], v[208:211], v[232:235]
    s_waitcnt lgkmcnt(4)
    v_mfma_f32_16x16x32_bf16 v[228:231], v[120:123], v[212:215], v[228:231]
    v_mfma_f32_16x16x32_bf16 v[232:235], v[120:123], v[216:219], v[232:235]
    s_waitcnt lgkmcnt(0)
    v_mfma_f32_16x16x32_bf16 v[228:231], v[124:127], v[220:223], v[228:231]
    v_mfma_f32_16x16x32_bf16 v[232:235], v[124:127], v[224:227], v[232:235]
    s_setprio 2
    s_waitcnt vmcnt(3)
    v_mov_b64 v[196:197], 0
    v_mov_b64 v[198:199], 0
    v_lshl_or_b32 v192, v192, 16, v192
    v_and_b32 v244, v244, v192
    v_and_b32 v245, v245, v192
    v_and_b32 v246, v246, v192
    v_and_b32 v247, v247, v192
    v_pk_mul_f32 v[228:229], v[228:229], s[72:73] op_sel_hi:[1,0]
    v_pk_mul_f32 v[230:231], v[230:231], s[72:73] op_sel_hi:[1,0]
    v_pk_mul_f32 v[232:233], v[232:233], s[72:73] op_sel_hi:[1,0]
    v_pk_mul_f32 v[234:235], v[234:235], s[72:73] op_sel_hi:[1,0]
    v_cvt_pk_bf16_f32 v228, v228, v229
    v_cvt_pk_bf16_f32 v229, v230, v231
    v_cvt_pk_bf16_f32 v230, v232, v233
    v_cvt_pk_bf16_f32 v231, v234, v235
    ds_write_b64 v154, v[228:229] offset:5632
    ds_write_b64 v131, v[230:231] offset:7936
    s_mov_b64 exec, 2
    ds_add_u32 v129, v128 offset:0
    s_mov_b64 exec, -1
    s_waitcnt vmcnt(0)
ck_73:
    v_xor_b32 v166, s51, v166
    v_bitop3_b32 v166, v167, s51, v166 bitop3:0xbe
    v_bitop3_b32 v166, v168, s51, v166 bitop3:0xbe
    v_cmp_ne_u32 vcc, 0, v166
    s_cbranch_vccnz ckrt_75
ckok_74:
    s_lshl_b32 s53, s49, 19
    s_lshl_b32 s54, s2, 5
    s_add_u32 s53, s53, s54
    s_add_u32 s71, s53, 2097152
    s_add_u32 s56, s71, 262144
    buffer_load_dwordx4 v[156:159], v193, s[32:35], s71 offen sc1
    buffer_load_dwordx4 v[160:163], v193, s[32:35], s56 offen sc1
    v_lshlrev_b32 v164, 2, v195
    s_and_b32 s53, s2, 0x1c
    s_lshl_b32 s53, s53, 10
    s_add_u32 m0, s66, 20480
    s_add_u32 s53, s53, s77
    buffer_load_dword v164, s[32:35], s53 offen sc1 lds
    s_mov_b64 exec, 0xffff
    ds_write_b128 v139, v[196:199] offset:16640
    ds_write_b128 v139, v[196:199] offset:17920
    s_mov_b64 exec, -1
    v_alignbit_b32 v201, v177, v176, 16
    v_alignbit_b32 v202, v178, v177, 16
    v_alignbit_b32 v203, v179, v178, 16
    v_alignbit_b32 v205, v181, v180, 16
    v_alignbit_b32 v206, v182, v181, 16
    v_alignbit_b32 v207, v183, v182, 16
    v_alignbit_b32 v209, v185, v184, 16
    v_alignbit_b32 v210, v186, v185, 16
    v_alignbit_b32 v211, v187, v186, 16
    v_alignbit_b32 v213, v189, v188, 16
    v_alignbit_b32 v214, v190, v189, 16
    v_alignbit_b32 v215, v191, v190, 16
gw_76:
    ds_read_b32 v141, v129 offset:16
    s_sub_i32 s52, s52, 1
    s_waitcnt lgkmcnt(0)
    v_readfirstlane_b32 s53, v141
    s_cmp_lt_u32 s53, 16
    s_cselect_b32 s53, s52, 0
    s_cmp_gt_i32 s53, 0
    s_cbranch_scc1 gw_76
    s_mov_b64 exec, 1
    ds_write_b128 v139, v[196:199] offset:8192
    ds_write_b128 v139, v[196:199] offset:12352
    s_mov_b64 exec, -1
    ds_write_b128 v139, v[176:179] offset:8208
    ds_write_b128 v139, v[180:183] offset:9232
    ds_write_b128 v139, v[184:187] offset:10256
    ds_write_b128 v139, v[188:191] offset:11280
    ds_read_b32 v220, v139 offset:8204
    ds_read_b32 v221, v139 offset:9228
    ds_read_b32 v222, v139 offset:10252
    ds_read_b32 v223, v139 offset:11276
    s_waitcnt lgkmcnt(0)
    v_alignbit_b32 v200, v176, v220, 16
    ds_write_b128 v139, v[200:203] offset:12368
    v_alignbit_b32 v204, v180, v221, 16
    ds_write_b128 v139, v[204:207] offset:13392
    v_alignbit_b32 v208, v184, v222, 16
    ds_write_b128 v139, v[208:211] offset:14416
    v_alignbit_b32 v212, v188, v223, 16
    ds_write_b128 v139, v[212:215] offset:15440
    s_waitcnt vmcnt(1)
    ds_write_b128 v250, v[156:159]
    ds_write_b128 v250, v[160:163] offset:128
    s_mov_b64 exec, 2
    ds_add_u32 v129, v128 offset:0
    s_mov_b64 exec, -1
gw_77:
    ds_read_b32 v141, v129 offset:16
    s_sub_i32 s52, s52, 1
    s_waitcnt lgkmcnt(0)
    v_readfirstlane_b32 s53, v141
    s_cmp_lt_u32 s53, 20
    s_cselect_b32 s53, s52, 0
    s_cmp_gt_i32 s53, 0
    s_cbranch_scc1 gw_77
    v_mov_b32 v141, s51
    ds_read_b128 v[236:239], v142 offset:224
    ds_read_b128 v[240:243], v142 offset:480
    ds_read_b128 v[228:231], v142 offset:736
    ds_read_b128 v[232:235], v142 offset:992
    ds_read2_b32 v[224:225], v255 offset0:0 offset1:1
    ds_read2_b32 v[226:227], v255 offset0:2 offset1:3
    ds_read2_b32 v[220:221], v254 offset0:0 offset1:1
    ds_read2_b32 v[222:223], v254 offset0:2 offset1:3
    ds_read2_b32 v[216:217], v253 offset0:0 offset1:1
    ds_read2_b32 v[218:219], v253 offset0:2 offset1:3
    s_waitcnt lgkmcnt(9)
    v_mfma_f32_32x32x16_bf16 v[148:163], v[244:247], v[236:239], 0
    s_waitcnt lgkmcnt(8)
    v_mfma_f32_32x32x16_bf16 v[164:179], v[244:247], v[240:243], 0
    s_waitcnt lgkmcnt(7)
    v_mfma_f32_32x32x16_bf16 v[180:195], v[244:247], v[228:231], 0
    s_waitcnt lgkmcnt(6)
    v_mfma_f32_32x32x16_bf16 v[196:211], v[244:247], v[232:235], 0
    s_setprio 0
    s_lshl_b32 s53, s80, 14
    s_add_u32 s53, s53, s74
    s_add_u32 s54, s53, 0
    buffer_store_dwordx4 v[144:147], v129, s[32:35], s54 offen sc1
    s_add_u32 s54, s53, 4194304
    buffer_store_dwordx4 v[144:147], v129, s[32:35], s54 offen sc1
    s_waitcnt lgkmcnt(4)
    v_mfma_f32_32x32x16_bf16 v[196:211], v[224:227], v[236:239], v[196:211]
    ds_read2_b32 v[212:213], v252 offset0:0 offset1:1
    ds_read2_b32 v[214:215], v252 offset0:2 offset1:3
    s_waitcnt lgkmcnt(4)
    v_mfma_f32_32x32x16_bf16 v[196:211], v[220:223], v[240:243], v[196:211]
    ds_read2_b32 v[224:225], v255 offset0:32 offset1:33
    ds_read2_b32 v[226:227], v255 offset0:34 offset1:35
    ds_read_b128 v[244:247], v142 offset:192
    v_mfma_f32_32x32x16_bf16 v[180:195], v[220:223], v[236:239], v[180:195]
    s_waitcnt lgkmcnt(5)
    v_mfma_f32_32x32x16_bf16 v[196:211], v[216:219], v[228:231], v[196:211]
    ds_read2_b32 v[220:221], v254 offset0:32 offset1:33
    ds_read2_b32 v[222:223], v254 offset0:34 offset1:35
    ds_read_b128 v[248:251], v142 offset:448
    v_mfma_f32_32x32x16_bf16 v[180:195], v[216:219], v[240:243], v[180:195]
    v_mfma_f32_32x32x16_bf16 v[164:179], v[216:219], v[236:239], v[164:179]
    s_waitcnt lgkmcnt(6)
    v_mfma_f32_32x32x16_bf16 v[196:211], v[212:215], v[232:235], v[196:211]
    ds_read2_b32 v[216:217], v253 offset0:32 offset1:33
    ds_read2_b32 v[218:219], v253 offset0:34 offset1:35
    v_mfma_f32_32x32x16_bf16 v[180:195], v[212:215], v[228:231], v[180:195]
    v_mfma_f32_32x32x16_bf16 v[164:179], v[212:215], v[240:243], v[164:179]
    ds_read_b128 v[228:231], v142 offset:704
    ds_read_b128 v[232:235], v142 offset:960
    v_mfma_f32_32x32x16_bf16 v[148:163], v[212:215], v[236:239], v[148:163]
    s_lshl_b32 s53, s81, 14
    s_add_u32 s53, s53, s74
    s_add_u32 s54, s53, 0
    buffer_store_dwordx4 v[144:147], v129, s[32:35], s54 offen sc1
    s_add_u32 s54, s53, 4194304
    buffer_store_dwordx4 v[144:147], v129, s[32:35], s54 offen sc1
    s_waitcnt lgkmcnt(7)
    v_mfma_f32_32x32x16_bf16 v[196:211], v[224:227], v[244:247], v[196:211]
    ds_read2_b32 v[212:213], v252 offset0:32 offset1:33
    ds_read2_b32 v[214:215], v252 offset0:34 offset1:35
    s_waitcnt lgkmcnt(6)
    v_mfma_f32_32x32x16_bf16 v[196:211], v[220:223], v[248:251], v[196:211]
    ds_read2_b32 v[224:225], v255 offset0:64 offset1:65
    ds_read2_b32 v[226:227], v255 offset0:66 offset1:67
    ds_read_b128 v[236:239], v142 offset:160
    v_mfma_f32_32x32x16_bf16 v[180:195], v[220:223], v[244:247], v[180:195]
    s_waitcnt lgkmcnt(6)
    v_mfma_f32_32x32x16_bf16 v[196:211], v[216:219], v[228:231], v[196:211]
    ds_read2_b32 v[220:221], v254 offset0:64 offset1:65
    ds_read2_b32 v[222:223], v254 offset0:66 offset1:67
    ds_read_b128 v[240:243], v142 offset:416
    v_mfma_f32_32x32x16_bf16 v[180:195], v[216:219], v[248:251], v[180:195]
    v_mfma_f32_32x32x16_bf16 v[164:179], v[216:219], v[244:247], v[164:179]
    s_waitcnt lgkmcnt(6)
    v_mfma_f32_32x32x16_bf16 v[196:211], v[212:215], v[232:235], v[196:211]
    ds_read2_b32 v[216:217], v253 offset0:64 offset1:65
    ds_read2_b32 v[218:219], v253 offset0:66 offset1:67
    v_mfma_f32_32x32x16_bf16 v[180:195], v[212:215], v[228:231], v[180:195]
    v_mfma_f32_32x32x16_bf16 v[164:179], v[212:215], v[248:251], v[164:179]
    ds_read_b128 v[228:231], v142 offset:672
    ds_read_b128 v[232:235], v142 offset:928
    v_mfma_f32_32x32x16_bf16 v[148:163], v[212:215], v[244:247], v[148:163]
    s_lshl_b32 s53, s82, 14
    s_add_u32 s53, s53, s74
    s_add_u32 s54, s53, 0
    buffer_store_dwordx4 v[144:147], v129, s[32:35], s54 offen sc1
    s_add_u32 s54, s53, 4194304
    buffer_store_dwordx4 v[144:147], v129, s[32:35], s54 offen sc1
    s_waitcnt lgkmcnt(7)
    v_mfma_f32_32x32x16_bf16 v[196:211], v[224:227], v[236:239], v[196:211]
    ds_read2_b32 v[212:213], v252 offset0:64 offset1:65
    ds_read2_b32 v[214:215], v252 offset0:66 offset1:67
    s_waitcnt lgkmcnt(6)
    v_mfma_f32_32x32x16_bf16 v[196:211], v[220:223], v[240:243], v[196:211]
    ds_read2_b32 v[224:225], v255 offset0:96 offset1:97
    ds_read2_b32 v[226:227], v255 offset0:98 offset1:99
    ds_read_b128 v[244:247], v142 offset:128
    v_mfma_f32_32x32x16_bf16 v[180:195], v[220:223], v[236:239], v[180:195]
    s_waitcnt lgkmcnt(6)
    v_mfma_f32_32x32x16_bf16 v[196:211], v[216:219], v[228:231], v[196:211]
    ds_read2_b32 v[220:221], v254 offset0:96 offset1:97
    ds_read2_b32 v[222:223], v254 offset0:98 offset1:99
    ds_read_b128 v[248:251], v142 offset:384
    v_mfma_f32_32x32x16_bf16 v[180:195], v[216:219], v[240:243], v[180:195]
    v_mfma_f32_32x32x16_bf16 v[164:179], v[216:219], v[236:239], v[164:179]
    s_waitcnt lgkmcnt(6)
    v_mfma_f32_32x32x16_bf16 v[196:211], v[212:215], v[232:235], v[196:211]
    ds_read2_b32 v[216:217], v253 offset0:96 offset1:97
    ds_read2_b32 v[218:219], v253 offset0:98 offset1:99
    v_mfma_f32_32x32x16_bf16 v[180:195], v[212:215], v[228:231], v[180:195]
    v_mfma_f32_32x32x16_bf16 v[164:179], v[212:215], v[240:243], v[164:179]
    ds_read_b128 v[228:231], v142 offset:640
    ds_read_b128 v[232:235], v142 offset:896
    v_mfma_f32_32x32x16_bf16 v[148:163], v[212:215], v[236:239], v[148:163]
    s_add_u32 s54, s57, 8388608
    buffer_store_dwordx4 v[144:147], v129, s[32:35], s54 offen sc1
    s_add_u32 s54, s57, 8392704
    buffer_store_dwordx4 v[144:147], v129, s[32:35], s54 offen sc1
    s_waitcnt lgkmcnt(7)
    v_mfma_f32_32x32x16_bf16 v[196:211], v[224:227], v[244:247], v[196:211]
    ds_read2_b32 v[212:213], v252 offset0:96 offset1:97
    ds_read2_b32 v[214:215], v252 offset0:98 offset1:99
    s_waitcnt lgkmcnt(6)
    v_mfma_f32_32x32x16_bf16 v[196:211], v[220:223], v[248:251], v[196:211]
    ds_read2_b32 v[224:225], v255 offset0:128 offset1:129
    ds_read2_b32 v[226:227], v255 offset0:130 offset1:131
    ds_read_b128 v[236:239], v142 offset:96
    v_mfma_f32_32x32x16_bf16 v[180:195], v[220:223], v[244:247], v[180:195]
    s_waitcnt lgkmcnt(6)
    v_mfma_f32_32x32x16_bf16 v[196:211], v[216:219], v[228:231], v[196:211]
    ds_read2_b32 v[220:221], v254 offset0:128 offset1:129
    ds_read2_b32 v[222:223], v254 offset0:130 offset1:131
    ds_read_b128 v[240:243], v142 offset:352
    v_mfma_f32_32x32x16_bf16 v[180:195], v[216:219], v[248:251], v[180:195]
    v_mfma_f32_32x32x16_bf16 v[164:179], v[216:219], v[244:247], v[164:179]
    s_waitcnt lgkmcnt(6)
    v_mfma_f32_32x32x16_bf16 v[196:211], v[212:215], v[232:235], v[196:211]
    ds_read2_b32 v[216:217], v253 offset0:128 offset1:129
    ds_read2_b32 v[218:219], v253 offset0:130 offset1:131
    v_mfma_f32_32x32x16_bf16 v[180:195], v[212:215], v[228:231], v[180:195]
    v_mfma_f32_32x32x16_bf16 v[164:179], v[212:215], v[248:251], v[164:179]
    ds_read_b128 v[228:231], v142 offset:608
    ds_read_b128 v[232:235], v142 offset:864
    v_mfma_f32_32x32x16_bf16 v[148:163], v[212:215], v[244:247], v[148:163]
    s_lshl_b32 s53, s49, 10
    s_add_u32 s53, s53, s57
    s_add_u32 s53, s53, 4194304
    buffer_store_dwordx4 v[144:147], v129, s[32:35], s53 offen offset:0 sc1
    buffer_store_dwordx4 v[144:147], v129, s[32:35], s53 offen offset:1024 sc1
    s_waitcnt lgkmcnt(7)
    v_mfma_f32_32x32x16_bf16 v[196:211], v[224:227], v[236:239], v[196:211]
    ds_read2_b32 v[212:213], v252 offset0:128 offset1:129
    ds_read2_b32 v[214:215], v252 offset0:130 offset1:131
    s_waitcnt lgkmcnt(6)
    v_mfma_f32_32x32x16_bf16 v[196:211], v[220:223], v[240:243], v[196:211]
    ds_read2_b32 v[224:225], v255 offset0:160 offset1:161
    ds_read2_b32 v[226:227], v255 offset0:162 offset1:163
    ds_read_b128 v[244:247], v142 offset:64
    v_mfma_f32_32x32x16_bf16 v[180:195], v[220:223], v[236:239], v[180:195]
    s_waitcnt lgkmcnt(6)
    v_mfma_f32_32x32x16_bf16 v[196:211], v[216:219], v[228:231], v[196:211]
    ds_read2_b32 v[220:221], v254 offset0:160 offset1:161
    ds_read2_b32 v[222:223], v254 offset0:162 offset1:163
    ds_read_b128 v[248:251], v142 offset:320
    v_mfma_f32_32x32x16_bf16 v[180:195], v[216:219], v[240:243], v[180:195]
    v_mfma_f32_32x32x16_bf16 v[164:179], v[216:219], v[236:239], v[164:179]
    s_waitcnt lgkmcnt(6)
    v_mfma_f32_32x32x16_bf16 v[196:211], v[212:215], v[232:235], v[196:211]
    ds_read2_b32 v[216:217], v253 offset0:160 offset1:161
    ds_read2_b32 v[218:219], v253 offset0:162 offset1:163
    v_mfma_f32_32x32x16_bf16 v[180:195], v[212:215], v[228:231], v[180:195]
    v_mfma_f32_32x32x16_bf16 v[164:179], v[212:215], v[240:243], v[164:179]
    ds_read_b128 v[228:231], v142 offset:576
    ds_read_b128 v[232:235], v142 offset:832
    v_mfma_f32_32x32x16_bf16 v[148:163], v[212:215], v[236:239], v[148:163]
    s_add_u32 m0, s66, 0
    s_add_u32 s53, s77, 0
    buffer_load_dwordx4 v129, s[32:35], s53 offen offset:0 sc1 lds
    buffer_load_dwordx4 v129, s[32:35], s53 offen offset:1024 sc1 lds
    buffer_load_dwordx4 v129, s[32:35], s53 offen offset:2048 sc1 lds
    buffer_load_dwordx4 v129, s[32:35], s53 offen offset:3072 sc1 lds
    s_waitcnt lgkmcnt(7)
    v_mfma_f32_32x32x16_bf16 v[196:211], v[224:227], v[244:247], v[196:211]
    ds_read2_b32 v[212:213], v252 offset0:160 offset1:161
    ds_read2_b32 v[214:215], v252 offset0:162 offset1:163
    s_waitcnt lgkmcnt(6)
    v_mfma_f32_32x32x16_bf16 v[196:211], v[220:223], v[248:251], v[196:211]
    ds_read2_b32 v[224:225], v255 offset0:192 offset1:193
    ds_read2_b32 v[226:227], v255 offset0:194 offset1:195
    ds_read_b128 v[236:239], v142 offset:32
    v_mfma_f32_32x32x16_bf16 v[180:195], v[220:223], v[244:247], v[180:195]
    s_waitcnt lgkmcnt(6)
    v_mfma_f32_32x32x16_bf16 v[196:211], v[216:219], v[228:231], v[196:211]
    ds_read2_b32 v[220:221], v254 offset0:192 offset1:193
    ds_read2_b32 v[222:223], v254 offset0:194 offset1:195
    ds_read_b128 v[240:243], v142 offset:288
    v_mfma_f32_32x32x16_bf16 v[180:195], v[216:219], v[248:251], v[180:195]
    v_mfma_f32_32x32x16_bf16 v[164:179], v[216:219], v[244:247], v[164:179]
    s_waitcnt lgkmcnt(6)
    v_mfma_f32_32x32x16_bf16 v[196:211], v[212:215], v[232:235], v[196:211]
    ds_read2_b32 v[216:217], v253 offset0:192 offset1:193
    ds_read2_b32 v[218:219], v253 offset0:194 offset1:195
    v_mfma_f32_32x32x16_bf16 v[180:195], v[212:215], v[228:231], v[180:195]
    v_mfma_f32_32x32x16_bf16 v[164:179], v[212:215], v[248:251], v[164:179]
    ds_read_b128 v[228:231], v142 offset:544
    ds_read_b128 v[232:235], v142 offset:800
    v_mfma_f32_32x32x16_bf16 v[148:163], v[212:215], v[244:247], v[148:163]
    s_add_u32 m0, s66, 4096
    s_add_u32 s53, s77, 4096
    buffer_load_dwordx4 v129, s[32:35], s53 offen offset:0 sc1 lds
    buffer_load_dwordx4 v129, s[32:35], s53 offen offset:1024 sc1 lds
    buffer_load_dwordx4 v129, s[32:35], s53 offen offset:2048 sc1 lds
    buffer_load_dwordx4 v129, s[32:35], s53 offen offset:3072 sc1 lds
    s_waitcnt lgkmcnt(7)
    v_mfma_f32_32x32x16_bf16 v[196:211], v[224:227], v[236:239], v[196:211]
    ds_read2_b32 v[212:213], v252 offset0:192 offset1:193
    ds_read2_b32 v[214:215], v252 offset0:194 offset1:195
    s_waitcnt lgkmcnt(6)
    v_mfma_f32_32x32x16_bf16 v[196:211], v[220:223], v[240:243], v[196:211]
    ds_read2_b32 v[224:225], v255 offset0:224 offset1:225
    ds_read2_b32 v[226:227], v255 offset0:226 offset1:227
    ds_read_b128 v[244:247], v142 offset:0
    v_mfma_f32_32x32x16_bf16 v[180:195], v[220:223], v[236:239], v[180:195]
    s_waitcnt lgkmcnt(6)
    v_mfma_f32_32x32x16_bf16 v[196:211], v[216:219], v[228:231], v[196:211]
    ds_read2_b32 v[220:221], v254 offset0:224 offset1:225
    ds_read2_b32 v[222:223], v254 offset0:226 offset1:227
    ds_read_b128 v[248:251], v142 offset:256
    v_mfma_f32_32x32x16_bf16 v[180:195], v[216:219], v[240:243], v[180:195]
    v_mfma_f32_32x32x16_bf16 v[164:179], v[216:219], v[236:239], v[164:179]
    s_waitcnt lgkmcnt(6)
    v_mfma_f32_32x32x16_bf16 v[196:211], v[212:215], v[232:235], v[196:211]
    ds_read2_b32 v[216:217], v253 offset0:224 offset1:225
    ds_read2_b32 v[218:219], v253 offset0:226 offset1:227
    v_mfma_f32_32x32x16_bf16 v[180:195], v[212:215], v[228:231], v[180:195]
    v_mfma_f32_32x32x16_bf16 v[164:179], v[212:215], v[240:243], v[164:179]
    ds_read_b128 v[228:231], v142 offset:512
    ds_read_b128 v[232:235], v142 offset:768
    v_mfma_f32_32x32x16_bf16 v[148:163], v[212:215], v[236:239], v[148:163]
    s_add_u32 s54, s67, 196608
    s_waitcnt vmcnt(8)
    s_mov_b64 exec, 1
    buffer_store_dword v141, off, s[32:35], s54 sc1
    s_mov_b64 exec, -1
    s_waitcnt lgkmcnt(7)
    v_mfma_f32_32x32x16_bf16 v[196:211], v[224:227], v[244:247], v[196:211]
    ds_read2_b32 v[212:213], v252 offset0:224 offset1:225
    ds_read2_b32 v[214:215], v252 offset0:226 offset1:227
    s_waitcnt lgkmcnt(6)
    v_mfma_f32_32x32x16_bf16 v[196:211], v[220:223], v[248:251], v[196:211]
    v_mfma_f32_32x32x16_bf16 v[180:195], v[220:223], v[244:247], v[180:195]
    s_waitcnt lgkmcnt(3)
    v_mfma_f32_32x32x16_bf16 v[196:211], v[216:219], v[228:231], v[196:211]
    v_mfma_f32_32x32x16_bf16 v[180:195], v[216:219], v[248:251], v[180:195]
    v_mfma_f32_32x32x16_bf16 v[164:179], v[216:219], v[244:247], v[164:179]
    s_waitcnt lgkmcnt(0)
    v_mfma_f32_32x32x16_bf16 v[196:211], v[212:215], v[232:235], v[196:211]
    v_mfma_f32_32x32x16_bf16 v[180:195], v[212:215], v[228:231], v[180:195]
    v_mfma_f32_32x32x16_bf16 v[164:179], v[212:215], v[248:251], v[164:179]
    v_mfma_f32_32x32x16_bf16 v[148:163], v[212:215], v[244:247], v[148:163]
    s_setprio 2
    v_lshrrev_b32 v216, 4, v128
    s_movk_i32 s53, 3840
    v_mad_u32_u24 v212, v216, s53, v139
    v_lshrrev_b32 v218, 5, v128
    v_xor_b32 v213, 64, v212
    v_xor_b32 v214, 0x80, v212
    v_xor_b32 v215, 0xc0, v212
    s_nop 0
    s_nop 0
    ds_write_b128 v212, v[196:199] offset:8960
    ds_write_b128 v213, v[200:203] offset:9984
    ds_write_b128 v214, v[204:207] offset:11008
    ds_write_b128 v215, v[208:211] offset:12032
    ds_write_b128 v212, v[180:183] offset:8704
    ds_write_b128 v213, v[184:187] offset:9728
    ds_write_b128 v214, v[188:191] offset:10752
    ds_write_b128 v215, v[192:195] offset:11776
    s_waitcnt lgkmcnt(4)
    ds_write_b128 v212, v[164:167] offset:8448
    ds_write_b128 v213, v[168:171] offset:9472
    ds_write_b128 v214, v[172:175] offset:10496
    ds_write_b128 v215, v[176:179] offset:11520
    ds_write_b128 v212, v[148:151] offset:8192
    ds_write_b128 v213, v[152:155] offset:9216
    ds_write_b128 v214, v[156:159] offset:10240
    ds_write_b128 v215, v[160:163] offset:11264
    s_mov_b64 exec, 2
    ds_add_u32 v129, v128 offset:0
    s_mov_b64 exec, -1
    v_and_b32 v217, 31, v128
    v_lshlrev_b32 v218, 4, v218
    v_lshl_add_u32 v252, v217, 5, v218
    v_lshl_add_u32 v142, v217, 13, v218
    v_and_b32 v221, 3, v128
    v_and_b32 v220, 0x3c0, v129
    v_mul_u32_u24 v221, 1088, v221
    v_lshrrev_b32 v220, 2, v220
    s_lshl_b32 s53, s49, 8
    s_add_u32 s53, s53, 73728
    v_xad_u32 v216, v220, v221, s53
    s_cmp_eq_u32 s49, 0
    s_cselect_b32 s53, 172032, s53
    v_mov_b32 v220, 24576
    s_add_u32 s54, s53, 2864
    v_mov_b32 v217, s54
    s_nop 0
    s_nop 0
    v_mov_b32_dpp v217, v216 wave_shr:1 row_mask:0xf bank_mask:0xf
    s_add_u32 s54, s53, 26480
    v_mov_b32 v218, s54
    s_nop 0
    s_nop 0
    v_add_u32_dpp v218, v217, v220 wave_shr:1 row_mask:0xf bank_mask:0xf
    s_add_u32 s54, s53, 25520
    v_mov_b32 v219, s54
    s_nop 0
    s_nop 0
    v_mov_b32_dpp v219, v218 wave_shr:1 row_mask:0xf bank_mask:0xf
gw_78:
    ds_read_b32 v141, v129 offset:16
    s_sub_i32 s52, s52, 1
    s_waitcnt lgkmcnt(0)
    v_readfirstlane_b32 s53, v141
    s_cmp_lt_u32 s53, 24
    s_cselect_b32 s53, s52, 0
    s_cmp_gt_i32 s53, 0
    s_cbranch_scc1 gw_78
    ds_read_b128 v[148:151], v216 offset:0
    ds_read_b128 v[152:155], v216 offset:8192
    ds_read_b128 v[156:159], v217 offset:4096
    ds_read_b128 v[160:163], v217 offset:12288
    ds_read_b128 v[164:167], v218 offset:0
    ds_read_b128 v[168:171], v218 offset:8192
    ds_read_b128 v[172:175], v219 offset:4096
    ds_read_b128 v[176:179], v219 offset:12288
    ds_read_b128 v[180:183], v216 offset:49152
    ds_read_b128 v[184:187], v216 offset:57344
    ds_read_b128 v[188:191], v217 offset:53248
    ds_read_b128 v[192:195], v217 offset:61440
    s_waitcnt lgkmcnt(8)
    ds_read_b128 v[196:199], v218 offset:49152
    ds_read_b128 v[200:203], v218 offset:57344
    ds_read_b128 v[204:207], v219 offset:53248
    ds_read_b128 v[208:211], v219 offset:61440
    s_mov_b64 exec, 2
    ds_add_u32 v129, v128 offset:0
    s_mov_b64 exec, -1
    v_pk_add_f32 v[148:149], v[148:149], v[156:157]
    v_pk_add_f32 v[150:151], v[150:151], v[158:159]
    v_pk_add_f32 v[152:153], v[152:153], v[160:161]
    v_pk_add_f32 v[154:155], v[154:155], v[162:163]
    s_waitcnt lgkmcnt(11)
    v_pk_add_f32 v[148:149], v[148:149], v[164:165]
    v_pk_add_f32 v[150:151], v[150:151], v[166:167]
    v_pk_add_f32 v[152:153], v[152:153], v[168:169]
    v_pk_add_f32 v[154:155], v[154:155], v[170:171]
    s_waitcnt lgkmcnt(9)
    v_pk_add_f32 v[148:149], v[148:149], v[172:173]
    v_pk_add_f32 v[150:151], v[150:151], v[174:175]
    v_pk_add_f32 v[152:153], v[152:153], v[176:177]
    v_pk_add_f32 v[154:155], v[154:155], v[178:179]
    s_waitcnt lgkmcnt(5)
    v_pk_add_f32 v[180:181], v[180:181], v[188:189]
    v_pk_add_f32 v[182:183], v[182:183], v[190:191]
    v_pk_add_f32 v[184:185], v[184:185], v[192:193]
    v_pk_add_f32 v[186:187], v[186:187], v[194:195]
    s_waitcnt lgkmcnt(3)
    v_pk_add_f32 v[180:181], v[180:181], v[196:197]
    v_pk_add_f32 v[182:183], v[182:183], v[198:199]
    v_pk_add_f32 v[184:185], v[184:185], v[200:201]
    v_pk_add_f32 v[186:187], v[186:187], v[202:203]
    s_waitcnt lgkmcnt(1)
    v_pk_add_f32 v[180:181], v[180:181], v[204:205]
    v_pk_add_f32 v[182:183], v[182:183], v[206:207]
    v_pk_add_f32 v[184:185], v[184:185], v[208:209]
    v_pk_add_f32 v[186:187], v[186:187], v[210:211]
    v_cvt_pk_bf16_f32 v240, v148, v180
    v_cvt_pk_bf16_f32 v241, v149, v181
    v_cvt_pk_bf16_f32 v242, v150, v182
    v_cvt_pk_bf16_f32 v243, v151, v183
    v_cvt_pk_bf16_f32 v244, v152, v184
    v_cvt_pk_bf16_f32 v245, v153, v185
    v_cvt_pk_bf16_f32 v246, v154, v186
    v_cvt_pk_bf16_f32 v247, v155, v187
    v_min_u32 v240, -2, v240
    v_min_u32 v244, -2, v244
    s_lshl_b32 s53, s49, 10
    s_add_u32 s53, s53, s57
    s_add_u32 s53, s53, 4194304
    v_permlane32_swap_b32 v240, v244
    v_permlane32_swap_b32 v241, v245
    v_permlane32_swap_b32 v242, v246
    v_permlane32_swap_b32 v243, v247
    buffer_store_dwordx4 v[240:243], v252, s[32:35], s53 offen offset:0 sc1
    buffer_store_dwordx4 v[244:247], v252, s[32:35], s53 offen offset:1024 sc1
gw_79:
    ds_read_b32 v141, v129 offset:16
    s_sub_i32 s52, s52, 1
    s_waitcnt lgkmcnt(0)
    v_readfirstlane_b32 s53, v141
    s_cmp_lt_u32 s53, 28
    s_cselect_b32 s53, s52, 0
    s_cmp_gt_i32 s53, 0
    s_cbranch_scc1 gw_79
    s_add_u32 m0, s66, 8192
    s_add_u32 s53, s77, 8192
    buffer_load_dwordx4 v129, s[32:35], s53 offen offset:0 sc1 lds
    buffer_load_dwordx4 v129, s[32:35], s53 offen offset:1024 sc1 lds
    buffer_load_dwordx4 v129, s[32:35], s53 offen offset:2048 sc1 lds
    buffer_load_dwordx4 v129, s[32:35], s53 offen offset:3072 sc1 lds
    s_add_u32 m0, s66, 12288
    s_add_u32 s53, s77, 12288
    buffer_load_dwordx4 v129, s[32:35], s53 offen offset:0 sc1 lds
    buffer_load_dwordx4 v129, s[32:35], s53 offen offset:1024 sc1 lds
    buffer_load_dwordx4 v129, s[32:35], s53 offen offset:2048 sc1 lds
    buffer_load_dwordx4 v129, s[32:35], s53 offen offset:3072 sc1 lds
    s_add_u32 m0, s66, 16384
    s_add_u32 s53, s77, 16384
    buffer_load_dwordx4 v129, s[32:35], s53 offen offset:0 sc1 lds
    buffer_load_dwordx4 v129, s[32:35], s53 offen offset:1024 sc1 lds
    buffer_load_dwordx4 v129, s[32:35], s53 offen offset:2048 sc1 lds
    buffer_load_dwordx4 v129, s[32:35], s53 offen offset:3072 sc1 lds
rwok_81:
    ds_read_b32 v141, v129 offset:64
    s_sub_i32 s52, s52, 1
    s_waitcnt lgkmcnt(0)
    v_cmp_gt_u32 vcc, 0x1bbba, v141
    s_and_b32 s53, vcc_lo, 15
    s_cselect_b32 s54, s52, 0
    s_cmp_gt_i32 s54, 0
    s_cbranch_scc1 rw_80
    ds_read2st64_b32 v[216:217], v134 offset0:0 offset1:9
    ds_read2st64_b32 v[218:219], v134 offset0:18 offset1:27
    ds_read_b64 v[208:209], v133 offset:28672
    ds_read_b64 v[210:211], v133 offset:30976
    ds_read_b64 v[212:213], v133 offset:33280
    ds_read_b64 v[214:215], v133 offset:35584
    ds_read2st64_b32 v[228:229], v134 offset0:36 offset1:45
    ds_read2st64_b32 v[230:231], v134 offset0:54 offset1:63
    ds_read_b64 v[220:221], v133 offset:37888
    ds_read_b64 v[222:223], v133 offset:40192
    ds_read_b64 v[224:225], v133 offset:42496
    ds_read_b64 v[226:227], v133 offset:44800
    s_waitcnt lgkmcnt(10)
    v_pk_add_f32 v[216:217], v[216:217], v[218:219]
    v_add_f32 v216, v216, v217
    v_rcp_f32 v218, v216
    v_subrev_u32 v216, s78, v216
    v_cmp_lt_u32 vcc, s79, v216
    s_waitcnt lgkmcnt(6)
    v_pk_add_f32 v[208:209], v[208:209], v[210:211]
    v_pk_add_f32 v[212:213], v[212:213], v[214:215]
    v_pk_add_f32 v[208:209], v[208:209], v[212:213]
    v_pk_mul_f32 v[208:209], v[208:209], v[218:219] op_sel_hi:[1,0]
    v_cvt_pk_bf16_f32 v208, v208, v209
    s_cbranch_vccnz sl_83
    ds_write_b32 v135, v208 offset:3584
slbk_84:
    s_waitcnt lgkmcnt(5)
    v_pk_add_f32 v[228:229], v[228:229], v[230:231]
    v_add_f32 v228, v228, v229
    v_rcp_f32 v230, v228
    v_subrev_u32 v228, s78, v228
    v_cmp_lt_u32 vcc, s79, v228
    s_waitcnt lgkmcnt(1)
    v_pk_add_f32 v[220:221], v[220:221], v[222:223]
    v_pk_add_f32 v[224:225], v[224:225], v[226:227]
    v_pk_add_f32 v[220:221], v[220:221], v[224:225]
    v_pk_mul_f32 v[220:221], v[220:221], v[230:231] op_sel_hi:[1,0]
    v_cvt_pk_bf16_f32 v220, v220, v221
    s_cbranch_vccnz sl_85
    ds_write_b32 v135, v220 offset:4608
slbk_86:
    s_mov_b64 exec, 2
    ds_add_u32 v129, v128 offset:0
    s_mov_b64 exec, -1
    s_add_u32 m0, s66, 20480
    s_add_u32 s53, s77, 20480
    buffer_load_dwordx4 v129, s[32:35], s53 offen offset:0 sc1 lds
    buffer_load_dwordx4 v129, s[32:35], s53 offen offset:1024 sc1 lds
    buffer_load_dwordx4 v129, s[32:35], s53 offen offset:2048 sc1 lds
    buffer_load_dwordx4 v129, s[32:35], s53 offen offset:3072 sc1 lds
    s_add_u32 s53, s77, 24576
    buffer_load_dwordx4 v[148:151], v129, s[32:35], s53 offen offset:0 sc1
PAD8:
    s_cbranch_execz PADRET
    buffer_load_dwordx4 v[152:155], v129, s[32:35], s53 offen offset:1024 sc1
    buffer_load_dwordx4 v[156:159], v129, s[32:35], s53 offen offset:2048 sc1
    buffer_load_dwordx4 v[160:163], v129, s[32:35], s53 offen offset:3072 sc1
    s_add_u32 s53, s77, 28672
    buffer_load_dwordx4 v[164:167], v129, s[32:35], s53 offen offset:0 sc1
    buffer_load_dwordx4 v[168:171], v129, s[32:35], s53 offen offset:1024 sc1
    buffer_load_dwordx4 v[172:175], v129, s[32:35], s53 offen offset:2048 sc1
    buffer_load_dwordx4 v[176:179], v129, s[32:35], s53 offen offset:3072 sc1
    v_bfe_u32 v197, v128, 2, 2
    v_and_b32 v198, 3, v128
    v_lshlrev_b32 v197, 13, v197
    v_lshl_add_u32 v197, v198, 2, v197
    s_and_b32 s70, s67, 0x1f80
    s_add_u32 s70, s70, 196608
    v_lshrrev_b32 v199, 2, v128
    v_lshlrev_b32 v199, 7, v199
    v_lshl_add_u32 v199, v198, 2, v199
    s_add_u32 s69, s69, 131072
    s_mov_b64 s[40:41], s[4:5]
    s_mov_b32 s42, 2097152
    s_mov_b32 s43, 0x20000
    s_add_u32 s53, s57, 4096
    buffer_load_dwordx4 v[188:191], v129, s[40:43], s57 offen
    buffer_load_dwordx4 v[192:195], v129, s[40:43], s53 offen
    buffer_load_dword v198, v197, s[32:35], s70 offen sc1
    buffer_load_dword v200, v199, s[32:35], s69 offen sc1
    s_mov_b64 s[36:37], s[26:27]
    s_mov_b32 s38, 2097152
    s_mov_b32 s39, 0x20000
gw_87:
    ds_read_b32 v141, v129 offset:16
    s_sub_i32 s52, s52, 1
    s_waitcnt lgkmcnt(0)
    v_readfirstlane_b32 s53, v141
    s_cmp_lt_u32 s53, 32
    s_cselect_b32 s53, s52, 0
    s_cmp_gt_i32 s53, 0
    s_cbranch_scc1 gw_87
rwok_89:
    ds_read_b32 v141, v129 offset:64
    s_sub_i32 s52, s52, 1
    s_waitcnt lgkmcnt(0)
    v_cmp_gt_u32 vcc, 0x37774, v141
    s_and_b32 s53, vcc_lo, 15
    s_cselect_b32 s54, s52, 0
    s_cmp_gt_i32 s54, 0
    s_cbranch_scc1 rw_88
    ds_read2st64_b32 v[216:217], v134 offset0:72 offset1:81
    ds_read2st64_b32 v[218:219], v134 offset0:90 offset1:99
    ds_read_b64 v[208:209], v133 offset:47104
    ds_read_b64 v[210:211], v133 offset:49408
    ds_read_b64 v[212:213], v133 offset:51712
    ds_read_b64 v[214:215], v133 offset:54016
    ds_read2st64_b32 v[228:229], v134 offset0:108 offset1:117
    ds_read2st64_b32 v[230:231], v134 offset0:126 offset1:135
    ds_read_b64 v[220:221], v133 offset:56320
    ds_read_b64 v[222:223], v133 offset:58624
    ds_read_b64 v[224:225], v133 offset:60928
    ds_read_b64 v[226:227], v133 offset:63232
    s_waitcnt lgkmcnt(10)
    v_pk_add_f32 v[216:217], v[216:217], v[218:219]
    v_add_f32 v216, v216, v217
    v_rcp_f32 v218, v216
    v_subrev_u32 v216, s78, v216
    v_cmp_lt_u32 vcc, s79, v216
    s_waitcnt lgkmcnt(6)
    v_pk_add_f32 v[208:209], v[208:209], v[210:211]
    v_pk_add_f32 v[212:213], v[212:213], v[214:215]
    v_pk_add_f32 v[208:209], v[208:209], v[212:213]
    v_pk_mul_f32 v[208:209], v[208:209], v[218:219] op_sel_hi:[1,0]
    v_cvt_pk_bf16_f32 v208, v208, v209
    s_cbranch_vccnz sl_91
    ds_write_b32 v135, v208 offset:5632
slbk_92:
    s_waitcnt lgkmcnt(5)
    v_pk_add_f32 v[228:229], v[228:229], v[230:231]
    v_add_f32 v228, v228, v229
    v_rcp_f32 v230, v228
    v_subrev_u32 v228, s78, v228
    v_cmp_lt_u32 vcc, s79, v228
    s_waitcnt lgkmcnt(1)
    v_pk_add_f32 v[220:221], v[220:221], v[222:223]
    v_pk_add_f32 v[224:225], v[224:225], v[226:227]
    v_pk_add_f32 v[220:221], v[220:221], v[224:225]
    v_pk_mul_f32 v[220:221], v[220:221], v[230:231] op_sel_hi:[1,0]
    v_cvt_pk_bf16_f32 v220, v220, v221
    s_cbranch_vccnz sl_93
    ds_write_b32 v135, v220 offset:6656
slbk_94:
    s_mov_b64 exec, 2
    ds_add_u32 v129, v128 offset:0
    s_mov_b64 exec, -1
    s_waitcnt vmcnt(0)
ck_95:
    v_xor_b32 v198, s51, v198
    v_bitop3_b32 v198, v200, s51, v198 bitop3:0xbe
    v_cmp_ne_u32 vcc, 0, v198
    s_cbranch_vccnz ckrt_97
ckok_96:
    s_lshl_b32 s53, s49, 19
    s_lshl_b32 s54, s2, 5
    s_add_u32 s53, s53, s54
    s_add_u32 s71, s53, 4194304
    s_add_u32 s56, s71, 262144
    s_mov_b32 s87, s71
    buffer_load_dwordx4 v[180:183], v142, s[32:35], s71 offen sc1
    buffer_load_dwordx4 v[184:187], v142, s[32:35], s56 offen sc1
    v_bfe_u32 v224, v128, 2, 2
    v_bfe_u32 v225, v128, 3, 1
    v_mul_u32_u24 v224, 768, v224
    v_sub_u32 v224, v132, v224
    v_lshl_add_u32 v224, v225, 9, v224
    ds_read_b128 v[236:239], v139 offset:0
    ds_read_b128 v[240:243], v139 offset:8192
    ds_read_b128 v[244:247], v139 offset:16384
    ds_read_b128 v[248:251], v139 offset:1024
    ds_read_b128 v[252:255], v139 offset:9216
    ds_read_b128 v[196:199], v139 offset:17408
    ds_read_b128 v[200:203], v139 offset:2048
    ds_read_b128 v[204:207], v139 offset:10240
gw_98:
    ds_read_b32 v141, v129 offset:16
    s_sub_i32 s52, s52, 1
    s_waitcnt lgkmcnt(0)
    v_readfirstlane_b32 s53, v141
    s_cmp_lt_u32 s53, 36
    s_cselect_b32 s53, s52, 0
    s_cmp_gt_i32 s53, 0
    s_cbranch_scc1 gw_98
    ds_read_b128 v[220:223], v224 offset:5760
    ds_read_b128 v[208:211], v224 offset:3584
    ds_read_b128 v[212:215], v224 offset:3712
    ds_read_b128 v[216:219], v224 offset:5632
    s_add_u32 s71, s74, 0
    s_waitcnt lgkmcnt(3)
    v_mfma_f32_16x16x32_bf16 v[224:227], v[148:151], v[220:223], 0
    s_waitcnt lgkmcnt(2)
    v_mfma_f32_16x16x32_bf16 v[224:227], v[236:239], v[208:211], v[224:227]
    ds_read_b128 v[236:239], v139 offset:18432
    s_waitcnt lgkmcnt(2)
    v_mfma_f32_16x16x32_bf16 v[224:227], v[240:243], v[212:215], v[224:227]
    ds_read_b128 v[240:243], v139 offset:3072
    s_waitcnt lgkmcnt(2)
    v_mfma_f32_16x16x32_bf16 v[224:227], v[244:247], v[216:219], v[224:227]
    ds_read_b128 v[244:247], v139 offset:11264
    v_mfma_f32_16x16x32_bf16 v[232:235], v[152:155], v[220:223], 0
    v_mfma_f32_16x16x32_bf16 v[232:235], v[248:251], v[208:211], v[232:235]
    ds_read_b128 v[248:251], v139 offset:19456
    v_mfma_f32_16x16x32_bf16 v[232:235], v[252:255], v[212:215], v[232:235]
    ds_read_b128 v[252:255], v139 offset:4096
    v_mfma_f32_16x16x32_bf16 v[232:235], v[196:199], v[216:219], v[232:235]
    ds_read_b128 v[196:199], v139 offset:12288
    v_mfma_f32_16x16x32_bf16 v[228:231], v[156:159], v[220:223], 0
    v_mfma_f32_16x16x32_bf16 v[228:231], v[200:203], v[208:211], v[228:231]
    ds_read_b128 v[200:203], v139 offset:20480
    v_mfma_f32_16x16x32_bf16 v[228:231], v[204:207], v[212:215], v[228:231]
    ds_read_b128 v[204:207], v139 offset:5120
    s_waitcnt lgkmcnt(7)
    v_mfma_f32_16x16x32_bf16 v[228:231], v[236:239], v[216:219], v[228:231]
    ds_read_b128 v[236:239], v139 offset:13312
    ds_write_b128 v138, v[224:227] offset:16000
    ds_write_b128 v138, v[232:235] offset:16016
    v_cvt_pk_bf16_f32 v224, v224, v225
    v_cvt_pk_bf16_f32 v225, v226, v227
    v_cvt_pk_bf16_f32 v226, v232, v233
    v_cvt_pk_bf16_f32 v227, v234, v235
    v_min_u32 v224, -2, v224
    buffer_store_dwordx4 v[224:227], v137, s[32:35], s71 offen offset:0 sc1
    v_mfma_f32_16x16x32_bf16 v[232:235], v[160:163], v[220:223], 0
    s_waitcnt lgkmcnt(9)
    v_mfma_f32_16x16x32_bf16 v[232:235], v[240:243], v[208:211], v[232:235]
    ds_read_b128 v[240:243], v139 offset:21504
    s_waitcnt lgkmcnt(9)
    v_mfma_f32_16x16x32_bf16 v[232:235], v[244:247], v[212:215], v[232:235]
    ds_read_b128 v[244:247], v139 offset:6144
    s_waitcnt lgkmcnt(9)
    v_mfma_f32_16x16x32_bf16 v[232:235], v[248:251], v[216:219], v[232:235]
    ds_read_b128 v[248:251], v139 offset:14336
    v_mfma_f32_16x16x32_bf16 v[224:227], v[164:167], v[220:223], 0
    s_waitcnt lgkmcnt(9)
    v_mfma_f32_16x16x32_bf16 v[224:227], v[252:255], v[208:211], v[224:227]
    ds_read_b128 v[252:255], v139 offset:22528
    s_waitcnt lgkmcnt(9)
    v_mfma_f32_16x16x32_bf16 v[224:227], v[196:199], v[212:215], v[224:227]
    ds_read_b128 v[196:199], v139 offset:7168
    s_waitcnt lgkmcnt(9)
    v_mfma_f32_16x16x32_bf16 v[224:227], v[200:203], v[216:219], v[224:227]
    ds_read_b128 v[200:203], v139 offset:15360
    ds_write_b128 v138, v[228:231] offset:16128
    ds_write_b128 v138, v[232:235] offset:16144
    v_cvt_pk_bf16_f32 v228, v228, v229
    v_cvt_pk_bf16_f32 v229, v230, v231
    v_cvt_pk_bf16_f32 v230, v232, v233
    v_cvt_pk_bf16_f32 v231, v234, v235
    v_min_u32 v228, -2, v228
    buffer_store_dwordx4 v[228:231], v137, s[32:35], s71 offen offset:256 sc1
    v_mfma_f32_16x16x32_bf16 v[232:235], v[168:171], v[220:223], 0
    s_waitcnt lgkmcnt(11)
    v_mfma_f32_16x16x32_bf16 v[232:235], v[204:207], v[208:211], v[232:235]
    ds_read_b128 v[204:207], v139 offset:23552
    s_waitcnt lgkmcnt(11)
    v_mfma_f32_16x16x32_bf16 v[232:235], v[236:239], v[212:215], v[232:235]
    s_waitcnt lgkmcnt(8)
    v_mfma_f32_16x16x32_bf16 v[232:235], v[240:243], v[216:219], v[232:235]
    v_mfma_f32_16x16x32_bf16 v[228:231], v[172:175], v[220:223], 0
    s_waitcnt lgkmcnt(7)
    v_mfma_f32_16x16x32_bf16 v[228:231], v[244:247], v[208:211], v[228:231]
    s_waitcnt lgkmcnt(6)
    v_mfma_f32_16x16x32_bf16 v[228:231], v[248:251], v[212:215], v[228:231]
    s_waitcnt lgkmcnt(5)
    v_mfma_f32_16x16x32_bf16 v[228:231], v[252:255], v[216:219], v[228:231]
    ds_write_b128 v138, v[224:227] offset:16256
    ds_write_b128 v138, v[232:235] offset:16272
    v_cvt_pk_bf16_f32 v224, v224, v225
    v_cvt_pk_bf16_f32 v225, v226, v227
    v_cvt_pk_bf16_f32 v226, v232, v233
    v_cvt_pk_bf16_f32 v227, v234, v235
    v_min_u32 v224, -2, v224
    buffer_store_dwordx4 v[224:227], v137, s[32:35], s71 offen offset:512 sc1
    v_mfma_f32_16x16x32_bf16 v[232:235], v[176:179], v[220:223], 0
    s_waitcnt lgkmcnt(6)
    v_mfma_f32_16x16x32_bf16 v[232:235], v[196:199], v[208:211], v[232:235]
    s_waitcnt lgkmcnt(5)
    v_mfma_f32_16x16x32_bf16 v[232:235], v[200:203], v[212:215], v[232:235]
    s_waitcnt lgkmcnt(2)
    v_mfma_f32_16x16x32_bf16 v[232:235], v[204:207], v[216:219], v[232:235]
    s_setprio 2
    s_nop 0
    s_nop 0
    s_nop 0
    s_nop 0
    s_nop 0
    s_nop 0
    ds_write_b128 v138, v[228:231] offset:16384
    ds_write_b128 v138, v[232:235] offset:16400
    v_cvt_pk_bf16_f32 v228, v228, v229
    v_cvt_pk_bf16_f32 v229, v230, v231
    v_cvt_pk_bf16_f32 v230, v232, v233
    v_cvt_pk_bf16_f32 v231, v234, v235
    v_min_u32 v228, -2, v228
    buffer_store_dwordx4 v[228:231], v137, s[32:35], s71 offen offset:768 sc1
    v_lshrrev_b32 v236, 5, v128
    v_and_b32 v237, 31, v128
    v_mul_u32_u24 v236, 12672, v236
    s_lshl_b32 s53, s49, 8
    v_lshl_add_u32 v237, v237, 2, s53
    v_add_u32 v236, v236, v237
    s_mul_i32 s53, s49, 1056
    v_add_u32 v223, s53, v129
    s_mov_b32 s71, s87
    s_waitcnt vmcnt(4)
ck_99:
    v_max_u32 v237, v180, v184
    v_cmp_eq_u32 vcc, -1, v237
    s_cbranch_vccnz ckrt_101
ckok_100:
    ds_write_b32 v236, v180 offset:11776
    ds_write_b32 v236, v181 offset:12832
    ds_write_b32 v236, v182 offset:13888
    ds_write_b32 v236, v183 offset:14944
    ds_write_b32 v236, v184 offset:11904
    ds_write_b32 v236, v185 offset:12960
    ds_write_b32 v236, v186 offset:14016
    ds_write_b32 v236, v187 offset:15072
    s_mov_b64 exec, 2
    ds_add_u32 v129, v128 offset:0
    s_mov_b64 exec, -1
    s_lshl_b32 s53, s2, 2
    s_add_u32 s54, s53, s80
    s_lshl_b32 s54, s54, 12
    s_add_u32 s68, s54, 16777216
    s_add_u32 s54, s53, s81
    s_lshl_b32 s54, s54, 12
    s_add_u32 s69, s54, 16777216
    s_add_u32 s54, s53, s82
    s_lshl_b32 s54, s54, 12
    s_add_u32 s70, s54, 16777216
rwok_103:
    ds_read_b32 v141, v129 offset:64
    s_sub_i32 s52, s52, 1
    s_waitcnt lgkmcnt(0)
    v_cmp_gt_u32 vcc, 0x45551, v141
    s_and_b32 s53, vcc_lo, 15
    s_cselect_b32 s54, s52, 0
    s_cmp_gt_i32 s54, 0
    s_cbranch_scc1 rw_102
    ds_read2st64_b32 v[216:217], v134 offset0:0 offset1:9
    ds_read2st64_b32 v[218:219], v134 offset0:18 offset1:27
    ds_read_b64 v[208:209], v133 offset:28672
    ds_read_b64 v[210:211], v133 offset:30976
    ds_read_b64 v[212:213], v133 offset:33280
    ds_read_b64 v[214:215], v133 offset:35584
    s_waitcnt lgkmcnt(4)
    v_pk_add_f32 v[216:217], v[216:217], v[218:219]
    v_add_f32 v216, v216, v217
    v_rcp_f32 v218, v216
    v_subrev_u32 v216, s78, v216
    v_cmp_lt_u32 vcc, s79, v216
    s_waitcnt lgkmcnt(0)
    v_pk_add_f32 v[208:209], v[208:209], v[210:211]
    v_pk_add_f32 v[212:213], v[212:213], v[214:215]
    v_pk_add_f32 v[208:209], v[208:209], v[212:213]
    v_pk_mul_f32 v[208:209], v[208:209], v[218:219] op_sel_hi:[1,0]
    v_cvt_pk_bf16_f32 v208, v208, v209
    s_cbranch_vccnz sl_105
    ds_write_b32 v135, v208 offset:7680
slbk_106:
    s_waitcnt vmcnt(0)
    buffer_load_dwordx4 v[196:199], v136, s[32:35], s68 offen sc1
    buffer_load_dwordx4 v[200:203], v136, s[32:35], s69 offen sc1
    buffer_load_dwordx4 v[204:207], v136, s[32:35], s70 offen sc1
    s_mul_i32 s55, s49, 2112
    v_lshl_add_u32 v222, v128, 5, s55
gw_107:
    ds_read_b32 v141, v129 offset:16
    s_sub_i32 s52, s52, 1
    s_waitcnt lgkmcnt(0)
    v_readfirstlane_b32 s53, v141
    s_cmp_lt_u32 s53, 40
    s_cselect_b32 s53, s52, 0
    s_cmp_gt_i32 s53, 0
    s_cbranch_scc1 gw_107
    ds_read_b128 v[180:183], v223 offset:11776
    ds_read_b128 v[184:187], v223 offset:24448
    ds_read_b128 v[208:211], v222 offset:16000
    ds_read_b128 v[212:215], v222 offset:16016
    s_add_u32 s55, s57, 8388608
    s_waitcnt lgkmcnt(0)
    v_dot2c_f32_bf16 v208, s75, v188
    v_dot2c_f32_bf16 v209, s76, v188
    v_dot2c_f32_bf16 v210, s75, v189
    v_dot2c_f32_bf16 v211, s76, v189
    v_dot2c_f32_bf16 v212, s75, v190
    v_dot2c_f32_bf16 v213, s76, v190
    v_dot2c_f32_bf16 v214, s75, v191
    v_dot2c_f32_bf16 v215, s76, v191
    s_waitcnt vmcnt(0)
ck_108:
    v_max3_u32 v216, v196, v200, v204
    v_cmp_eq_u32 vcc, -1, v216
    s_cbranch_vccnz ckrt_110
ckok_109:
    s_lshl_b32 s53, s49, 13
    s_add_u32 s53, s53, 524288
    s_add_u32 s54, s53, 4096
    buffer_load_dwordx4 v[224:227], v129, s[32:35], s53 offen offset:0 sc1
    buffer_load_dwordx4 v[228:231], v129, s[32:35], s53 offen offset:1024 sc1
    buffer_load_dwordx4 v[232:235], v129, s[32:35], s53 offen offset:2048 sc1
    buffer_load_dwordx4 v[236:239], v129, s[32:35], s53 offen offset:3072 sc1
    buffer_load_dwordx4 v[240:243], v129, s[32:35], s54 offen offset:0 sc1
    buffer_load_dwordx4 v[244:247], v129, s[32:35], s54 offen offset:1024 sc1
    buffer_load_dwordx4 v[248:251], v129, s[32:35], s54 offen offset:2048 sc1
    buffer_load_dwordx4 v[252:255], v129, s[32:35], s54 offen offset:3072 sc1
    v_dot2c_f32_bf16 v208, s75, v196
    v_dot2c_f32_bf16 v209, s76, v196
    v_dot2c_f32_bf16 v210, s75, v197
    v_dot2c_f32_bf16 v211, s76, v197
    v_dot2c_f32_bf16 v212, s75, v198
    v_dot2c_f32_bf16 v213, s76, v198
    v_dot2c_f32_bf16 v214, s75, v199
    v_dot2c_f32_bf16 v215, s76, v199
    v_dot2c_f32_bf16 v208, s75, v200
    v_dot2c_f32_bf16 v209, s76, v200
    v_dot2c_f32_bf16 v210, s75, v201
    v_dot2c_f32_bf16 v211, s76, v201
    v_dot2c_f32_bf16 v212, s75, v202
    v_dot2c_f32_bf16 v213, s76, v202
    v_dot2c_f32_bf16 v214, s75, v203
    v_dot2c_f32_bf16 v215, s76, v203
    v_dot2c_f32_bf16 v208, s75, v204
    v_dot2c_f32_bf16 v209, s76, v204
    v_dot2c_f32_bf16 v210, s75, v205
    v_dot2c_f32_bf16 v211, s76, v205
    v_dot2c_f32_bf16 v212, s75, v206
    v_dot2c_f32_bf16 v213, s76, v206
    v_dot2c_f32_bf16 v214, s75, v207
    v_dot2c_f32_bf16 v215, s76, v207
    s_nop 0
    v_pk_add_f32 v[216:217], v[208:209], v[210:211]
    v_pk_mul_f32 v[220:221], v[208:209], v[208:209]
    v_pk_add_f32 v[218:219], v[212:213], v[214:215]
    v_pk_fma_f32 v[220:221], v[210:211], v[210:211], v[220:221]
    v_pk_add_f32 v[216:217], v[216:217], v[218:219]
    v_pk_fma_f32 v[220:221], v[212:213], v[212:213], v[220:221]
    v_add_f32 v216, v216, v217
    v_pk_fma_f32 v[220:221], v[214:215], v[214:215], v[220:221]
    v_add_f32 v217, v220, v221
    v_lshlrev_b32 v196, 16, v180
    v_and_b32 v197, 0xffff0000, v180
    v_permlane32_swap_b32 v216, v217
    v_add_f32 v216, v216, v217
    v_lshlrev_b32 v198, 16, v181
    v_and_b32 v199, 0xffff0000, v181
    v_add_f32_dpp v216, v216, v216 quad_perm:[1,0,3,2] row_mask:0xf bank_mask:0xf
    v_lshlrev_b32 v200, 16, v182
    v_and_b32 v201, 0xffff0000, v182
    v_add_f32_dpp v216, v216, v216 quad_perm:[2,3,0,1] row_mask:0xf bank_mask:0xf
    v_lshlrev_b32 v202, 16, v183
    v_and_b32 v203, 0xffff0000, v183
    v_add_f32_dpp v216, v216, v216 row_half_mirror row_mask:0xf bank_mask:0xf
    s_nop 0
    s_nop 0
    v_add_f32_dpp v216, v216, v216 row_mirror row_mask:0xf bank_mask:0xf
    s_nop 0
    s_nop 0
    v_add_f32_dpp v216, v216, v216 row_bcast:15 row_mask:0xa bank_mask:0xf
    v_mul_f32 v216, 0x3b000000, v216
    s_nop 0
    v_readlane_b32 s59, v216, 63
    v_readlane_b32 s58, v216, 31
    s_nop 0
    v_mov_b32 v216, s59
    v_fma_f32 v216, -s58, s58, v216
    v_add_f32 v216, s91, abs(v216)
    v_rsq_f32 v216, v216
    s_nop 0
    v_mul_f32 v217, s58, v216
    v_pk_fma_f32 v[204:205], v[208:209], v[216:217], v[216:217] op_sel:[0,0,1] op_sel_hi:[1,0,1] neg_lo:[0,0,1] neg_hi:[0,0,1]
    v_pk_fma_f32 v[206:207], v[210:211], v[216:217], v[216:217] op_sel:[0,0,1] op_sel_hi:[1,0,1] neg_lo:[0,0,1] neg_hi:[0,0,1]
    v_pk_fma_f32 v[208:209], v[204:205], v[196:197], v[208:209]
    v_pk_fma_f32 v[210:211], v[206:207], v[198:199], v[210:211]
    v_pk_fma_f32 v[204:205], v[212:213], v[216:217], v[216:217] op_sel:[0,0,1] op_sel_hi:[1,0,1] neg_lo:[0,0,1] neg_hi:[0,0,1]
    v_pk_fma_f32 v[206:207], v[214:215], v[216:217], v[216:217] op_sel:[0,0,1] op_sel_hi:[1,0,1] neg_lo:[0,0,1] neg_hi:[0,0,1]
    v_pk_fma_f32 v[212:213], v[204:205], v[200:201], v[212:213]
    v_pk_fma_f32 v[214:215], v[206:207], v[202:203], v[214:215]
    v_pk_add_f32 v[216:217], v[208:209], v[210:211]
    v_pk_mul_f32 v[220:221], v[208:209], v[208:209]
    v_pk_add_f32 v[218:219], v[212:213], v[214:215]
    v_pk_fma_f32 v[220:221], v[210:211], v[210:211], v[220:221]
    v_pk_add_f32 v[216:217], v[216:217], v[218:219]
    v_pk_fma_f32 v[220:221], v[212:213], v[212:213], v[220:221]
    v_add_f32 v216, v216, v217
    v_pk_fma_f32 v[220:221], v[214:215], v[214:215], v[220:221]
    v_add_f32 v217, v220, v221
    v_cvt_pk_bf16_f32 v188, v208, v209
    v_cvt_pk_bf16_f32 v189, v210, v211
    v_permlane32_swap_b32 v216, v217
    v_add_f32 v216, v216, v217
    v_cvt_pk_bf16_f32 v190, v212, v213
    v_cvt_pk_bf16_f32 v191, v214, v215
    v_add_f32_dpp v216, v216, v216 quad_perm:[1,0,3,2] row_mask:0xf bank_mask:0xf
    s_mul_i32 s53, s49, 1056
    v_add_u32 v200, s53, v129
    v_add_f32_dpp v216, v216, v216 quad_perm:[2,3,0,1] row_mask:0xf bank_mask:0xf
    v_and_b32 v222, 12, v128
    v_mul_u32_u24 v222, 1056, v222
    v_add_f32_dpp v216, v216, v216 row_half_mirror row_mask:0xf bank_mask:0xf
    v_sub_u32 v222, v130, v222
    s_lshl_b32 s53, s49, 8
    v_add_f32_dpp v216, v216, v216 row_mirror row_mask:0xf bank_mask:0xf
    v_add_u32 v222, s53, v222
    s_nop 0
    v_add_f32_dpp v216, v216, v216 row_bcast:15 row_mask:0xa bank_mask:0xf
    v_mul_f32 v216, 0x3b000000, v216
    s_nop 0
    v_readlane_b32 s59, v216, 63
    v_readlane_b32 s58, v216, 31
    s_nop 0
    v_mov_b32 v216, s59
    v_fma_f32 v216, -s58, s58, v216
    v_add_f32 v216, s91, abs(v216)
    v_rsq_f32 v216, v216
    s_nop 0
    v_mul_f32 v217, s58, v216
    v_pk_fma_f32 v[208:209], v[208:209], v[216:217], v[216:217] op_sel:[0,0,1] op_sel_hi:[1,0,1] neg_lo:[0,0,1] neg_hi:[0,0,1]
    v_pk_fma_f32 v[210:211], v[210:211], v[216:217], v[216:217] op_sel:[0,0,1] op_sel_hi:[1,0,1] neg_lo:[0,0,1] neg_hi:[0,0,1]
    v_pk_fma_f32 v[212:213], v[212:213], v[216:217], v[216:217] op_sel:[0,0,1] op_sel_hi:[1,0,1] neg_lo:[0,0,1] neg_hi:[0,0,1]
    v_pk_fma_f32 v[214:215], v[214:215], v[216:217], v[216:217] op_sel:[0,0,1] op_sel_hi:[1,0,1] neg_lo:[0,0,1] neg_hi:[0,0,1]
    v_cvt_pk_bf16_f32 v196, v208, v209
    v_cvt_pk_bf16_f32 v197, v210, v211
    v_cvt_pk_bf16_f32 v198, v212, v213
    v_cvt_pk_bf16_f32 v199, v214, v215
    v_min_u32 v196, -2, v196
    ds_write_b128 v200, v[196:199] offset:24448
    s_mov_b64 exec, 2
    ds_add_u32 v129, v128 offset:0
    s_mov_b64 exec, -1
    buffer_store_dwordx4 v[196:199], v129, s[32:35], s55 offen sc1
    s_lshl_b32 s53, s49, 9
    v_and_b32 v220, 0xff, v137
    v_add_u32 v220, s53, v220
    v_add_u32 v221, s53, v129
gw_111:
    ds_read_b32 v141, v129 offset:16
    s_sub_i32 s52, s52, 1
    s_waitcnt lgkmcnt(0)
    v_readfirstlane_b32 s53, v141
    s_cmp_lt_u32 s53, 44
    s_cselect_b32 s53, s52, 0
    s_cmp_gt_i32 s53, 0
    s_cbranch_scc1 gw_111
    s_waitcnt vmcnt(1)
    ds_read_b128 v[196:199], v222 offset:24448
    ds_read_b128 v[200:203], v222 offset:24512
    ds_read_b128 v[204:207], v222 offset:24576
    ds_read_b128 v[208:211], v222 offset:24640
    s_waitcnt lgkmcnt(3)
    v_mfma_f32_16x16x32_bf16 v[212:215], v[224:227], v[196:199], 0
    v_mfma_f32_16x16x32_bf16 v[216:219], v[196:199], v[240:243], 0
    s_waitcnt lgkmcnt(2)
    v_mfma_f32_16x16x32_bf16 v[212:215], v[228:231], v[200:203], v[212:215]
    v_mfma_f32_16x16x32_bf16 v[216:219], v[200:203], v[244:247], v[216:219]
    s_waitcnt lgkmcnt(1)
    v_mfma_f32_16x16x32_bf16 v[212:215], v[232:235], v[204:207], v[212:215]
    v_mfma_f32_16x16x32_bf16 v[216:219], v[204:207], v[248:251], v[216:219]
    s_waitcnt lgkmcnt(0)
    v_mfma_f32_16x16x32_bf16 v[212:215], v[236:239], v[208:211], v[212:215]
    v_mfma_f32_16x16x32_bf16 v[216:219], v[208:211], v[252:255], v[216:219]
    s_mov_b32 s54, 393216
    s_nop 0
    s_nop 0
    s_nop 0
    s_nop 0
    s_mov_b32 exec_lo, 0xf000f
    s_mov_b32 exec_hi, 0xf000f
    ds_write_b128 v220, v[212:215] offset:1024
    s_mov_b32 exec_lo, 65535
    s_mov_b32 exec_hi, 0
    ds_write_b128 v221, v[216:219] offset:1280
    s_mov_b64 exec, 2
    ds_add_u32 v129, v128 offset:0
    s_mov_b64 exec, -1
gw_112:
    ds_read_b32 v141, v129 offset:16
    s_sub_i32 s52, s52, 1
    s_waitcnt lgkmcnt(0)
    v_readfirstlane_b32 s53, v141
    s_cmp_lt_u32 s53, 48
    s_cselect_b32 s53, s52, 0
    s_cmp_gt_i32 s53, 0
    s_cbranch_scc1 gw_112
    s_cmp_eq_u32 s49, 0
    s_cbranch_scc0 kvend_113
    s_mov_b32 exec_hi, 0
    ds_read_b128 v[196:199], v129 offset:1024
    ds_read_b128 v[200:203], v129 offset:1536
    ds_read_b128 v[204:207], v129 offset:2048
    ds_read_b128 v[208:211], v129 offset:2560
    s_waitcnt lgkmcnt(2)
    v_pk_add_f32 v[196:197], v[196:197], v[200:201]
    v_pk_add_f32 v[198:199], v[198:199], v[202:203]
    s_waitcnt lgkmcnt(0)
    v_pk_add_f32 v[204:205], v[204:205], v[208:209]
    v_pk_add_f32 v[206:207], v[206:207], v[210:211]
    v_pk_add_f32 v[196:197], v[196:197], v[204:205]
    v_pk_add_f32 v[198:199], v[198:199], v[206:207]
    v_cvt_pk_bf16_f32 v196, v196, v197
    v_cvt_pk_bf16_f32 v197, v198, v199
    v_min_u32 v196, -2, v196
    buffer_store_dwordx2 v[196:197], v140, s[32:35], s54 offen sc1
    s_mov_b64 exec, -1
kvend_113:
    s_and_b32 s53, s57, 0x1f8fff
    s_add_u32 s53, s53, 8388608
    s_lshl_b32 s54, s80, 13
    s_add_u32 s68, s53, s54
    s_lshl_b32 s54, s81, 13
    s_add_u32 s69, s53, s54
    s_lshl_b32 s54, s82, 13
    s_add_u32 s70, s53, s54
    s_waitcnt vmcnt(1)
    s_cmp_eq_u32 s49, 0
    s_cbranch_scc1 xw_114
    s_waitcnt vmcnt(0)
xw_114:
    buffer_load_dwordx4 v[196:199], v129, s[32:35], s68 offen sc1
    buffer_load_dwordx4 v[200:203], v129, s[32:35], s69 offen sc1
    buffer_load_dwordx4 v[204:207], v129, s[32:35], s70 offen sc1
rwok_116:
    ds_read_b32 v141, v129 offset:64
    s_sub_i32 s52, s52, 1
    s_waitcnt lgkmcnt(0)
    v_cmp_gt_u32 vcc, 0x5332e, v141
    s_and_b32 s53, vcc_lo, 15
    s_cselect_b32 s54, s52, 0
    s_cmp_gt_i32 s54, 0
    s_cbranch_scc1 rw_115
    ds_read2st64_b32 v[216:217], v134 offset0:36 offset1:45
    ds_read2st64_b32 v[218:219], v134 offset0:54 offset1:63
    ds_read_b64 v[208:209], v133 offset:37888
    ds_read_b64 v[210:211], v133 offset:40192
    ds_read_b64 v[212:213], v133 offset:42496
    ds_read_b64 v[214:215], v133 offset:44800
    s_waitcnt lgkmcnt(4)
    v_pk_add_f32 v[216:217], v[216:217], v[218:219]
    v_add_f32 v216, v216, v217
    v_rcp_f32 v218, v216
    v_subrev_u32 v216, s78, v216
    v_cmp_lt_u32 vcc, s79, v216
    s_waitcnt lgkmcnt(0)
    v_pk_add_f32 v[208:209], v[208:209], v[210:211]
    v_pk_add_f32 v[212:213], v[212:213], v[214:215]
    v_pk_add_f32 v[208:209], v[208:209], v[212:213]
    v_pk_mul_f32 v[208:209], v[208:209], v[218:219] op_sel_hi:[1,0]
    v_cvt_pk_bf16_f32 v208, v208, v209
    s_cbranch_vccnz sl_118
    ds_write_b32 v135, v208 offset:8704
slbk_119:
    s_mul_i32 s55, s49, 1056
    v_add_u32 v208, s55, v129
    s_waitcnt vmcnt(0)
ck_120:
    v_max3_u32 v209, v196, v200, v204
    v_cmp_eq_u32 vcc, -1, v209
    s_cbranch_vccnz ckrt_122
ckok_121:
    ds_write_b128 v208, v[196:199] offset:11776
    ds_write_b128 v208, v[200:203] offset:16000
    ds_write_b128 v208, v[204:207] offset:20224
    s_mov_b64 exec, 2
    ds_add_u32 v129, v128 offset:0
    s_mov_b64 exec, -1
gw_123:
    ds_read_b32 v141, v129 offset:16
    s_sub_i32 s52, s52, 1
    s_waitcnt lgkmcnt(0)
    v_readfirstlane_b32 s53, v141
    s_cmp_lt_u32 s53, 52
    s_cselect_b32 s53, s52, 0
    s_cmp_gt_i32 s53, 0
    s_cbranch_scc1 gw_123
    s_lshl_b32 s53, s80, 14
    s_add_u32 s53, s53, s74
    s_add_u32 s54, s53, 8388608
    buffer_store_dwordx4 v[144:147], v129, s[32:35], s54 offen sc1
    s_lshl_b32 s53, s81, 14
    s_add_u32 s53, s53, s74
    s_add_u32 s54, s53, 8388608
    buffer_store_dwordx4 v[144:147], v129, s[32:35], s54 offen sc1
    s_lshl_b32 s53, s82, 14
    s_add_u32 s53, s53, s74
    s_add_u32 s54, s53, 8388608
    buffer_store_dwordx4 v[144:147], v129, s[32:35], s54 offen sc1
    ds_read_b128 v[196:199], v130 offset:11776
    ds_read_b128 v[200:203], v130 offset:11840
    ds_read_b128 v[204:207], v130 offset:11904
    ds_read_b128 v[208:211], v130 offset:11968
    ds_read_b128 v[212:215], v130 offset:12032
    ds_read_b128 v[216:219], v130 offset:12096
    ds_read_b128 v[220:223], v130 offset:12160
    ds_read_b128 v[224:227], v130 offset:12224
    ds_read_b128 v[228:231], v130 offset:12288
    ds_read_b128 v[232:235], v130 offset:12352
    s_waitcnt lgkmcnt(9)
    v_mfma_f32_16x16x32_bf16 v[236:239], v[0:3], v[196:199], 0
    v_mfma_f32_16x16x32_bf16 v[240:243], v[64:67], v[196:199], 0
    ds_read_b128 v[196:199], v130 offset:12416
    s_waitcnt lgkmcnt(9)
    v_mfma_f32_16x16x32_bf16 v[236:239], v[4:7], v[200:203], v[236:239]
    v_mfma_f32_16x16x32_bf16 v[240:243], v[68:71], v[200:203], v[240:243]
    ds_read_b128 v[200:203], v130 offset:12480
    s_waitcnt lgkmcnt(9)
    v_mfma_f32_16x16x32_bf16 v[236:239], v[8:11], v[204:207], v[236:239]
    v_mfma_f32_16x16x32_bf16 v[240:243], v[72:75], v[204:207], v[240:243]
    ds_read_b128 v[204:207], v130 offset:12544
    s_waitcnt lgkmcnt(9)
    v_mfma_f32_16x16x32_bf16 v[236:239], v[12:15], v[208:211], v[236:239]
    v_mfma_f32_16x16x32_bf16 v[240:243], v[76:79], v[208:211], v[240:243]
    ds_read_b128 v[208:211], v130 offset:12608
    s_waitcnt lgkmcnt(9)
    v_mfma_f32_16x16x32_bf16 v[236:239], v[16:19], v[212:215], v[236:239]
    v_mfma_f32_16x16x32_bf16 v[240:243], v[80:83], v[212:215], v[240:243]
    ds_read_b128 v[212:215], v130 offset:12672
    s_waitcnt lgkmcnt(9)
    v_mfma_f32_16x16x32_bf16 v[236:239], v[20:23], v[216:219], v[236:239]
    v_mfma_f32_16x16x32_bf16 v[240:243], v[84:87], v[216:219], v[240:243]
    ds_read_b128 v[216:219], v130 offset:12736
    s_waitcnt lgkmcnt(9)
    v_mfma_f32_16x16x32_bf16 v[236:239], v[24:27], v[220:223], v[236:239]
    v_mfma_f32_16x16x32_bf16 v[240:243], v[88:91], v[220:223], v[240:243]
    s_waitcnt lgkmcnt(8)
    v_mfma_f32_16x16x32_bf16 v[236:239], v[28:31], v[224:227], v[236:239]
    v_mfma_f32_16x16x32_bf16 v[240:243], v[92:95], v[224:227], v[240:243]
    s_waitcnt lgkmcnt(7)
    v_mfma_f32_16x16x32_bf16 v[236:239], v[32:35], v[228:231], v[236:239]
    v_mfma_f32_16x16x32_bf16 v[240:243], v[96:99], v[228:231], v[240:243]
    s_waitcnt lgkmcnt(6)
PAD9:
    s_cbranch_execz PADRET
    v_mfma_f32_16x16x32_bf16 v[236:239], v[36:39], v[232:235], v[236:239]
    v_mfma_f32_16x16x32_bf16 v[240:243], v[100:103], v[232:235], v[240:243]
    s_waitcnt lgkmcnt(5)
    v_mfma_f32_16x16x32_bf16 v[236:239], v[40:43], v[196:199], v[236:239]
    v_mfma_f32_16x16x32_bf16 v[240:243], v[104:107], v[196:199], v[240:243]
    s_waitcnt lgkmcnt(4)
    v_mfma_f32_16x16x32_bf16 v[236:239], v[44:47], v[200:203], v[236:239]
    v_mfma_f32_16x16x32_bf16 v[240:243], v[108:111], v[200:203], v[240:243]
    s_waitcnt lgkmcnt(3)
    v_mfma_f32_16x16x32_bf16 v[236:239], v[48:51], v[204:207], v[236:239]
    v_mfma_f32_16x16x32_bf16 v[240:243], v[112:115], v[204:207], v[240:243]
    s_waitcnt lgkmcnt(2)
    v_mfma_f32_16x16x32_bf16 v[236:239], v[52:55], v[208:211], v[236:239]
    v_mfma_f32_16x16x32_bf16 v[240:243], v[116:119], v[208:211], v[240:243]
    s_waitcnt lgkmcnt(1)
    v_mfma_f32_16x16x32_bf16 v[236:239], v[56:59], v[212:215], v[236:239]
    v_mfma_f32_16x16x32_bf16 v[240:243], v[120:123], v[212:215], v[240:243]
    s_waitcnt lgkmcnt(0)
    v_mfma_f32_16x16x32_bf16 v[236:239], v[60:63], v[216:219], v[236:239]
    v_mfma_f32_16x16x32_bf16 v[240:243], v[124:127], v[216:219], v[240:243]
    s_setprio 2
    s_nop 0
    s_nop 0
    s_nop 0
    s_nop 0
    s_nop 0
    s_nop 0
    v_pk_mul_f32 v[236:237], v[236:237], s[72:73] op_sel_hi:[1,0]
    v_pk_mul_f32 v[238:239], v[238:239], s[72:73] op_sel_hi:[1,0]
    v_pk_mul_f32 v[240:241], v[240:241], s[72:73] op_sel_hi:[1,0]
    v_pk_mul_f32 v[242:243], v[242:243], s[72:73] op_sel_hi:[1,0]
    v_cvt_pk_bf16_f32 v236, v236, v237
    v_cvt_pk_bf16_f32 v237, v238, v239
    v_cvt_pk_bf16_f32 v238, v240, v241
    v_cvt_pk_bf16_f32 v239, v242, v243
    ds_write_b64 v131, v[236:237] offset:3584
    ds_write_b64 v131, v[238:239] offset:3840
    s_mov_b64 exec, 2
    ds_add_u32 v129, v128 offset:0
    s_mov_b64 exec, -1
gw_124:
    ds_read_b32 v141, v129 offset:16
    s_sub_i32 s52, s52, 1
    s_waitcnt lgkmcnt(0)
    v_readfirstlane_b32 s53, v141
    s_cmp_lt_u32 s53, 56
    s_cselect_b32 s53, s52, 0
    s_cmp_gt_i32 s53, 0
    s_cbranch_scc1 gw_124
rwok_126:
    ds_read_b32 v141, v129 offset:64
    s_sub_i32 s52, s52, 1
    s_waitcnt lgkmcnt(0)
    v_cmp_gt_u32 vcc, 0x6110b, v141
    s_and_b32 s53, vcc_lo, 15
    s_cselect_b32 s54, s52, 0
    s_cmp_gt_i32 s54, 0
    s_cbranch_scc1 rw_125
    ds_read2st64_b32 v[216:217], v134 offset0:72 offset1:81
    ds_read2st64_b32 v[218:219], v134 offset0:90 offset1:99
    ds_read_b64 v[208:209], v133 offset:47104
    ds_read_b64 v[210:211], v133 offset:49408
    ds_read_b64 v[212:213], v133 offset:51712
    ds_read_b64 v[214:215], v133 offset:54016
    s_waitcnt lgkmcnt(4)
    v_pk_add_f32 v[216:217], v[216:217], v[218:219]
    v_add_f32 v216, v216, v217
    v_rcp_f32 v218, v216
    v_subrev_u32 v216, s78, v216
    v_cmp_lt_u32 vcc, s79, v216
    s_waitcnt lgkmcnt(0)
    v_pk_add_f32 v[208:209], v[208:209], v[210:211]
    v_pk_add_f32 v[212:213], v[212:213], v[214:215]
    v_pk_add_f32 v[208:209], v[208:209], v[212:213]
    v_pk_mul_f32 v[208:209], v[208:209], v[218:219] op_sel_hi:[1,0]
    v_cvt_pk_bf16_f32 v208, v208, v209
    s_cbranch_vccnz sl_128
    ds_write_b32 v135, v208 offset:9728
slbk_129:
    s_mov_b64 exec, 2
    ds_add_u32 v129, v128 offset:0
    s_mov_b64 exec, -1
    ds_read_b128 v[236:239], v139 offset:0
    ds_read_b128 v[240:243], v139 offset:8192
    ds_read_b128 v[244:247], v139 offset:16384
    ds_read_b128 v[248:251], v139 offset:1024
    ds_read_b128 v[252:255], v139 offset:9216
    ds_read_b128 v[196:199], v139 offset:17408
    ds_read_b128 v[200:203], v139 offset:2048
    ds_read_b128 v[204:207], v139 offset:10240
gw_130:
    ds_read_b32 v141, v129 offset:16
    s_sub_i32 s52, s52, 1
    s_waitcnt lgkmcnt(0)
    v_readfirstlane_b32 s53, v141
    s_cmp_lt_u32 s53, 60
    s_cselect_b32 s53, s52, 0
    s_cmp_gt_i32 s53, 0
    s_cbranch_scc1 gw_130
    s_mov_b32 s53, 1048576
    v_and_or_b32 v224, v137, s53, v132
    ds_read_b128 v[220:223], v224 offset:8064
    ds_read_b128 v[208:211], v224 offset:7680
    ds_read_b128 v[212:215], v224 offset:7808
    ds_read_b128 v[216:219], v224 offset:7936
    s_add_u32 s71, s74, 4194304
    s_waitcnt vmcnt(0)
    s_waitcnt lgkmcnt(3)
    v_mfma_f32_16x16x32_bf16 v[224:227], v[148:151], v[220:223], 0
    s_waitcnt lgkmcnt(2)
    v_mfma_f32_16x16x32_bf16 v[224:227], v[236:239], v[208:211], v[224:227]
    ds_read_b128 v[236:239], v139 offset:18432
    s_waitcnt lgkmcnt(2)
    v_mfma_f32_16x16x32_bf16 v[224:227], v[240:243], v[212:215], v[224:227]
    ds_read_b128 v[240:243], v139 offset:3072
    s_waitcnt lgkmcnt(2)
    v_mfma_f32_16x16x32_bf16 v[224:227], v[244:247], v[216:219], v[224:227]
    ds_read_b128 v[244:247], v139 offset:11264
    v_mfma_f32_16x16x32_bf16 v[232:235], v[152:155], v[220:223], 0
    v_mfma_f32_16x16x32_bf16 v[232:235], v[248:251], v[208:211], v[232:235]
    ds_read_b128 v[248:251], v139 offset:19456
    v_mfma_f32_16x16x32_bf16 v[232:235], v[252:255], v[212:215], v[232:235]
    ds_read_b128 v[252:255], v139 offset:4096
    v_mfma_f32_16x16x32_bf16 v[232:235], v[196:199], v[216:219], v[232:235]
    ds_read_b128 v[196:199], v139 offset:12288
    v_mfma_f32_16x16x32_bf16 v[228:231], v[156:159], v[220:223], 0
    v_mfma_f32_16x16x32_bf16 v[228:231], v[200:203], v[208:211], v[228:231]
    ds_read_b128 v[200:203], v139 offset:20480
    v_mfma_f32_16x16x32_bf16 v[228:231], v[204:207], v[212:215], v[228:231]
    ds_read_b128 v[204:207], v139 offset:5120
    s_waitcnt lgkmcnt(7)
    v_mfma_f32_16x16x32_bf16 v[228:231], v[236:239], v[216:219], v[228:231]
    ds_read_b128 v[236:239], v139 offset:13312
    v_cvt_pk_bf16_f32 v224, v224, v225
    v_cvt_pk_bf16_f32 v225, v226, v227
    v_cvt_pk_bf16_f32 v226, v232, v233
    v_cvt_pk_bf16_f32 v227, v234, v235
    v_min_u32 v224, -2, v224
    buffer_store_dwordx4 v[224:227], v137, s[32:35], s71 offen offset:0 sc1
    v_mfma_f32_16x16x32_bf16 v[232:235], v[160:163], v[220:223], 0
    s_waitcnt lgkmcnt(7)
    v_mfma_f32_16x16x32_bf16 v[232:235], v[240:243], v[208:211], v[232:235]
    ds_read_b128 v[240:243], v139 offset:21504
    s_waitcnt lgkmcnt(7)
    v_mfma_f32_16x16x32_bf16 v[232:235], v[244:247], v[212:215], v[232:235]
    ds_read_b128 v[244:247], v139 offset:6144
    s_waitcnt lgkmcnt(7)
    v_mfma_f32_16x16x32_bf16 v[232:235], v[248:251], v[216:219], v[232:235]
    ds_read_b128 v[248:251], v139 offset:14336
    v_mfma_f32_16x16x32_bf16 v[224:227], v[164:167], v[220:223], 0
    s_waitcnt lgkmcnt(7)
    v_mfma_f32_16x16x32_bf16 v[224:227], v[252:255], v[208:211], v[224:227]
    ds_read_b128 v[252:255], v139 offset:22528
    s_waitcnt lgkmcnt(7)
    v_mfma_f32_16x16x32_bf16 v[224:227], v[196:199], v[212:215], v[224:227]
    ds_read_b128 v[196:199], v139 offset:7168
    s_waitcnt lgkmcnt(7)
    v_mfma_f32_16x16x32_bf16 v[224:227], v[200:203], v[216:219], v[224:227]
    ds_read_b128 v[200:203], v139 offset:15360
    v_cvt_pk_bf16_f32 v228, v228, v229
    v_cvt_pk_bf16_f32 v229, v230, v231
    v_cvt_pk_bf16_f32 v230, v232, v233
    v_cvt_pk_bf16_f32 v231, v234, v235
    v_min_u32 v228, -2, v228
    buffer_store_dwordx4 v[228:231], v137, s[32:35], s71 offen offset:256 sc1
    v_mfma_f32_16x16x32_bf16 v[232:235], v[168:171], v[220:223], 0
    s_waitcnt lgkmcnt(7)
    v_mfma_f32_16x16x32_bf16 v[232:235], v[204:207], v[208:211], v[232:235]
    ds_read_b128 v[204:207], v139 offset:23552
    s_waitcnt lgkmcnt(7)
    v_mfma_f32_16x16x32_bf16 v[232:235], v[236:239], v[212:215], v[232:235]
    s_waitcnt lgkmcnt(6)
    v_mfma_f32_16x16x32_bf16 v[232:235], v[240:243], v[216:219], v[232:235]
    v_mfma_f32_16x16x32_bf16 v[228:231], v[172:175], v[220:223], 0
    s_waitcnt lgkmcnt(5)
    v_mfma_f32_16x16x32_bf16 v[228:231], v[244:247], v[208:211], v[228:231]
    s_waitcnt lgkmcnt(4)
    v_mfma_f32_16x16x32_bf16 v[228:231], v[248:251], v[212:215], v[228:231]
    s_waitcnt lgkmcnt(3)
    v_mfma_f32_16x16x32_bf16 v[228:231], v[252:255], v[216:219], v[228:231]
    v_cvt_pk_bf16_f32 v224, v224, v225
    v_cvt_pk_bf16_f32 v225, v226, v227
    v_cvt_pk_bf16_f32 v226, v232, v233
    v_cvt_pk_bf16_f32 v227, v234, v235
    v_min_u32 v224, -2, v224
    buffer_store_dwordx4 v[224:227], v137, s[32:35], s71 offen offset:512 sc1
    v_mfma_f32_16x16x32_bf16 v[232:235], v[176:179], v[220:223], 0
    s_waitcnt lgkmcnt(2)
    v_mfma_f32_16x16x32_bf16 v[232:235], v[196:199], v[208:211], v[232:235]
    s_waitcnt lgkmcnt(1)
    v_mfma_f32_16x16x32_bf16 v[232:235], v[200:203], v[212:215], v[232:235]
    s_waitcnt lgkmcnt(0)
    v_mfma_f32_16x16x32_bf16 v[232:235], v[204:207], v[216:219], v[232:235]
    s_setprio 2
    s_nop 0
    s_nop 0
    s_nop 0
    s_nop 0
    s_nop 0
    s_nop 0
    v_cvt_pk_bf16_f32 v228, v228, v229
    v_cvt_pk_bf16_f32 v229, v230, v231
    v_cvt_pk_bf16_f32 v230, v232, v233
    v_cvt_pk_bf16_f32 v231, v234, v235
    v_min_u32 v228, -2, v228
    buffer_store_dwordx4 v[228:231], v137, s[32:35], s71 offen offset:768 sc1
    s_lshl_b32 s53, s2, 2
    s_add_u32 s54, s53, s80
    s_lshl_b32 s54, s54, 12
    s_add_u32 s68, s54, 20971520
    s_add_u32 s54, s53, s81
    s_lshl_b32 s54, s54, 12
    s_add_u32 s69, s54, 20971520
    s_add_u32 s54, s53, s82
    s_lshl_b32 s54, s54, 12
    s_add_u32 s70, s54, 20971520
    ds_read_b128 v[236:239], v139 offset:0
    ds_read_b128 v[240:243], v139 offset:8192
    ds_read_b128 v[244:247], v139 offset:16384
    ds_read_b128 v[248:251], v139 offset:1024
    ds_read_b128 v[252:255], v139 offset:9216
rwok_132:
    ds_read_b32 v141, v129 offset:64
    s_sub_i32 s52, s52, 1
    s_waitcnt lgkmcnt(0)
    v_cmp_gt_u32 vcc, 0x6eee8, v141
    s_and_b32 s53, vcc_lo, 15
    s_cselect_b32 s54, s52, 0
    s_cmp_gt_i32 s54, 0
    s_cbranch_scc1 rw_131
    ds_read2st64_b32 v[216:217], v134 offset0:108 offset1:117
    ds_read2st64_b32 v[218:219], v134 offset0:126 offset1:135
    ds_read_b64 v[208:209], v133 offset:56320
    ds_read_b64 v[210:211], v133 offset:58624
    ds_read_b64 v[212:213], v133 offset:60928
    ds_read_b64 v[214:215], v133 offset:63232
    s_waitcnt lgkmcnt(4)
    v_pk_add_f32 v[216:217], v[216:217], v[218:219]
    v_add_f32 v216, v216, v217
    v_rcp_f32 v218, v216
    v_subrev_u32 v216, s78, v216
    v_cmp_lt_u32 vcc, s79, v216
    s_waitcnt lgkmcnt(0)
    v_pk_add_f32 v[208:209], v[208:209], v[210:211]
    v_pk_add_f32 v[212:213], v[212:213], v[214:215]
    v_pk_add_f32 v[208:209], v[208:209], v[212:213]
    v_pk_mul_f32 v[208:209], v[208:209], v[218:219] op_sel_hi:[1,0]
    v_cvt_pk_bf16_f32 v208, v208, v209
    s_cbranch_vccnz sl_134
    ds_write_b32 v135, v208 offset:10752
slbk_135:
    s_mov_b64 exec, 2
    ds_add_u32 v129, v128 offset:0
    s_mov_b64 exec, -1
    s_waitcnt vmcnt(0)
    buffer_load_dwordx4 v[196:199], v136, s[32:35], s68 offen sc1
    buffer_load_dwordx4 v[200:203], v136, s[32:35], s69 offen sc1
    buffer_load_dwordx4 v[204:207], v136, s[32:35], s70 offen sc1
gw_136:
    ds_read_b32 v141, v129 offset:16
    s_sub_i32 s52, s52, 1
    s_waitcnt lgkmcnt(0)
    v_readfirstlane_b32 s53, v141
    s_cmp_lt_u32 s53, 64
    s_cselect_b32 s53, s52, 0
    s_cmp_gt_i32 s53, 0
    s_cbranch_scc1 gw_136
    s_mov_b32 s53, 163840
    v_and_or_b32 v224, v138, s53, v132
    ds_read_b128 v[220:223], v224 offset:8064
    ds_read_b128 v[208:211], v224 offset:7680
    ds_read_b128 v[212:215], v224 offset:7808
    ds_read_b128 v[216:219], v224 offset:7936
    s_waitcnt lgkmcnt(3)
    v_mfma_f32_16x16x32_bf16 v[224:227], v[148:151], v[220:223], 0
    s_waitcnt lgkmcnt(2)
    v_mfma_f32_16x16x32_bf16 v[224:227], v[236:239], v[208:211], v[224:227]
    ds_read_b128 v[236:239], v139 offset:17408
    s_waitcnt lgkmcnt(2)
    v_mfma_f32_16x16x32_bf16 v[224:227], v[240:243], v[212:215], v[224:227]
    ds_read_b128 v[240:243], v139 offset:2048
    s_waitcnt lgkmcnt(2)
    v_mfma_f32_16x16x32_bf16 v[224:227], v[244:247], v[216:219], v[224:227]
    ds_read_b128 v[244:247], v139 offset:10240
    v_mfma_f32_16x16x32_bf16 v[232:235], v[152:155], v[220:223], 0
    v_mfma_f32_16x16x32_bf16 v[232:235], v[248:251], v[208:211], v[232:235]
    ds_read_b128 v[248:251], v139 offset:18432
    v_mfma_f32_16x16x32_bf16 v[232:235], v[252:255], v[212:215], v[232:235]
    ds_read_b128 v[252:255], v139 offset:3072
    s_waitcnt lgkmcnt(4)
    v_mfma_f32_16x16x32_bf16 v[232:235], v[236:239], v[216:219], v[232:235]
    ds_read_b128 v[236:239], v139 offset:11264
    v_mfma_f32_16x16x32_bf16 v[228:231], v[156:159], v[220:223], 0
    s_waitcnt lgkmcnt(4)
    v_mfma_f32_16x16x32_bf16 v[228:231], v[240:243], v[208:211], v[228:231]
    ds_read_b128 v[240:243], v139 offset:19456
    s_waitcnt lgkmcnt(4)
    v_mfma_f32_16x16x32_bf16 v[228:231], v[244:247], v[212:215], v[228:231]
    ds_read_b128 v[244:247], v139 offset:4096
    s_waitcnt lgkmcnt(4)
    v_mfma_f32_16x16x32_bf16 v[228:231], v[248:251], v[216:219], v[228:231]
    ds_read_b128 v[248:251], v139 offset:12288
    ds_write_b128 v138, v[224:227] offset:16000
    ds_write_b128 v138, v[232:235] offset:16016
    v_mfma_f32_16x16x32_bf16 v[232:235], v[160:163], v[220:223], 0
    s_waitcnt lgkmcnt(6)
    v_mfma_f32_16x16x32_bf16 v[232:235], v[252:255], v[208:211], v[232:235]
    ds_read_b128 v[252:255], v139 offset:20480
    s_waitcnt lgkmcnt(6)
    v_mfma_f32_16x16x32_bf16 v[232:235], v[236:239], v[212:215], v[232:235]
    ds_read_b128 v[236:239], v139 offset:5120
    s_waitcnt lgkmcnt(6)
    v_mfma_f32_16x16x32_bf16 v[232:235], v[240:243], v[216:219], v[232:235]
    ds_read_b128 v[240:243], v139 offset:13312
    v_mfma_f32_16x16x32_bf16 v[224:227], v[164:167], v[220:223], 0
    s_waitcnt lgkmcnt(6)
    v_mfma_f32_16x16x32_bf16 v[224:227], v[244:247], v[208:211], v[224:227]
    ds_read_b128 v[244:247], v139 offset:21504
    s_waitcnt lgkmcnt(6)
    v_mfma_f32_16x16x32_bf16 v[224:227], v[248:251], v[212:215], v[224:227]
    ds_read_b128 v[248:251], v139 offset:6144
    s_waitcnt lgkmcnt(4)
    v_mfma_f32_16x16x32_bf16 v[224:227], v[252:255], v[216:219], v[224:227]
    ds_read_b128 v[252:255], v139 offset:14336
    ds_write_b128 v138, v[228:231] offset:16128
    ds_write_b128 v138, v[232:235] offset:16144
    v_mfma_f32_16x16x32_bf16 v[232:235], v[168:171], v[220:223], 0
    s_waitcnt lgkmcnt(6)
    v_mfma_f32_16x16x32_bf16 v[232:235], v[236:239], v[208:211], v[232:235]
    ds_read_b128 v[236:239], v139 offset:22528
    s_waitcnt lgkmcnt(6)
    v_mfma_f32_16x16x32_bf16 v[232:235], v[240:243], v[212:215], v[232:235]
    ds_read_b128 v[240:243], v139 offset:7168
    s_waitcnt lgkmcnt(6)
    v_mfma_f32_16x16x32_bf16 v[232:235], v[244:247], v[216:219], v[232:235]
    ds_read_b128 v[244:247], v139 offset:15360
    v_mfma_f32_16x16x32_bf16 v[228:231], v[172:175], v[220:223], 0
    s_waitcnt lgkmcnt(6)
    v_mfma_f32_16x16x32_bf16 v[228:231], v[248:251], v[208:211], v[228:231]
    ds_read_b128 v[248:251], v139 offset:23552
    s_waitcnt lgkmcnt(6)
    v_mfma_f32_16x16x32_bf16 v[228:231], v[252:255], v[212:215], v[228:231]
    s_waitcnt lgkmcnt(3)
    v_mfma_f32_16x16x32_bf16 v[228:231], v[236:239], v[216:219], v[228:231]
    ds_write_b128 v138, v[224:227] offset:16256
    ds_write_b128 v138, v[232:235] offset:16272
    v_mfma_f32_16x16x32_bf16 v[232:235], v[176:179], v[220:223], 0
    s_waitcnt lgkmcnt(4)
    v_mfma_f32_16x16x32_bf16 v[232:235], v[240:243], v[208:211], v[232:235]
    s_waitcnt lgkmcnt(3)
    v_mfma_f32_16x16x32_bf16 v[232:235], v[244:247], v[212:215], v[232:235]
    s_waitcnt lgkmcnt(2)
    v_mfma_f32_16x16x32_bf16 v[232:235], v[248:251], v[216:219], v[232:235]
    s_setprio 2
    s_nop 0
    s_nop 0
    s_nop 0
    s_nop 0
    s_nop 0
    s_nop 0
    ds_write_b128 v138, v[228:231] offset:16384
    ds_write_b128 v138, v[232:235] offset:16400
    s_mov_b64 exec, 2
    ds_add_u32 v129, v128 offset:0
    s_mov_b64 exec, -1
    s_mul_i32 s55, s49, 2112
    v_lshl_add_u32 v222, v128, 5, s55
    v_lshlrev_b32 v208, 16, v192
    v_and_b32 v209, 0xffff0000, v192
    v_lshlrev_b32 v210, 16, v193
    v_and_b32 v211, 0xffff0000, v193
    v_lshlrev_b32 v212, 16, v194
    v_and_b32 v213, 0xffff0000, v194
    v_lshlrev_b32 v214, 16, v195
    v_and_b32 v215, 0xffff0000, v195
    s_waitcnt vmcnt(0)
ck_137:
    v_max3_u32 v216, v196, v200, v204
    v_cmp_eq_u32 vcc, -1, v216
    s_cbranch_vccnz ckrt_139
ckok_138:
    s_lshl_b32 s53, s49, 13
    s_add_u32 s53, s53, 524288
    s_add_u32 s54, s53, 4096
    buffer_load_dwordx4 v[224:227], v129, s[32:35], s53 offen offset:0 sc1
    buffer_load_dwordx4 v[228:231], v129, s[32:35], s53 offen offset:1024 sc1
    buffer_load_dwordx4 v[232:235], v129, s[32:35], s53 offen offset:2048 sc1
    buffer_load_dwordx4 v[236:239], v129, s[32:35], s53 offen offset:3072 sc1
    buffer_load_dwordx4 v[240:243], v129, s[32:35], s54 offen offset:0 sc1
    buffer_load_dwordx4 v[244:247], v129, s[32:35], s54 offen offset:1024 sc1
    buffer_load_dwordx4 v[248:251], v129, s[32:35], s54 offen offset:2048 sc1
    buffer_load_dwordx4 v[252:255], v129, s[32:35], s54 offen offset:3072 sc1
    v_dot2c_f32_bf16 v208, s75, v196
    v_dot2c_f32_bf16 v209, s76, v196
    v_dot2c_f32_bf16 v210, s75, v197
    v_dot2c_f32_bf16 v211, s76, v197
    v_dot2c_f32_bf16 v212, s75, v198
    v_dot2c_f32_bf16 v213, s76, v198
    v_dot2c_f32_bf16 v214, s75, v199
    v_dot2c_f32_bf16 v215, s76, v199
    v_dot2c_f32_bf16 v208, s75, v200
    v_dot2c_f32_bf16 v209, s76, v200
    v_dot2c_f32_bf16 v210, s75, v201
    v_dot2c_f32_bf16 v211, s76, v201
    v_dot2c_f32_bf16 v212, s75, v202
    v_dot2c_f32_bf16 v213, s76, v202
    v_dot2c_f32_bf16 v214, s75, v203
    v_dot2c_f32_bf16 v215, s76, v203
    v_dot2c_f32_bf16 v208, s75, v204
    v_dot2c_f32_bf16 v209, s76, v204
    v_dot2c_f32_bf16 v210, s75, v205
    v_dot2c_f32_bf16 v211, s76, v205
    v_dot2c_f32_bf16 v212, s75, v206
    v_dot2c_f32_bf16 v213, s76, v206
    v_dot2c_f32_bf16 v214, s75, v207
    v_dot2c_f32_bf16 v215, s76, v207
gw_140:
    ds_read_b32 v141, v129 offset:16
    s_sub_i32 s52, s52, 1
    s_waitcnt lgkmcnt(0)
    v_readfirstlane_b32 s53, v141
    s_cmp_lt_u32 s53, 68
    s_cselect_b32 s53, s52, 0
    s_cmp_gt_i32 s53, 0
    s_cbranch_scc1 gw_140
    ds_read_b128 v[196:199], v222 offset:16000
    ds_read_b128 v[200:203], v222 offset:16016
    s_add_u32 s55, s57, 8392704
    s_waitcnt lgkmcnt(0)
    v_pk_add_f32 v[208:209], v[208:209], v[196:197]
    v_pk_add_f32 v[210:211], v[210:211], v[198:199]
    v_pk_add_f32 v[212:213], v[212:213], v[200:201]
    v_pk_add_f32 v[214:215], v[214:215], v[202:203]
    v_pk_add_f32 v[216:217], v[208:209], v[210:211]
    v_pk_mul_f32 v[220:221], v[208:209], v[208:209]
    v_pk_add_f32 v[218:219], v[212:213], v[214:215]
    v_pk_fma_f32 v[220:221], v[210:211], v[210:211], v[220:221]
    v_pk_add_f32 v[216:217], v[216:217], v[218:219]
    v_pk_fma_f32 v[220:221], v[212:213], v[212:213], v[220:221]
    v_add_f32 v216, v216, v217
    v_pk_fma_f32 v[220:221], v[214:215], v[214:215], v[220:221]
    v_add_f32 v217, v220, v221
    v_lshlrev_b32 v196, 16, v184
    v_and_b32 v197, 0xffff0000, v184
    v_permlane32_swap_b32 v216, v217
    v_add_f32 v216, v216, v217
    v_lshlrev_b32 v198, 16, v185
    v_and_b32 v199, 0xffff0000, v185
    v_add_f32_dpp v216, v216, v216 quad_perm:[1,0,3,2] row_mask:0xf bank_mask:0xf
    v_lshlrev_b32 v200, 16, v186
    v_and_b32 v201, 0xffff0000, v186
    v_add_f32_dpp v216, v216, v216 quad_perm:[2,3,0,1] row_mask:0xf bank_mask:0xf
    v_lshlrev_b32 v202, 16, v187
    v_and_b32 v203, 0xffff0000, v187
    v_add_f32_dpp v216, v216, v216 row_half_mirror row_mask:0xf bank_mask:0xf
    s_nop 0
    s_nop 0
    v_add_f32_dpp v216, v216, v216 row_mirror row_mask:0xf bank_mask:0xf
    s_nop 0
    s_nop 0
    v_add_f32_dpp v216, v216, v216 row_bcast:15 row_mask:0xa bank_mask:0xf
    v_mul_f32 v216, 0x3b000000, v216
    s_nop 0
    v_readlane_b32 s59, v216, 63
    v_readlane_b32 s58, v216, 31
    s_nop 0
    v_mov_b32 v216, s59
    v_fma_f32 v216, -s58, s58, v216
    v_add_f32 v216, s91, abs(v216)
    v_rsq_f32 v216, v216
    s_nop 0
    v_mul_f32 v217, s58, v216
    v_pk_fma_f32 v[204:205], v[208:209], v[216:217], v[216:217] op_sel:[0,0,1] op_sel_hi:[1,0,1] neg_lo:[0,0,1] neg_hi:[0,0,1]
    v_pk_fma_f32 v[206:207], v[210:211], v[216:217], v[216:217] op_sel:[0,0,1] op_sel_hi:[1,0,1] neg_lo:[0,0,1] neg_hi:[0,0,1]
    v_pk_fma_f32 v[208:209], v[204:205], v[196:197], v[208:209]
    v_pk_fma_f32 v[210:211], v[206:207], v[198:199], v[210:211]
    v_pk_fma_f32 v[204:205], v[212:213], v[216:217], v[216:217] op_sel:[0,0,1] op_sel_hi:[1,0,1] neg_lo:[0,0,1] neg_hi:[0,0,1]
    v_pk_fma_f32 v[206:207], v[214:215], v[216:217], v[216:217] op_sel:[0,0,1] op_sel_hi:[1,0,1] neg_lo:[0,0,1] neg_hi:[0,0,1]
    v_pk_fma_f32 v[212:213], v[204:205], v[200:201], v[212:213]
    v_pk_fma_f32 v[214:215], v[206:207], v[202:203], v[214:215]
    v_pk_add_f32 v[216:217], v[208:209], v[210:211]
    v_pk_mul_f32 v[220:221], v[208:209], v[208:209]
    v_pk_add_f32 v[218:219], v[212:213], v[214:215]
    v_pk_fma_f32 v[220:221], v[210:211], v[210:211], v[220:221]
    v_pk_add_f32 v[216:217], v[216:217], v[218:219]
    v_pk_fma_f32 v[220:221], v[212:213], v[212:213], v[220:221]
    v_add_f32 v216, v216, v217
    v_pk_fma_f32 v[220:221], v[214:215], v[214:215], v[220:221]
    v_add_f32 v217, v220, v221
    v_cvt_pk_bf16_f32 v192, v208, v209
    v_cvt_pk_bf16_f32 v193, v210, v211
    v_permlane32_swap_b32 v216, v217
    v_add_f32 v216, v216, v217
    v_cvt_pk_bf16_f32 v194, v212, v213
    v_cvt_pk_bf16_f32 v195, v214, v215
    v_add_f32_dpp v216, v216, v216 quad_perm:[1,0,3,2] row_mask:0xf bank_mask:0xf
    s_mul_i32 s53, s49, 1056
    v_add_u32 v200, s53, v129
    v_add_f32_dpp v216, v216, v216 quad_perm:[2,3,0,1] row_mask:0xf bank_mask:0xf
    v_and_b32 v222, 12, v128
    v_mul_u32_u24 v222, 1056, v222
    v_add_f32_dpp v216, v216, v216 row_half_mirror row_mask:0xf bank_mask:0xf
    v_sub_u32 v222, v130, v222
    s_lshl_b32 s53, s49, 8
    v_add_f32_dpp v216, v216, v216 row_mirror row_mask:0xf bank_mask:0xf
    v_add_u32 v222, s53, v222
    s_nop 0
    v_add_f32_dpp v216, v216, v216 row_bcast:15 row_mask:0xa bank_mask:0xf
    v_mul_f32 v216, 0x3b000000, v216
    s_nop 0
    v_readlane_b32 s59, v216, 63
    v_readlane_b32 s58, v216, 31
    s_nop 0
    v_mov_b32 v216, s59
    v_fma_f32 v216, -s58, s58, v216
    v_add_f32 v216, s91, abs(v216)
    v_rsq_f32 v216, v216
    s_nop 0
    v_mul_f32 v217, s58, v216
    v_pk_fma_f32 v[208:209], v[208:209], v[216:217], v[216:217] op_sel:[0,0,1] op_sel_hi:[1,0,1] neg_lo:[0,0,1] neg_hi:[0,0,1]
    v_pk_fma_f32 v[210:211], v[210:211], v[216:217], v[216:217] op_sel:[0,0,1] op_sel_hi:[1,0,1] neg_lo:[0,0,1] neg_hi:[0,0,1]
    v_pk_fma_f32 v[212:213], v[212:213], v[216:217], v[216:217] op_sel:[0,0,1] op_sel_hi:[1,0,1] neg_lo:[0,0,1] neg_hi:[0,0,1]
    v_pk_fma_f32 v[214:215], v[214:215], v[216:217], v[216:217] op_sel:[0,0,1] op_sel_hi:[1,0,1] neg_lo:[0,0,1] neg_hi:[0,0,1]
    v_cvt_pk_bf16_f32 v196, v208, v209
    v_cvt_pk_bf16_f32 v197, v210, v211
    v_cvt_pk_bf16_f32 v198, v212, v213
    v_cvt_pk_bf16_f32 v199, v214, v215
    v_min_u32 v196, -2, v196
    ds_write_b128 v200, v[196:199] offset:24448
    s_mov_b64 exec, 2
    ds_add_u32 v129, v128 offset:0
    s_mov_b64 exec, -1
    buffer_store_dwordx4 v[196:199], v129, s[32:35], s55 offen sc1
    s_lshl_b32 s53, s49, 9
    v_and_b32 v220, 0xff, v137
    v_add_u32 v220, s53, v220
    v_add_u32 v221, s53, v129
gw_141:
    ds_read_b32 v141, v129 offset:16
    s_sub_i32 s52, s52, 1
    s_waitcnt lgkmcnt(0)
    v_readfirstlane_b32 s53, v141
    s_cmp_lt_u32 s53, 72
    s_cselect_b32 s53, s52, 0
    s_cmp_gt_i32 s53, 0
    s_cbranch_scc1 gw_141
    s_waitcnt vmcnt(1)
    ds_read_b128 v[196:199], v222 offset:24448
    ds_read_b128 v[200:203], v222 offset:24512
    ds_read_b128 v[204:207], v222 offset:24576
    ds_read_b128 v[208:211], v222 offset:24640
    s_waitcnt lgkmcnt(3)
    v_mfma_f32_16x16x32_bf16 v[212:215], v[224:227], v[196:199], 0
    v_mfma_f32_16x16x32_bf16 v[216:219], v[196:199], v[240:243], 0
    s_waitcnt lgkmcnt(2)
    v_mfma_f32_16x16x32_bf16 v[212:215], v[228:231], v[200:203], v[212:215]
    v_mfma_f32_16x16x32_bf16 v[216:219], v[200:203], v[244:247], v[216:219]
    s_waitcnt lgkmcnt(1)
    v_mfma_f32_16x16x32_bf16 v[212:215], v[232:235], v[204:207], v[212:215]
    v_mfma_f32_16x16x32_bf16 v[216:219], v[204:207], v[248:251], v[216:219]
    s_waitcnt lgkmcnt(0)
    v_mfma_f32_16x16x32_bf16 v[212:215], v[236:239], v[208:211], v[212:215]
    v_mfma_f32_16x16x32_bf16 v[216:219], v[208:211], v[252:255], v[216:219]
    s_mov_b32 s54, 458752
    s_nop 0
    s_nop 0
    s_nop 0
    s_nop 0
    s_mov_b32 exec_lo, 0xf000f
    s_mov_b32 exec_hi, 0xf000f
    ds_write_b128 v220, v[212:215] offset:1024
    s_mov_b32 exec_lo, 65535
    s_mov_b32 exec_hi, 0
    ds_write_b128 v221, v[216:219] offset:1280
    s_mov_b64 exec, 2
    ds_add_u32 v129, v128 offset:0
    s_mov_b64 exec, -1
gw_142:
    ds_read_b32 v141, v129 offset:16
    s_sub_i32 s52, s52, 1
    s_waitcnt lgkmcnt(0)
    v_readfirstlane_b32 s53, v141
    s_cmp_lt_u32 s53, 76
    s_cselect_b32 s53, s52, 0
    s_cmp_gt_i32 s53, 0
    s_cbranch_scc1 gw_142
    s_cmp_eq_u32 s49, 0
    s_cbranch_scc0 kvend_143
    s_mov_b32 exec_hi, 0
    ds_read_b128 v[196:199], v129 offset:1024
    ds_read_b128 v[200:203], v129 offset:1536
    ds_read_b128 v[204:207], v129 offset:2048
    ds_read_b128 v[208:211], v129 offset:2560
    s_waitcnt lgkmcnt(2)
    v_pk_add_f32 v[196:197], v[196:197], v[200:201]
    v_pk_add_f32 v[198:199], v[198:199], v[202:203]
    s_waitcnt lgkmcnt(0)
    v_pk_add_f32 v[204:205], v[204:205], v[208:209]
    v_pk_add_f32 v[206:207], v[206:207], v[210:211]
    v_pk_add_f32 v[196:197], v[196:197], v[204:205]
    v_pk_add_f32 v[198:199], v[198:199], v[206:207]
    v_cvt_pk_bf16_f32 v196, v196, v197
    v_cvt_pk_bf16_f32 v197, v198, v199
    v_min_u32 v196, -2, v196
    buffer_store_dwordx2 v[196:197], v140, s[32:35], s54 offen sc1
    s_waitcnt vmcnt(0)
    s_mov_b64 exec, 2
    ds_write_b32 v129, v128 offset:16
    s_mov_b64 exec, -1
kvend_143:
    s_and_b32 s53, s57, 0x1f8fff
    s_add_u32 s53, s53, 8392704
    s_lshl_b32 s54, s80, 13
    s_add_u32 s68, s53, s54
    s_lshl_b32 s54, s81, 13
    s_add_u32 s69, s53, s54
    s_lshl_b32 s54, s82, 13
    s_add_u32 s70, s53, s54
    s_waitcnt vmcnt(1)
    s_cmp_eq_u32 s49, 0
    s_cbranch_scc1 xw_144
    s_waitcnt vmcnt(0)
xw_144:
    buffer_load_dwordx4 v[196:199], v129, s[32:35], s68 offen sc1
    buffer_load_dwordx4 v[200:203], v129, s[32:35], s69 offen sc1
    buffer_load_dwordx4 v[204:207], v129, s[32:35], s70 offen sc1
    s_mul_i32 s55, s49, 1056
    v_add_u32 v208, s55, v129
    s_waitcnt vmcnt(0)
ck_145:
    v_max3_u32 v209, v196, v200, v204
    v_cmp_eq_u32 vcc, -1, v209
    s_cbranch_vccnz ckrt_147
ckok_146:
    ds_write_b128 v208, v[196:199] offset:11776
    ds_write_b128 v208, v[200:203] offset:16000
    ds_write_b128 v208, v[204:207] offset:20224
    s_mov_b64 exec, 2
    ds_add_u32 v129, v128 offset:0
    s_mov_b64 exec, -1
gw_148:
    ds_read_b32 v141, v129 offset:16
    s_sub_i32 s52, s52, 1
    s_waitcnt lgkmcnt(0)
    v_readfirstlane_b32 s53, v141
    s_cmp_lt_u32 s53, 80
    s_cselect_b32 s53, s52, 0
    s_cmp_gt_i32 s53, 0
    s_cbranch_scc1 gw_148
    s_lshl_b32 s53, s80, 14
    s_add_u32 s53, s53, s74
    s_add_u32 s54, s53, 12582912
    buffer_store_dwordx4 v[144:147], v129, s[32:35], s54 offen sc1
    s_lshl_b32 s53, s81, 14
    s_add_u32 s53, s53, s74
    s_add_u32 s54, s53, 12582912
    buffer_store_dwordx4 v[144:147], v129, s[32:35], s54 offen sc1
    s_lshl_b32 s53, s82, 14
    s_add_u32 s53, s53, s74
    s_add_u32 s54, s53, 12582912
    buffer_store_dwordx4 v[144:147], v129, s[32:35], s54 offen sc1
    s_setprio 0
    ds_read_b128 v[196:199], v130 offset:11776
    ds_read_b128 v[200:203], v130 offset:11840
    ds_read_b128 v[204:207], v130 offset:11904
    ds_read_b128 v[208:211], v130 offset:11968
    ds_read_b128 v[212:215], v130 offset:12032
    ds_read_b128 v[216:219], v130 offset:12096
PAD10:
    s_cbranch_execz PADRET
    ds_read_b128 v[220:223], v130 offset:12160
    ds_read_b128 v[224:227], v130 offset:12224
    ds_read_b128 v[228:231], v130 offset:12288
    ds_read_b128 v[232:235], v130 offset:12352
    s_waitcnt lgkmcnt(9)
    v_mfma_f32_16x16x32_bf16 v[236:239], v[0:3], v[196:199], 0
    v_mfma_f32_16x16x32_bf16 v[240:243], v[64:67], v[196:199], 0
    ds_read_b128 v[196:199], v130 offset:12416
    s_waitcnt lgkmcnt(9)
    v_mfma_f32_16x16x32_bf16 v[236:239], v[4:7], v[200:203], v[236:239]
    v_mfma_f32_16x16x32_bf16 v[240:243], v[68:71], v[200:203], v[240:243]
    ds_read_b128 v[200:203], v130 offset:12480
    s_waitcnt lgkmcnt(9)
    v_mfma_f32_16x16x32_bf16 v[236:239], v[8:11], v[204:207], v[236:239]
    v_mfma_f32_16x16x32_bf16 v[240:243], v[72:75], v[204:207], v[240:243]
    ds_read_b128 v[204:207], v130 offset:12544
    s_waitcnt lgkmcnt(9)
    v_mfma_f32_16x16x32_bf16 v[236:239], v[12:15], v[208:211], v[236:239]
    v_mfma_f32_16x16x32_bf16 v[240:243], v[76:79], v[208:211], v[240:243]
    ds_read_b128 v[208:211], v130 offset:12608
    s_waitcnt lgkmcnt(9)
    v_mfma_f32_16x16x32_bf16 v[236:239], v[16:19], v[212:215], v[236:239]
    v_mfma_f32_16x16x32_bf16 v[240:243], v[80:83], v[212:215], v[240:243]
    ds_read_b128 v[212:215], v130 offset:12672
    s_waitcnt lgkmcnt(9)
    v_mfma_f32_16x16x32_bf16 v[236:239], v[20:23], v[216:219], v[236:239]
    v_mfma_f32_16x16x32_bf16 v[240:243], v[84:87], v[216:219], v[240:243]
    ds_read_b128 v[216:219], v130 offset:12736
    s_waitcnt lgkmcnt(9)
    v_mfma_f32_16x16x32_bf16 v[236:239], v[24:27], v[220:223], v[236:239]
    v_mfma_f32_16x16x32_bf16 v[240:243], v[88:91], v[220:223], v[240:243]
    s_waitcnt lgkmcnt(8)
    v_mfma_f32_16x16x32_bf16 v[236:239], v[28:31], v[224:227], v[236:239]
    v_mfma_f32_16x16x32_bf16 v[240:243], v[92:95], v[224:227], v[240:243]
    s_waitcnt lgkmcnt(7)
    v_mfma_f32_16x16x32_bf16 v[236:239], v[32:35], v[228:231], v[236:239]
    v_mfma_f32_16x16x32_bf16 v[240:243], v[96:99], v[228:231], v[240:243]
    s_waitcnt lgkmcnt(6)
    v_mfma_f32_16x16x32_bf16 v[236:239], v[36:39], v[232:235], v[236:239]
    v_mfma_f32_16x16x32_bf16 v[240:243], v[100:103], v[232:235], v[240:243]
    s_waitcnt lgkmcnt(5)
    v_mfma_f32_16x16x32_bf16 v[236:239], v[40:43], v[196:199], v[236:239]
    v_mfma_f32_16x16x32_bf16 v[240:243], v[104:107], v[196:199], v[240:243]
    s_waitcnt lgkmcnt(4)
    v_mfma_f32_16x16x32_bf16 v[236:239], v[44:47], v[200:203], v[236:239]
    v_mfma_f32_16x16x32_bf16 v[240:243], v[108:111], v[200:203], v[240:243]
    s_waitcnt lgkmcnt(3)
    v_mfma_f32_16x16x32_bf16 v[236:239], v[48:51], v[204:207], v[236:239]
    v_mfma_f32_16x16x32_bf16 v[240:243], v[112:115], v[204:207], v[240:243]
    s_waitcnt lgkmcnt(2)
    v_mfma_f32_16x16x32_bf16 v[236:239], v[52:55], v[208:211], v[236:239]
    v_mfma_f32_16x16x32_bf16 v[240:243], v[116:119], v[208:211], v[240:243]
    s_waitcnt lgkmcnt(1)
    v_mfma_f32_16x16x32_bf16 v[236:239], v[56:59], v[212:215], v[236:239]
    v_mfma_f32_16x16x32_bf16 v[240:243], v[120:123], v[212:215], v[240:243]
    s_waitcnt lgkmcnt(0)
    v_mfma_f32_16x16x32_bf16 v[236:239], v[60:63], v[216:219], v[236:239]
    v_mfma_f32_16x16x32_bf16 v[240:243], v[124:127], v[216:219], v[240:243]
    s_setprio 2
    s_nop 0
    s_nop 0
    s_nop 0
    s_nop 0
    s_nop 0
    s_nop 0
    v_pk_mul_f32 v[236:237], v[236:237], s[72:73] op_sel_hi:[1,0]
    v_pk_mul_f32 v[238:239], v[238:239], s[72:73] op_sel_hi:[1,0]
    v_pk_mul_f32 v[240:241], v[240:241], s[72:73] op_sel_hi:[1,0]
    v_pk_mul_f32 v[242:243], v[242:243], s[72:73] op_sel_hi:[1,0]
    v_cvt_pk_bf16_f32 v236, v236, v237
    v_cvt_pk_bf16_f32 v237, v238, v239
    v_cvt_pk_bf16_f32 v238, v240, v241
    v_cvt_pk_bf16_f32 v239, v242, v243
    ds_write_b64 v131, v[236:237] offset:7680
    ds_write_b64 v131, v[238:239] offset:7936
    s_mov_b64 exec, 2
    ds_add_u32 v129, v128 offset:0
    s_mov_b64 exec, -1
gw_149:
    ds_read_b32 v141, v129 offset:16
    s_sub_i32 s52, s52, 1
    s_waitcnt lgkmcnt(0)
    v_readfirstlane_b32 s53, v141
    s_cmp_lt_u32 s53, 84
    s_cselect_b32 s53, s52, 0
    s_cmp_gt_i32 s53, 0
    s_cbranch_scc1 gw_149
    ds_read_b128 v[0:3], v139 offset:0
    ds_read_b128 v[4:7], v139 offset:8192
    ds_read_b128 v[8:11], v139 offset:16384
    ds_read_b128 v[12:15], v139 offset:1024
    ds_read_b128 v[16:19], v139 offset:9216
    ds_read_b128 v[20:23], v139 offset:17408
    ds_read_b128 v[24:27], v139 offset:2048
    ds_read_b128 v[28:31], v139 offset:10240
    ds_read_b128 v[32:35], v139 offset:18432
    ds_read_b128 v[36:39], v139 offset:3072
    ds_read_b128 v[40:43], v139 offset:11264
    ds_read_b128 v[44:47], v139 offset:19456
    s_waitcnt lgkmcnt(6)
    ds_read_b128 v[48:51], v139 offset:4096
    ds_read_b128 v[52:55], v139 offset:12288
    ds_read_b128 v[56:59], v139 offset:20480
    ds_read_b128 v[60:63], v139 offset:5120
    ds_read_b128 v[64:67], v139 offset:13312
    ds_read_b128 v[68:71], v139 offset:21504
    ds_read_b128 v[72:75], v139 offset:6144
    ds_read_b128 v[76:79], v139 offset:14336
    ds_read_b128 v[80:83], v139 offset:22528
    ds_read_b128 v[84:87], v139 offset:7168
    ds_read_b128 v[88:91], v139 offset:15360
    ds_read_b128 v[92:95], v139 offset:23552
rwok_151:
    ds_read_b32 v141, v129 offset:64
    s_sub_i32 s52, s52, 1
    s_waitcnt lgkmcnt(0)
    v_cmp_gt_u32 vcc, 0x9887f, v141
    s_and_b32 s53, vcc_lo, 15
    s_cselect_b32 s54, s52, 0
    s_cmp_gt_i32 s54, 0
    s_cbranch_scc1 rw_150
    ds_read2st64_b32 v[216:217], v134 offset0:0 offset1:9
    ds_read2st64_b32 v[218:219], v134 offset0:18 offset1:27
    ds_read_b64 v[208:209], v133 offset:28672
    ds_read_b64 v[210:211], v133 offset:30976
    ds_read_b64 v[212:213], v133 offset:33280
    ds_read_b64 v[214:215], v133 offset:35584
    ds_read2st64_b32 v[228:229], v134 offset0:36 offset1:45
    ds_read2st64_b32 v[230:231], v134 offset0:54 offset1:63
    ds_read_b64 v[220:221], v133 offset:37888
    ds_read_b64 v[222:223], v133 offset:40192
    ds_read_b64 v[224:225], v133 offset:42496
    ds_read_b64 v[226:227], v133 offset:44800
    s_waitcnt lgkmcnt(10)
    v_pk_add_f32 v[216:217], v[216:217], v[218:219]
    v_add_f32 v216, v216, v217
    v_rcp_f32 v218, v216
    v_subrev_u32 v216, s78, v216
    v_cmp_lt_u32 vcc, s79, v216
    s_waitcnt lgkmcnt(6)
    ds_read2st64_b32 v[240:241], v134 offset0:72 offset1:81
    ds_read2st64_b32 v[242:243], v134 offset0:90 offset1:99
    ds_read_b64 v[232:233], v133 offset:47104
    ds_read_b64 v[234:235], v133 offset:49408
    ds_read_b64 v[236:237], v133 offset:51712
    ds_read_b64 v[238:239], v133 offset:54016
    v_pk_add_f32 v[208:209], v[208:209], v[210:211]
    v_pk_add_f32 v[212:213], v[212:213], v[214:215]
    v_pk_add_f32 v[208:209], v[208:209], v[212:213]
    v_pk_mul_f32 v[208:209], v[208:209], v[218:219] op_sel_hi:[1,0]
    v_cvt_pk_bf16_f32 v208, v208, v209
    s_cbranch_vccnz sl_153
    ds_write_b32 v135, v208 offset:3584
slbk_154:
    s_waitcnt lgkmcnt(11)
    v_pk_add_f32 v[228:229], v[228:229], v[230:231]
    v_add_f32 v228, v228, v229
    v_rcp_f32 v230, v228
    v_subrev_u32 v228, s78, v228
    v_cmp_lt_u32 vcc, s79, v228
    s_waitcnt lgkmcnt(7)
    v_pk_add_f32 v[220:221], v[220:221], v[222:223]
    v_pk_add_f32 v[224:225], v[224:225], v[226:227]
    v_pk_add_f32 v[220:221], v[220:221], v[224:225]
    v_pk_mul_f32 v[220:221], v[220:221], v[230:231] op_sel_hi:[1,0]
    v_cvt_pk_bf16_f32 v220, v220, v221
    s_cbranch_vccnz sl_155
    ds_write_b32 v135, v220 offset:4608
slbk_156:
    s_waitcnt lgkmcnt(6)
    v_pk_add_f32 v[240:241], v[240:241], v[242:243]
    v_add_f32 v240, v240, v241
    v_rcp_f32 v242, v240
    v_subrev_u32 v240, s78, v240
    v_cmp_lt_u32 vcc, s79, v240
    s_waitcnt lgkmcnt(2)
    v_pk_add_f32 v[232:233], v[232:233], v[234:235]
    v_pk_add_f32 v[236:237], v[236:237], v[238:239]
    v_pk_add_f32 v[232:233], v[232:233], v[236:237]
    v_pk_mul_f32 v[232:233], v[232:233], v[242:243] op_sel_hi:[1,0]
    v_cvt_pk_bf16_f32 v232, v232, v233
    s_cbranch_vccnz sl_157
    ds_write_b32 v135, v232 offset:5632
slbk_158:
rwok_160:
    ds_read_b32 v141, v129 offset:64
    s_sub_i32 s52, s52, 1
    s_waitcnt lgkmcnt(0)
    v_cmp_gt_u32 vcc, 0xa665c, v141
    s_and_b32 s53, vcc_lo, 15
    s_cselect_b32 s54, s52, 0
    s_cmp_gt_i32 s54, 0
    s_cbranch_scc1 rw_159
    ds_read2st64_b32 v[216:217], v134 offset0:108 offset1:117
    ds_read2st64_b32 v[218:219], v134 offset0:126 offset1:135
    ds_read_b64 v[208:209], v133 offset:56320
    ds_read_b64 v[210:211], v133 offset:58624
    ds_read_b64 v[212:213], v133 offset:60928
    ds_read_b64 v[214:215], v133 offset:63232
    s_waitcnt lgkmcnt(4)
    v_pk_add_f32 v[216:217], v[216:217], v[218:219]
    v_add_f32 v216, v216, v217
    v_rcp_f32 v218, v216
    v_subrev_u32 v216, s78, v216
    v_cmp_lt_u32 vcc, s79, v216
    s_waitcnt lgkmcnt(0)
    v_pk_add_f32 v[208:209], v[208:209], v[210:211]
    v_pk_add_f32 v[212:213], v[212:213], v[214:215]
    v_pk_add_f32 v[208:209], v[208:209], v[212:213]
    v_pk_mul_f32 v[208:209], v[208:209], v[218:219] op_sel_hi:[1,0]
    v_cvt_pk_bf16_f32 v208, v208, v209
    s_cbranch_vccnz sl_162
    ds_write_b32 v135, v208 offset:6656
slbk_163:
    s_mov_b64 exec, 2
    ds_add_u32 v129, v128 offset:0
    s_mov_b64 exec, -1
gw_164:
    ds_read_b32 v141, v129 offset:16
    s_sub_i32 s52, s52, 1
    s_waitcnt lgkmcnt(0)
    v_readfirstlane_b32 s53, v141
    s_cmp_lt_u32 s53, 88
    s_cselect_b32 s53, s52, 0
    s_cmp_gt_i32 s53, 0
    s_cbranch_scc1 gw_164
    ds_read_b128 v[220:223], v132 offset:3968
    ds_read_b128 v[208:211], v132 offset:3584
    ds_read_b128 v[212:215], v132 offset:3712
    ds_read_b128 v[216:219], v132 offset:3840
    s_add_u32 s71, s74, 8388608
    s_waitcnt vmcnt(0)
    s_setprio 0
    s_waitcnt lgkmcnt(3)
    v_mfma_f32_16x16x32_bf16 v[224:227], v[148:151], v[220:223], 0
    s_waitcnt lgkmcnt(2)
    v_mfma_f32_16x16x32_bf16 v[224:227], v[0:3], v[208:211], v[224:227]
    s_waitcnt lgkmcnt(1)
    v_mfma_f32_16x16x32_bf16 v[224:227], v[4:7], v[212:215], v[224:227]
    s_waitcnt lgkmcnt(0)
    v_mfma_f32_16x16x32_bf16 v[224:227], v[8:11], v[216:219], v[224:227]
    v_mfma_f32_16x16x32_bf16 v[232:235], v[152:155], v[220:223], 0
    v_mfma_f32_16x16x32_bf16 v[232:235], v[12:15], v[208:211], v[232:235]
    v_mfma_f32_16x16x32_bf16 v[232:235], v[16:19], v[212:215], v[232:235]
    v_mfma_f32_16x16x32_bf16 v[232:235], v[20:23], v[216:219], v[232:235]
    v_mfma_f32_16x16x32_bf16 v[228:231], v[156:159], v[220:223], 0
    v_mfma_f32_16x16x32_bf16 v[228:231], v[24:27], v[208:211], v[228:231]
    v_mfma_f32_16x16x32_bf16 v[228:231], v[28:31], v[212:215], v[228:231]
    v_mfma_f32_16x16x32_bf16 v[228:231], v[32:35], v[216:219], v[228:231]
    s_setprio 2
    s_nop 0
    s_nop 0
    ds_write_b128 v138, v[224:227] offset:16000
    ds_write_b128 v138, v[232:235] offset:16016
    v_cvt_pk_bf16_f32 v224, v224, v225
    v_cvt_pk_bf16_f32 v225, v226, v227
    v_cvt_pk_bf16_f32 v226, v232, v233
    v_cvt_pk_bf16_f32 v227, v234, v235
    v_min_u32 v224, -2, v224
    buffer_store_dwordx4 v[224:227], v137, s[32:35], s71 offen offset:0 sc1
    s_setprio 0
    v_mfma_f32_16x16x32_bf16 v[232:235], v[160:163], v[220:223], 0
    v_mfma_f32_16x16x32_bf16 v[232:235], v[36:39], v[208:211], v[232:235]
    v_mfma_f32_16x16x32_bf16 v[232:235], v[40:43], v[212:215], v[232:235]
    v_mfma_f32_16x16x32_bf16 v[232:235], v[44:47], v[216:219], v[232:235]
    v_mfma_f32_16x16x32_bf16 v[224:227], v[164:167], v[220:223], 0
    v_mfma_f32_16x16x32_bf16 v[224:227], v[48:51], v[208:211], v[224:227]
    v_mfma_f32_16x16x32_bf16 v[224:227], v[52:55], v[212:215], v[224:227]
    v_mfma_f32_16x16x32_bf16 v[224:227], v[56:59], v[216:219], v[224:227]
    s_setprio 2
    s_nop 0
    s_nop 0
    ds_write_b128 v138, v[228:231] offset:16128
    ds_write_b128 v138, v[232:235] offset:16144
    v_cvt_pk_bf16_f32 v228, v228, v229
    v_cvt_pk_bf16_f32 v229, v230, v231
    v_cvt_pk_bf16_f32 v230, v232, v233
    v_cvt_pk_bf16_f32 v231, v234, v235
    v_min_u32 v228, -2, v228
    buffer_store_dwordx4 v[228:231], v137, s[32:35], s71 offen offset:256 sc1
    s_setprio 0
    v_mfma_f32_16x16x32_bf16 v[232:235], v[168:171], v[220:223], 0
    v_mfma_f32_16x16x32_bf16 v[232:235], v[60:63], v[208:211], v[232:235]
    v_mfma_f32_16x16x32_bf16 v[232:235], v[64:67], v[212:215], v[232:235]
    v_mfma_f32_16x16x32_bf16 v[232:235], v[68:71], v[216:219], v[232:235]
    v_mfma_f32_16x16x32_bf16 v[228:231], v[172:175], v[220:223], 0
    v_mfma_f32_16x16x32_bf16 v[228:231], v[72:75], v[208:211], v[228:231]
    v_mfma_f32_16x16x32_bf16 v[228:231], v[76:79], v[212:215], v[228:231]
    v_mfma_f32_16x16x32_bf16 v[228:231], v[80:83], v[216:219], v[228:231]
    s_setprio 2
    s_nop 0
    s_nop 0
    ds_write_b128 v138, v[224:227] offset:16256
    ds_write_b128 v138, v[232:235] offset:16272
    v_cvt_pk_bf16_f32 v224, v224, v225
    v_cvt_pk_bf16_f32 v225, v226, v227
    v_cvt_pk_bf16_f32 v226, v232, v233
    v_cvt_pk_bf16_f32 v227, v234, v235
    v_min_u32 v224, -2, v224
    buffer_store_dwordx4 v[224:227], v137, s[32:35], s71 offen offset:512 sc1
    s_setprio 0
    v_mfma_f32_16x16x32_bf16 v[232:235], v[176:179], v[220:223], 0
    v_mfma_f32_16x16x32_bf16 v[232:235], v[84:87], v[208:211], v[232:235]
    v_mfma_f32_16x16x32_bf16 v[232:235], v[88:91], v[212:215], v[232:235]
    v_mfma_f32_16x16x32_bf16 v[232:235], v[92:95], v[216:219], v[232:235]
    s_setprio 2
    s_nop 0
    s_nop 0
    s_nop 0
    s_nop 0
    s_nop 0
    s_nop 0
    ds_write_b128 v138, v[228:231] offset:16384
    ds_write_b128 v138, v[232:235] offset:16400
    v_cvt_pk_bf16_f32 v228, v228, v229
    v_cvt_pk_bf16_f32 v229, v230, v231
    v_cvt_pk_bf16_f32 v230, v232, v233
    v_cvt_pk_bf16_f32 v231, v234, v235
    v_min_u32 v228, -2, v228
    buffer_store_dwordx4 v[228:231], v137, s[32:35], s71 offen offset:768 sc1
    s_mov_b64 exec, 2
    ds_add_u32 v129, v128 offset:0
    s_mov_b64 exec, -1
    s_lshl_b32 s53, s2, 2
    s_add_u32 s54, s53, s80
    s_lshl_b32 s54, s54, 12
    s_add_u32 s68, s54, 25165824
    s_add_u32 s54, s53, s81
    s_lshl_b32 s54, s54, 12
    s_add_u32 s69, s54, 25165824
    s_add_u32 s54, s53, s82
    s_lshl_b32 s54, s54, 12
    s_add_u32 s70, s54, 25165824
    s_waitcnt vmcnt(0)
    buffer_load_dwordx4 v[196:199], v136, s[32:35], s68 offen sc1
    buffer_load_dwordx4 v[200:203], v136, s[32:35], s69 offen sc1
    buffer_load_dwordx4 v[204:207], v136, s[32:35], s70 offen sc1
    s_mul_i32 s55, s49, 2112
    v_lshl_add_u32 v222, v128, 5, s55
gw_165:
    ds_read_b32 v141, v129 offset:16
    s_sub_i32 s52, s52, 1
    s_waitcnt lgkmcnt(0)
    v_readfirstlane_b32 s53, v141
    s_cmp_lt_u32 s53, 92
    s_cselect_b32 s53, s52, 0
    s_cmp_gt_i32 s53, 0
    s_cbranch_scc1 gw_165
    ds_read_b128 v[208:211], v222 offset:16000
    ds_read_b128 v[212:215], v222 offset:16016
    s_add_u32 s55, s57, 0
    s_waitcnt lgkmcnt(0)
    v_dot2c_f32_bf16 v208, s75, v188
    v_dot2c_f32_bf16 v209, s76, v188
    v_dot2c_f32_bf16 v210, s75, v189
    v_dot2c_f32_bf16 v211, s76, v189
    v_dot2c_f32_bf16 v212, s75, v190
    v_dot2c_f32_bf16 v213, s76, v190
    v_dot2c_f32_bf16 v214, s75, v191
    v_dot2c_f32_bf16 v215, s76, v191
    s_waitcnt vmcnt(0)
ck_166:
    v_max3_u32 v216, v196, v200, v204
    v_cmp_eq_u32 vcc, -1, v216
    s_cbranch_vccnz ckrt_168
ckok_167:
    v_dot2c_f32_bf16 v208, s75, v196
    v_dot2c_f32_bf16 v209, s76, v196
    v_dot2c_f32_bf16 v210, s75, v197
    v_dot2c_f32_bf16 v211, s76, v197
    v_dot2c_f32_bf16 v212, s75, v198
    v_dot2c_f32_bf16 v213, s76, v198
    v_dot2c_f32_bf16 v214, s75, v199
    v_dot2c_f32_bf16 v215, s76, v199
    v_dot2c_f32_bf16 v208, s75, v200
    v_dot2c_f32_bf16 v209, s76, v200
    v_dot2c_f32_bf16 v210, s75, v201
    v_dot2c_f32_bf16 v211, s76, v201
    v_dot2c_f32_bf16 v212, s75, v202
    v_dot2c_f32_bf16 v213, s76, v202
    v_dot2c_f32_bf16 v214, s75, v203
    v_dot2c_f32_bf16 v215, s76, v203
    v_dot2c_f32_bf16 v208, s75, v204
    v_dot2c_f32_bf16 v209, s76, v204
    v_dot2c_f32_bf16 v210, s75, v205
    v_dot2c_f32_bf16 v211, s76, v205
    v_dot2c_f32_bf16 v212, s75, v206
    v_dot2c_f32_bf16 v213, s76, v206
    v_dot2c_f32_bf16 v214, s75, v207
    v_dot2c_f32_bf16 v215, s76, v207
    s_nop 0
    v_pk_add_f32 v[216:217], v[208:209], v[210:211]
    v_pk_mul_f32 v[220:221], v[208:209], v[208:209]
    v_pk_add_f32 v[218:219], v[212:213], v[214:215]
    v_pk_fma_f32 v[220:221], v[210:211], v[210:211], v[220:221]
    v_pk_add_f32 v[216:217], v[216:217], v[218:219]
    v_pk_fma_f32 v[220:221], v[212:213], v[212:213], v[220:221]
    v_add_f32 v216, v216, v217
    v_pk_fma_f32 v[220:221], v[214:215], v[214:215], v[220:221]
    v_add_f32 v217, v220, v221
    v_lshlrev_b32 v196, 16, v180
    v_and_b32 v197, 0xffff0000, v180
    v_permlane32_swap_b32 v216, v217
    v_add_f32 v216, v216, v217
    v_lshlrev_b32 v198, 16, v181
    v_and_b32 v199, 0xffff0000, v181
    v_add_f32_dpp v216, v216, v216 quad_perm:[1,0,3,2] row_mask:0xf bank_mask:0xf
    v_lshlrev_b32 v200, 16, v182
    v_and_b32 v201, 0xffff0000, v182
    v_add_f32_dpp v216, v216, v216 quad_perm:[2,3,0,1] row_mask:0xf bank_mask:0xf
    v_lshlrev_b32 v202, 16, v183
    v_and_b32 v203, 0xffff0000, v183
    v_add_f32_dpp v216, v216, v216 row_half_mirror row_mask:0xf bank_mask:0xf
    s_nop 0
    s_nop 0
    v_add_f32_dpp v216, v216, v216 row_mirror row_mask:0xf bank_mask:0xf
    s_nop 0
    s_nop 0
    v_add_f32_dpp v216, v216, v216 row_bcast:15 row_mask:0xa bank_mask:0xf
    v_mul_f32 v216, 0x3b000000, v216
    s_nop 0
    v_readlane_b32 s59, v216, 63
    v_readlane_b32 s58, v216, 31
    s_nop 0
    v_mov_b32 v216, s59
    v_fma_f32 v216, -s58, s58, v216
    v_add_f32 v216, s91, abs(v216)
    v_rsq_f32 v216, v216
    s_nop 0
    v_mul_f32 v217, s58, v216
    v_pk_fma_f32 v[204:205], v[208:209], v[216:217], v[216:217] op_sel:[0,0,1] op_sel_hi:[1,0,1] neg_lo:[0,0,1] neg_hi:[0,0,1]
    v_pk_fma_f32 v[206:207], v[210:211], v[216:217], v[216:217] op_sel:[0,0,1] op_sel_hi:[1,0,1] neg_lo:[0,0,1] neg_hi:[0,0,1]
    v_pk_fma_f32 v[208:209], v[204:205], v[196:197], v[208:209]
    v_pk_fma_f32 v[210:211], v[206:207], v[198:199], v[210:211]
    v_pk_fma_f32 v[204:205], v[212:213], v[216:217], v[216:217] op_sel:[0,0,1] op_sel_hi:[1,0,1] neg_lo:[0,0,1] neg_hi:[0,0,1]
    v_pk_fma_f32 v[206:207], v[214:215], v[216:217], v[216:217] op_sel:[0,0,1] op_sel_hi:[1,0,1] neg_lo:[0,0,1] neg_hi:[0,0,1]
    v_pk_fma_f32 v[212:213], v[204:205], v[200:201], v[212:213]
    v_pk_fma_f32 v[214:215], v[206:207], v[202:203], v[214:215]
    v_cvt_pk_bf16_f32 v196, v208, v209
    v_cvt_pk_bf16_f32 v197, v210, v211
    v_cvt_pk_bf16_f32 v198, v212, v213
    v_cvt_pk_bf16_f32 v199, v214, v215
    buffer_store_dwordx4 v[196:199], v129, s[36:39], s55 offen sc1
rwok_170:
    ds_read_b32 v141, v129 offset:64
    s_sub_i32 s52, s52, 1
    s_waitcnt lgkmcnt(0)
    v_cmp_gt_u32 vcc, 0xc2216, v141
    s_and_b32 s53, vcc_lo, 15
    s_cselect_b32 s54, s52, 0
    s_cmp_gt_i32 s54, 0
    s_cbranch_scc1 rw_169
    ds_read2st64_b32 v[216:217], v134 offset0:0 offset1:9
    ds_read2st64_b32 v[218:219], v134 offset0:18 offset1:27
    ds_read_b64 v[208:209], v133 offset:28672
    ds_read_b64 v[210:211], v133 offset:30976
    ds_read_b64 v[212:213], v133 offset:33280
    ds_read_b64 v[214:215], v133 offset:35584
    ds_read2st64_b32 v[228:229], v134 offset0:36 offset1:45
    ds_read2st64_b32 v[230:231], v134 offset0:54 offset1:63
    ds_read_b64 v[220:221], v133 offset:37888
    ds_read_b64 v[222:223], v133 offset:40192
    ds_read_b64 v[224:225], v133 offset:42496
    ds_read_b64 v[226:227], v133 offset:44800
    s_waitcnt lgkmcnt(10)
    v_pk_add_f32 v[216:217], v[216:217], v[218:219]
    v_add_f32 v216, v216, v217
    v_rcp_f32 v218, v216
    v_subrev_u32 v216, s78, v216
    v_cmp_lt_u32 vcc, s79, v216
    s_waitcnt lgkmcnt(6)
    v_pk_add_f32 v[208:209], v[208:209], v[210:211]
    v_pk_add_f32 v[212:213], v[212:213], v[214:215]
    v_pk_add_f32 v[208:209], v[208:209], v[212:213]
    v_pk_mul_f32 v[208:209], v[208:209], v[218:219] op_sel_hi:[1,0]
    v_cvt_pk_bf16_f32 v208, v208, v209
    s_cbranch_vccnz sl_172
    ds_write_b32 v135, v208 offset:7680
slbk_173:
    s_waitcnt lgkmcnt(5)
    v_pk_add_f32 v[228:229], v[228:229], v[230:231]
    v_add_f32 v228, v228, v229
    v_rcp_f32 v230, v228
    v_subrev_u32 v228, s78, v228
    v_cmp_lt_u32 vcc, s79, v228
    s_waitcnt lgkmcnt(1)
    v_pk_add_f32 v[220:221], v[220:221], v[222:223]
    v_pk_add_f32 v[224:225], v[224:225], v[226:227]
    v_pk_add_f32 v[220:221], v[220:221], v[224:225]
    v_pk_mul_f32 v[220:221], v[220:221], v[230:231] op_sel_hi:[1,0]
    v_cvt_pk_bf16_f32 v220, v220, v221
    s_cbranch_vccnz sl_174
    ds_write_b32 v135, v220 offset:8704
slbk_175:
rwok_177:
    ds_read_b32 v141, v129 offset:64
    s_sub_i32 s52, s52, 1
    s_waitcnt lgkmcnt(0)
    v_cmp_gt_u32 vcc, 0xcfff3, v141
    s_and_b32 s53, vcc_lo, 15
    s_cselect_b32 s54, s52, 0
    s_cmp_gt_i32 s54, 0
    s_cbranch_scc1 rw_176
    ds_read2st64_b32 v[216:217], v134 offset0:72 offset1:81
    ds_read2st64_b32 v[218:219], v134 offset0:90 offset1:99
    ds_read_b64 v[208:209], v133 offset:47104
    ds_read_b64 v[210:211], v133 offset:49408
    ds_read_b64 v[212:213], v133 offset:51712
    ds_read_b64 v[214:215], v133 offset:54016
    s_waitcnt lgkmcnt(4)
    v_pk_add_f32 v[216:217], v[216:217], v[218:219]
    v_add_f32 v216, v216, v217
    v_rcp_f32 v218, v216
    v_subrev_u32 v216, s78, v216
    v_cmp_lt_u32 vcc, s79, v216
    s_waitcnt lgkmcnt(0)
    v_pk_add_f32 v[208:209], v[208:209], v[210:211]
    v_pk_add_f32 v[212:213], v[212:213], v[214:215]
    v_pk_add_f32 v[208:209], v[208:209], v[212:213]
    v_pk_mul_f32 v[208:209], v[208:209], v[218:219] op_sel_hi:[1,0]
    v_cvt_pk_bf16_f32 v208, v208, v209
    s_cbranch_vccnz sl_179
    ds_write_b32 v135, v208 offset:9728
slbk_180:
    s_mov_b64 exec, 2
    ds_add_u32 v129, v128 offset:0
    s_mov_b64 exec, -1
gw_181:
    ds_read_b32 v141, v129 offset:16
    s_sub_i32 s52, s52, 1
    s_waitcnt lgkmcnt(0)
    v_readfirstlane_b32 s53, v141
    s_cmp_lt_u32 s53, 96
    s_cselect_b32 s53, s52, 0
    s_cmp_gt_i32 s53, 0
    s_cbranch_scc1 gw_181
    s_mov_b32 s53, 1048576
    v_and_or_b32 v224, v137, s53, v132
    ds_read_b128 v[220:223], v224 offset:8064
    ds_read_b128 v[208:211], v224 offset:7680
    ds_read_b128 v[212:215], v224 offset:7808
    ds_read_b128 v[216:219], v224 offset:7936
    s_add_u32 s71, s74, 12582912
    s_waitcnt lgkmcnt(3)
    v_mfma_f32_16x16x32_bf16 v[224:227], v[148:151], v[220:223], 0
    s_waitcnt lgkmcnt(2)
    v_mfma_f32_16x16x32_bf16 v[224:227], v[0:3], v[208:211], v[224:227]
    s_waitcnt lgkmcnt(1)
    v_mfma_f32_16x16x32_bf16 v[224:227], v[4:7], v[212:215], v[224:227]
    s_waitcnt lgkmcnt(0)
    v_mfma_f32_16x16x32_bf16 v[224:227], v[8:11], v[216:219], v[224:227]
    v_mfma_f32_16x16x32_bf16 v[232:235], v[152:155], v[220:223], 0
    v_mfma_f32_16x16x32_bf16 v[232:235], v[12:15], v[208:211], v[232:235]
    v_mfma_f32_16x16x32_bf16 v[232:235], v[16:19], v[212:215], v[232:235]
    v_mfma_f32_16x16x32_bf16 v[232:235], v[20:23], v[216:219], v[232:235]
    v_mfma_f32_16x16x32_bf16 v[228:231], v[156:159], v[220:223], 0
    v_mfma_f32_16x16x32_bf16 v[228:231], v[24:27], v[208:211], v[228:231]
    v_mfma_f32_16x16x32_bf16 v[228:231], v[28:31], v[212:215], v[228:231]
    v_mfma_f32_16x16x32_bf16 v[228:231], v[32:35], v[216:219], v[228:231]
    s_nop 0
    s_nop 0
    s_nop 0
    v_cvt_pk_bf16_f32 v224, v224, v225
    v_cvt_pk_bf16_f32 v225, v226, v227
    v_cvt_pk_bf16_f32 v226, v232, v233
    v_cvt_pk_bf16_f32 v227, v234, v235
    v_min_u32 v224, -2, v224
    buffer_store_dwordx4 v[224:227], v137, s[32:35], s71 offen offset:0 sc1
    v_mfma_f32_16x16x32_bf16 v[232:235], v[160:163], v[220:223], 0
    v_mfma_f32_16x16x32_bf16 v[232:235], v[36:39], v[208:211], v[232:235]
    v_mfma_f32_16x16x32_bf16 v[232:235], v[40:43], v[212:215], v[232:235]
    v_mfma_f32_16x16x32_bf16 v[232:235], v[44:47], v[216:219], v[232:235]
    v_mfma_f32_16x16x32_bf16 v[224:227], v[164:167], v[220:223], 0
    v_mfma_f32_16x16x32_bf16 v[224:227], v[48:51], v[208:211], v[224:227]
    v_mfma_f32_16x16x32_bf16 v[224:227], v[52:55], v[212:215], v[224:227]
    v_mfma_f32_16x16x32_bf16 v[224:227], v[56:59], v[216:219], v[224:227]
    s_nop 0
    s_nop 0
    s_nop 0
    v_cvt_pk_bf16_f32 v228, v228, v229
    v_cvt_pk_bf16_f32 v229, v230, v231
    v_cvt_pk_bf16_f32 v230, v232, v233
    v_cvt_pk_bf16_f32 v231, v234, v235
    v_min_u32 v228, -2, v228
    buffer_store_dwordx4 v[228:231], v137, s[32:35], s71 offen offset:256 sc1
    v_mfma_f32_16x16x32_bf16 v[232:235], v[168:171], v[220:223], 0
    v_mfma_f32_16x16x32_bf16 v[232:235], v[60:63], v[208:211], v[232:235]
    v_mfma_f32_16x16x32_bf16 v[232:235], v[64:67], v[212:215], v[232:235]
    v_mfma_f32_16x16x32_bf16 v[232:235], v[68:71], v[216:219], v[232:235]
    v_mfma_f32_16x16x32_bf16 v[228:231], v[172:175], v[220:223], 0
    v_mfma_f32_16x16x32_bf16 v[228:231], v[72:75], v[208:211], v[228:231]
    v_mfma_f32_16x16x32_bf16 v[228:231], v[76:79], v[212:215], v[228:231]
    v_mfma_f32_16x16x32_bf16 v[228:231], v[80:83], v[216:219], v[228:231]
    s_nop 0
    s_nop 0
    s_nop 0
    v_cvt_pk_bf16_f32 v224, v224, v225
    v_cvt_pk_bf16_f32 v225, v226, v227
    v_cvt_pk_bf16_f32 v226, v232, v233
    v_cvt_pk_bf16_f32 v227, v234, v235
    v_min_u32 v224, -2, v224
    buffer_store_dwordx4 v[224:227], v137, s[32:35], s71 offen offset:512 sc1
    v_mfma_f32_16x16x32_bf16 v[232:235], v[176:179], v[220:223], 0
    v_mfma_f32_16x16x32_bf16 v[232:235], v[84:87], v[208:211], v[232:235]
    v_mfma_f32_16x16x32_bf16 v[232:235], v[88:91], v[212:215], v[232:235]
    v_mfma_f32_16x16x32_bf16 v[232:235], v[92:95], v[216:219], v[232:235]
    s_setprio 2
    s_nop 0
    s_nop 0
    s_nop 0
    s_nop 0
    s_nop 0
    s_nop 0
    v_cvt_pk_bf16_f32 v228, v228, v229
    v_cvt_pk_bf16_f32 v229, v230, v231
    v_cvt_pk_bf16_f32 v230, v232, v233
    v_cvt_pk_bf16_f32 v231, v234, v235
    v_min_u32 v228, -2, v228
    buffer_store_dwordx4 v[228:231], v137, s[32:35], s71 offen offset:768 sc1
    s_lshl_b32 s53, s2, 2
    s_add_u32 s54, s53, s80
    s_lshl_b32 s54, s54, 12
    s_add_u32 s68, s54, 29360128
    s_add_u32 s54, s53, s81
    s_lshl_b32 s54, s54, 12
    s_add_u32 s69, s54, 29360128
    s_add_u32 s54, s53, s82
    s_lshl_b32 s54, s54, 12
    s_add_u32 s70, s54, 29360128
    s_waitcnt lgkmcnt(0)
    s_barrier
    s_waitcnt vmcnt(0)
    buffer_load_dwordx4 v[196:199], v136, s[32:35], s68 offen sc1
    buffer_load_dwordx4 v[200:203], v136, s[32:35], s69 offen sc1
    buffer_load_dwordx4 v[204:207], v136, s[32:35], s70 offen sc1
    ds_read2st64_b32 v[216:217], v134 offset0:108 offset1:117
    ds_read2st64_b32 v[218:219], v134 offset0:126 offset1:135
    ds_read_b64 v[208:209], v133 offset:56320
    ds_read_b64 v[210:211], v133 offset:58624
    ds_read_b64 v[212:213], v133 offset:60928
    ds_read_b64 v[214:215], v133 offset:63232
    s_waitcnt lgkmcnt(4)
    v_pk_add_f32 v[216:217], v[216:217], v[218:219]
    v_add_f32 v216, v216, v217
    v_rcp_f32 v218, v216
    v_subrev_u32 v216, s78, v216
    v_cmp_lt_u32 vcc, s79, v216
    s_waitcnt lgkmcnt(0)
    v_pk_add_f32 v[208:209], v[208:209], v[210:211]
    v_pk_add_f32 v[212:213], v[212:213], v[214:215]
    v_pk_add_f32 v[208:209], v[208:209], v[212:213]
    v_pk_mul_f32 v[208:209], v[208:209], v[218:219] op_sel_hi:[1,0]
    v_cvt_pk_bf16_f32 v208, v208, v209
    s_cbranch_vccnz sl_182
    ds_write_b32 v135, v208 offset:10752
slbk_183:
    s_waitcnt lgkmcnt(0)
    s_barrier
    ds_read_b128 v[220:223], v132 offset:8064
    ds_read_b128 v[208:211], v132 offset:7680
    ds_read_b128 v[212:215], v132 offset:7808
    ds_read_b128 v[216:219], v132 offset:7936
PAD11:
    s_cbranch_execz PADRET
    s_waitcnt lgkmcnt(3)
    v_mfma_f32_16x16x32_bf16 v[224:227], v[148:151], v[220:223], 0
    s_waitcnt lgkmcnt(2)
    v_mfma_f32_16x16x32_bf16 v[224:227], v[0:3], v[208:211], v[224:227]
    s_waitcnt lgkmcnt(1)
    v_mfma_f32_16x16x32_bf16 v[224:227], v[4:7], v[212:215], v[224:227]
    s_waitcnt lgkmcnt(0)
    v_mfma_f32_16x16x32_bf16 v[224:227], v[8:11], v[216:219], v[224:227]
    v_mfma_f32_16x16x32_bf16 v[232:235], v[152:155], v[220:223], 0
    v_mfma_f32_16x16x32_bf16 v[232:235], v[12:15], v[208:211], v[232:235]
    v_mfma_f32_16x16x32_bf16 v[232:235], v[16:19], v[212:215], v[232:235]
    v_mfma_f32_16x16x32_bf16 v[232:235], v[20:23], v[216:219], v[232:235]
    v_mfma_f32_16x16x32_bf16 v[228:231], v[156:159], v[220:223], 0
    v_mfma_f32_16x16x32_bf16 v[228:231], v[24:27], v[208:211], v[228:231]
    v_mfma_f32_16x16x32_bf16 v[228:231], v[28:31], v[212:215], v[228:231]
    v_mfma_f32_16x16x32_bf16 v[228:231], v[32:35], v[216:219], v[228:231]
    s_nop 0
    s_nop 0
    s_nop 0
    ds_write_b128 v138, v[224:227] offset:16000
    ds_write_b128 v138, v[232:235] offset:16016
    v_mfma_f32_16x16x32_bf16 v[232:235], v[160:163], v[220:223], 0
    v_mfma_f32_16x16x32_bf16 v[232:235], v[36:39], v[208:211], v[232:235]
    v_mfma_f32_16x16x32_bf16 v[232:235], v[40:43], v[212:215], v[232:235]
    v_mfma_f32_16x16x32_bf16 v[232:235], v[44:47], v[216:219], v[232:235]
    v_mfma_f32_16x16x32_bf16 v[224:227], v[164:167], v[220:223], 0
    v_mfma_f32_16x16x32_bf16 v[224:227], v[48:51], v[208:211], v[224:227]
    v_mfma_f32_16x16x32_bf16 v[224:227], v[52:55], v[212:215], v[224:227]
    v_mfma_f32_16x16x32_bf16 v[224:227], v[56:59], v[216:219], v[224:227]
    s_nop 0
    s_nop 0
    s_nop 0
    ds_write_b128 v138, v[228:231] offset:16128
    ds_write_b128 v138, v[232:235] offset:16144
    v_mfma_f32_16x16x32_bf16 v[232:235], v[168:171], v[220:223], 0
    v_mfma_f32_16x16x32_bf16 v[232:235], v[60:63], v[208:211], v[232:235]
    v_mfma_f32_16x16x32_bf16 v[232:235], v[64:67], v[212:215], v[232:235]
    v_mfma_f32_16x16x32_bf16 v[232:235], v[68:71], v[216:219], v[232:235]
    v_mfma_f32_16x16x32_bf16 v[228:231], v[172:175], v[220:223], 0
    v_mfma_f32_16x16x32_bf16 v[228:231], v[72:75], v[208:211], v[228:231]
    v_mfma_f32_16x16x32_bf16 v[228:231], v[76:79], v[212:215], v[228:231]
    v_mfma_f32_16x16x32_bf16 v[228:231], v[80:83], v[216:219], v[228:231]
    s_nop 0
    s_nop 0
    s_nop 0
    ds_write_b128 v138, v[224:227] offset:16256
    ds_write_b128 v138, v[232:235] offset:16272
    v_mfma_f32_16x16x32_bf16 v[232:235], v[176:179], v[220:223], 0
    v_mfma_f32_16x16x32_bf16 v[232:235], v[84:87], v[208:211], v[232:235]
    v_mfma_f32_16x16x32_bf16 v[232:235], v[88:91], v[212:215], v[232:235]
    v_mfma_f32_16x16x32_bf16 v[232:235], v[92:95], v[216:219], v[232:235]
    s_setprio 2
    s_nop 0
    s_nop 0
    s_nop 0
    s_nop 0
    s_nop 0
    s_nop 0
    ds_write_b128 v138, v[228:231] offset:16384
    ds_write_b128 v138, v[232:235] offset:16400
    s_mul_i32 s55, s49, 2112
    v_lshl_add_u32 v222, v128, 5, s55
    v_lshlrev_b32 v208, 16, v192
    v_and_b32 v209, 0xffff0000, v192
    v_lshlrev_b32 v210, 16, v193
    v_and_b32 v211, 0xffff0000, v193
    v_lshlrev_b32 v212, 16, v194
    v_and_b32 v213, 0xffff0000, v194
    v_lshlrev_b32 v214, 16, v195
    v_and_b32 v215, 0xffff0000, v195
    s_waitcnt vmcnt(0)
ck_184:
    v_max3_u32 v216, v196, v200, v204
    v_cmp_eq_u32 vcc, -1, v216
    s_cbranch_vccnz ckrt_186
ckok_185:
    v_dot2c_f32_bf16 v208, s75, v196
    v_dot2c_f32_bf16 v209, s76, v196
    v_dot2c_f32_bf16 v210, s75, v197
    v_dot2c_f32_bf16 v211, s76, v197
    v_dot2c_f32_bf16 v212, s75, v198
    v_dot2c_f32_bf16 v213, s76, v198
    v_dot2c_f32_bf16 v214, s75, v199
    v_dot2c_f32_bf16 v215, s76, v199
    v_dot2c_f32_bf16 v208, s75, v200
    v_dot2c_f32_bf16 v209, s76, v200
    v_dot2c_f32_bf16 v210, s75, v201
    v_dot2c_f32_bf16 v211, s76, v201
    v_dot2c_f32_bf16 v212, s75, v202
    v_dot2c_f32_bf16 v213, s76, v202
    v_dot2c_f32_bf16 v214, s75, v203
    v_dot2c_f32_bf16 v215, s76, v203
    v_dot2c_f32_bf16 v208, s75, v204
    v_dot2c_f32_bf16 v209, s76, v204
    v_dot2c_f32_bf16 v210, s75, v205
    v_dot2c_f32_bf16 v211, s76, v205
    v_dot2c_f32_bf16 v212, s75, v206
    v_dot2c_f32_bf16 v213, s76, v206
    v_dot2c_f32_bf16 v214, s75, v207
    v_dot2c_f32_bf16 v215, s76, v207
    s_waitcnt lgkmcnt(0)
    s_barrier
    ds_read_b128 v[196:199], v222 offset:16000
    ds_read_b128 v[200:203], v222 offset:16016
    s_add_u32 s55, s57, 4096
    s_waitcnt lgkmcnt(0)
    v_pk_add_f32 v[208:209], v[208:209], v[196:197]
    v_pk_add_f32 v[210:211], v[210:211], v[198:199]
    v_pk_add_f32 v[212:213], v[212:213], v[200:201]
    v_pk_add_f32 v[214:215], v[214:215], v[202:203]
    v_pk_add_f32 v[216:217], v[208:209], v[210:211]
    v_pk_mul_f32 v[220:221], v[208:209], v[208:209]
    v_pk_add_f32 v[218:219], v[212:213], v[214:215]
    v_pk_fma_f32 v[220:221], v[210:211], v[210:211], v[220:221]
    v_pk_add_f32 v[216:217], v[216:217], v[218:219]
    v_pk_fma_f32 v[220:221], v[212:213], v[212:213], v[220:221]
    v_add_f32 v216, v216, v217
    v_pk_fma_f32 v[220:221], v[214:215], v[214:215], v[220:221]
    v_add_f32 v217, v220, v221
    v_lshlrev_b32 v196, 16, v184
    v_and_b32 v197, 0xffff0000, v184
    v_permlane32_swap_b32 v216, v217
    v_add_f32 v216, v216, v217
    v_lshlrev_b32 v198, 16, v185
    v_and_b32 v199, 0xffff0000, v185
    v_add_f32_dpp v216, v216, v216 quad_perm:[1,0,3,2] row_mask:0xf bank_mask:0xf
    v_lshlrev_b32 v200, 16, v186
    v_and_b32 v201, 0xffff0000, v186
    v_add_f32_dpp v216, v216, v216 quad_perm:[2,3,0,1] row_mask:0xf bank_mask:0xf
    v_lshlrev_b32 v202, 16, v187
    v_and_b32 v203, 0xffff0000, v187
    v_add_f32_dpp v216, v216, v216 row_half_mirror row_mask:0xf bank_mask:0xf
    s_nop 0
    s_nop 0
    v_add_f32_dpp v216, v216, v216 row_mirror row_mask:0xf bank_mask:0xf
    s_nop 0
    s_nop 0
    v_add_f32_dpp v216, v216, v216 row_bcast:15 row_mask:0xa bank_mask:0xf
    v_mul_f32 v216, 0x3b000000, v216
    s_nop 0
    v_readlane_b32 s59, v216, 63
    v_readlane_b32 s58, v216, 31
    s_nop 0
    v_mov_b32 v216, s59
    v_fma_f32 v216, -s58, s58, v216
    v_add_f32 v216, s91, abs(v216)
    v_rsq_f32 v216, v216
    s_nop 0
    v_mul_f32 v217, s58, v216
    v_pk_fma_f32 v[204:205], v[208:209], v[216:217], v[216:217] op_sel:[0,0,1] op_sel_hi:[1,0,1] neg_lo:[0,0,1] neg_hi:[0,0,1]
    v_pk_fma_f32 v[206:207], v[210:211], v[216:217], v[216:217] op_sel:[0,0,1] op_sel_hi:[1,0,1] neg_lo:[0,0,1] neg_hi:[0,0,1]
    v_pk_fma_f32 v[208:209], v[204:205], v[196:197], v[208:209]
    v_pk_fma_f32 v[210:211], v[206:207], v[198:199], v[210:211]
    v_pk_fma_f32 v[204:205], v[212:213], v[216:217], v[216:217] op_sel:[0,0,1] op_sel_hi:[1,0,1] neg_lo:[0,0,1] neg_hi:[0,0,1]
    v_pk_fma_f32 v[206:207], v[214:215], v[216:217], v[216:217] op_sel:[0,0,1] op_sel_hi:[1,0,1] neg_lo:[0,0,1] neg_hi:[0,0,1]
    v_pk_fma_f32 v[212:213], v[204:205], v[200:201], v[212:213]
    v_pk_fma_f32 v[214:215], v[206:207], v[202:203], v[214:215]
    v_cvt_pk_bf16_f32 v196, v208, v209
    v_cvt_pk_bf16_f32 v197, v210, v211
    v_cvt_pk_bf16_f32 v198, v212, v213
    v_cvt_pk_bf16_f32 v199, v214, v215
    buffer_store_dwordx4 v[196:199], v129, s[36:39], s55 offen sc1
    s_cmp_eq_u32 s67, 0
    s_cbranch_scc0 H_END
    v_mov_b32 v141, s51
    s_mov_b64 exec, 1
    buffer_store_dword v141, off, s[32:35], s67 sc1
    s_mov_b64 exec, -1
H_END:
    s_endpgm
ckrt_75:
    s_sub_i32 s52, s52, 1
    s_cmp_gt_i32 s52, 0
    s_cbranch_scc0 ckok_74
    s_sleep 8
    buffer_load_dword v166, v194, s[32:35], s69 offen sc1
    buffer_load_dword v167, v164, s[32:35], s70 offen sc1
    buffer_load_dword v168, v165, s[32:35], s71 offen sc1
    s_waitcnt vmcnt(0)
    s_branch ck_73
rw_80:
    s_cmp_eq_u32 s53, 15
    s_cbranch_scc0 rwok_81
    s_sleep 4
    s_branch rwok_81
sl_83:
    s_mov_b32 s83, 262144
    s_mov_b32 s84, 3584
    s_call_b64 s[62:63], EXACT
    s_branch slbk_84
sl_85:
    s_mov_b32 s83, 262144
    s_mov_b32 s84, 4608
    s_call_b64 s[62:63], EXACT
    s_branch slbk_86
rw_88:
    s_cmp_eq_u32 s53, 15
    s_cbranch_scc0 rwok_89
    s_sleep 4
    s_branch rwok_89
sl_91:
    s_mov_b32 s83, 262144
    s_mov_b32 s84, 5632
    s_call_b64 s[62:63], EXACT
    s_branch slbk_92
sl_93:
    s_mov_b32 s83, 262144
    s_mov_b32 s84, 6656
    s_call_b64 s[62:63], EXACT
    s_branch slbk_94
ckrt_97:
    s_sub_i32 s52, s52, 1
    s_cmp_gt_i32 s52, 0
    s_cbranch_scc0 ckok_96
    s_sleep 2
    buffer_load_dword v198, v197, s[32:35], s70 offen sc1
    buffer_load_dword v200, v199, s[32:35], s69 offen sc1
    s_waitcnt vmcnt(0)
    s_branch ck_95
ckrt_101:
    s_sub_i32 s52, s52, 1
    s_cmp_gt_i32 s52, 0
    s_cbranch_scc0 ckok_100
    s_sleep 4
    buffer_load_dwordx4 v[180:183], v142, s[32:35], s71 offen sc1
    buffer_load_dwordx4 v[184:187], v142, s[32:35], s56 offen sc1
    s_waitcnt vmcnt(0)
    s_branch ck_99
rw_102:
    s_cmp_eq_u32 s53, 15
    s_cbranch_scc0 rwok_103
    s_sleep 4
    s_branch rwok_103
sl_105:
    s_mov_b32 s83, 262144
    s_mov_b32 s84, 7680
    s_call_b64 s[62:63], EXACT
    s_branch slbk_106
ckrt_110:
    s_sub_i32 s52, s52, 1
    s_cmp_gt_i32 s52, 0
    s_cbranch_scc0 ckok_109
    s_sleep 4
    buffer_load_dwordx4 v[196:199], v136, s[32:35], s68 offen sc1
    buffer_load_dwordx4 v[200:203], v136, s[32:35], s69 offen sc1
    buffer_load_dwordx4 v[204:207], v136, s[32:35], s70 offen sc1
    s_waitcnt vmcnt(0)
    s_branch ck_108
rw_115:
    s_cmp_eq_u32 s53, 15
    s_cbranch_scc0 rwok_116
    s_sleep 4
    s_branch rwok_116
sl_118:
    s_mov_b32 s83, 262144
    s_mov_b32 s84, 8704
    s_call_b64 s[62:63], EXACT
    s_branch slbk_119
ckrt_122:
    s_sub_i32 s52, s52, 1
    s_cmp_gt_i32 s52, 0
    s_cbranch_scc0 ckok_121
    s_sleep 4
    buffer_load_dwordx4 v[196:199], v129, s[32:35], s68 offen sc1
    buffer_load_dwordx4 v[200:203], v129, s[32:35], s69 offen sc1
    buffer_load_dwordx4 v[204:207], v129, s[32:35], s70 offen sc1
    s_waitcnt vmcnt(0)
    s_branch ck_120
rw_125:
    s_cmp_eq_u32 s53, 15
    s_cbranch_scc0 rwok_126
    s_sleep 4
    s_branch rwok_126
sl_128:
    s_mov_b32 s83, 262144
    s_mov_b32 s84, 9728
    s_call_b64 s[62:63], EXACT
    s_branch slbk_129
rw_131:
    s_cmp_eq_u32 s53, 15
    s_cbranch_scc0 rwok_132
    s_sleep 4
    s_branch rwok_132
sl_134:
    s_mov_b32 s83, 262144
    s_mov_b32 s84, 10752
    s_call_b64 s[62:63], EXACT
    s_branch slbk_135
ckrt_139:
    s_sub_i32 s52, s52, 1
    s_cmp_gt_i32 s52, 0
    s_cbranch_scc0 ckok_138
    s_sleep 4
    buffer_load_dwordx4 v[196:199], v136, s[32:35], s68 offen sc1
    buffer_load_dwordx4 v[200:203], v136, s[32:35], s69 offen sc1
    buffer_load_dwordx4 v[204:207], v136, s[32:35], s70 offen sc1
    s_waitcnt vmcnt(0)
    s_branch ck_137
ckrt_147:
    s_sub_i32 s52, s52, 1
    s_cmp_gt_i32 s52, 0
    s_cbranch_scc0 ckok_146
    s_sleep 4
    buffer_load_dwordx4 v[196:199], v129, s[32:35], s68 offen sc1
    buffer_load_dwordx4 v[200:203], v129, s[32:35], s69 offen sc1
    buffer_load_dwordx4 v[204:207], v129, s[32:35], s70 offen sc1
    s_waitcnt vmcnt(0)
    s_branch ck_145
rw_150:
    s_cmp_eq_u32 s53, 15
    s_cbranch_scc0 rwok_151
    s_sleep 16
    s_branch rwok_151
sl_153:
    s_mov_b32 s83, 393216
    s_mov_b32 s84, 3584
    s_call_b64 s[62:63], EXACT
    s_branch slbk_154
sl_155:
    s_mov_b32 s83, 393216
    s_mov_b32 s84, 4608
    s_call_b64 s[62:63], EXACT
    s_branch slbk_156
sl_157:
    s_mov_b32 s83, 393216
    s_mov_b32 s84, 5632
    s_call_b64 s[62:63], EXACT
    s_branch slbk_158
rw_159:
    s_cmp_eq_u32 s53, 15
    s_cbranch_scc0 rwok_160
    s_sleep 4
    s_branch rwok_160
sl_162:
    s_mov_b32 s83, 393216
    s_mov_b32 s84, 6656
    s_call_b64 s[62:63], EXACT
    s_branch slbk_163
ckrt_168:
    s_sub_i32 s52, s52, 1
    s_cmp_gt_i32 s52, 0
    s_cbranch_scc0 ckok_167
    s_sleep 4
    buffer_load_dwordx4 v[196:199], v136, s[32:35], s68 offen sc1
    buffer_load_dwordx4 v[200:203], v136, s[32:35], s69 offen sc1
    buffer_load_dwordx4 v[204:207], v136, s[32:35], s70 offen sc1
    s_waitcnt vmcnt(0)
    s_branch ck_166
rw_169:
    s_cmp_eq_u32 s53, 15
    s_cbranch_scc0 rwok_170
    s_sleep 16
    s_branch rwok_170
sl_172:
    s_mov_b32 s83, 393216
    s_mov_b32 s84, 7680
    s_call_b64 s[62:63], EXACT
    s_branch slbk_173
sl_174:
    s_mov_b32 s83, 393216
    s_mov_b32 s84, 8704
    s_call_b64 s[62:63], EXACT
    s_branch slbk_175
rw_176:
    s_cmp_eq_u32 s53, 15
    s_cbranch_scc0 rwok_177
    s_sleep 4
    s_branch rwok_177
sl_179:
    s_mov_b32 s83, 393216
    s_mov_b32 s84, 9728
    s_call_b64 s[62:63], EXACT
    s_branch slbk_180
sl_182:
    s_mov_b32 s83, 393216
    s_mov_b32 s84, 10752
    s_call_b64 s[62:63], EXACT
    s_branch slbk_183
ckrt_186:
    s_sub_i32 s52, s52, 1
    s_cmp_gt_i32 s52, 0
    s_cbranch_scc0 ckok_185
    s_sleep 4
    buffer_load_dwordx4 v[196:199], v136, s[32:35], s68 offen sc1
    buffer_load_dwordx4 v[200:203], v136, s[32:35], s69 offen sc1
    buffer_load_dwordx4 v[204:207], v136, s[32:35], s70 offen sc1
    s_waitcnt vmcnt(0)
    s_branch ck_184
EXACT:
    s_waitcnt vmcnt(0) lgkmcnt(0)
    s_lshl_b32 s53, s2, 2
    s_add_u32 s53, s53, s49
    s_lshl_b32 s53, s53, 14
    s_add_u32 s86, s53, 67108864
    s_add_u32 s54, s86, 0
    buffer_store_dwordx4 v[196:199], v129, s[32:35], s54 offen sc1
    s_add_u32 s54, s86, 1024
    buffer_store_dwordx4 v[200:203], v129, s[32:35], s54 offen sc1
    s_add_u32 s54, s86, 2048
    buffer_store_dwordx4 v[204:207], v129, s[32:35], s54 offen sc1
    s_add_u32 s54, s86, 3072
    buffer_store_dwordx4 v[208:211], v129, s[32:35], s54 offen sc1
    s_add_u32 s54, s86, 4096
    buffer_store_dwordx4 v[212:215], v129, s[32:35], s54 offen sc1
    s_add_u32 s54, s86, 5120
    buffer_store_dwordx4 v[216:219], v129, s[32:35], s54 offen sc1
    s_add_u32 s54, s86, 6144
    buffer_store_dwordx4 v[220:223], v129, s[32:35], s54 offen sc1
    s_add_u32 s54, s86, 7168
    buffer_store_dwordx4 v[224:227], v129, s[32:35], s54 offen sc1
    s_add_u32 s54, s86, 8192
    buffer_store_dwordx4 v[228:231], v129, s[32:35], s54 offen sc1
    s_add_u32 s54, s86, 9216
    buffer_store_dwordx4 v[232:235], v129, s[32:35], s54 offen sc1
    s_add_u32 s54, s86, 10240
    buffer_store_dwordx4 v[236:239], v129, s[32:35], s54 offen sc1
    s_add_u32 s54, s86, 11264
    buffer_store_dwordx4 v[240:243], v129, s[32:35], s54 offen sc1
    s_add_u32 s54, s86, 12288
    buffer_store_dwordx4 v[244:247], v129, s[32:35], s54 offen sc1
    s_add_u32 s54, s86, 13312
    buffer_store_dwordx4 v[248:251], v129, s[32:35], s54 offen sc1
    s_waitcnt vmcnt(0)
    v_add_u32 v247, s84, v129
    ds_read_b128 v[240:243], v247
    s_add_u32 s85, s85, 4
    s_mov_b64 exec, 2
    ds_add_u32 v129, v128 offset:20
    s_mov_b64 exec, -1
gw_187:
    ds_read_b32 v141, v129 offset:36
    s_sub_i32 s52, s52, 1
    s_waitcnt lgkmcnt(0)
    v_readfirstlane_b32 s53, v141
    s_cmp_lt_u32 s53, s85
    s_cselect_b32 s53, s52, 0
    s_cmp_gt_i32 s53, 0
    s_cbranch_scc1 gw_187
    v_and_b32 v228, 31, v128
    v_lshrrev_b32 v229, 5, v128
    v_lshlrev_b32 v246, 5, v228
    v_lshl_add_u32 v246, v229, 4, v246
    v_lshlrev_b32 v247, 4, v228
    v_lshl_add_u32 v247, v229, 3, v247
    v_add_u32 v247, s84, v247
    v_mov_b32 v244, 0xff800000
    v_mov_b32 v245, 0xdddd
    v_mov_b32 v232, 0x3f803f80
    v_mov_b32 v233, 0x3f803f80
    v_mov_b32 v234, 0x3f803f80
    v_mov_b32 v235, 0x3f803f80
    v_mov_b32 v236, 0x3f803f80
    v_mov_b32 v237, 0x3f803f80
    v_mov_b32 v238, 0x3f803f80
    v_mov_b32 v239, 0x3f803f80
    v_mov_b64 v[212:213], 0
    v_mov_b64 v[214:215], 0
    v_mov_b64 v[216:217], 0
    v_mov_b64 v[218:219], 0
    v_mov_b64 v[220:221], 0
    v_mov_b64 v[222:223], 0
    v_mov_b64 v[224:225], 0
    v_mov_b64 v[226:227], 0
    s_mov_b32 s55, 0
EX_L0:
    s_and_b32 s53, s55, 32
    s_add_u32 s53, s53, s55
    s_lshl_b32 s53, s53, 10
    s_add_u32 s53, s53, s83
    buffer_load_dwordx4 v[228:231], v246, s[32:35], s53 offen sc1
    s_waitcnt vmcnt(0)
    v_mfma_f32_32x32x16_bf16 v[196:211], v[228:231], v[240:243], 0
    s_nop 0
    s_nop 0
    s_nop 0
    s_nop 0
    s_nop 0
    s_nop 0
    s_nop 0
    s_nop 0
    s_nop 0
    s_nop 0
    s_nop 0
    s_nop 0
    v_max3_f32 v244, v244, v196, v197
    v_max3_f32 v244, v244, v198, v199
    v_max3_f32 v244, v244, v200, v201
    v_max3_f32 v244, v244, v202, v203
    v_max3_f32 v244, v244, v204, v205
    v_max3_f32 v244, v244, v206, v207
    v_max3_f32 v244, v244, v208, v209
    v_max3_f32 v244, v244, v210, v211
    s_add_u32 s55, s55, 1
    s_cmp_lt_u32 s55, 64
    s_cbranch_scc1 EX_L0
    v_mov_b32 v248, v244
    s_nop 0
    s_nop 0
    v_permlane32_swap_b32 v244, v248
    v_max_f32 v244, v244, v248
    s_mov_b32 s55, 0
EX_L1:
    s_and_b32 s53, s55, 32
    s_add_u32 s53, s53, s55
    s_lshl_b32 s53, s53, 10
    s_add_u32 s53, s53, s83
    buffer_load_dwordx4 v[228:231], v246, s[32:35], s53 offen sc1
    s_add_u32 s53, s53, 32768
    s_mov_b32 exec_lo, 0xffff
    s_mov_b32 exec_hi, 0xffff
    buffer_load_dwordx4 v[232:235], v129, s[32:35], s53 offen offset:0 sc1
    buffer_load_dwordx4 v[236:239], v129, s[32:35], s53 offen offset:256 sc1
    s_mov_b64 exec, -1
    s_waitcnt vmcnt(0)
    v_mfma_f32_32x32x16_bf16 v[196:211], v[228:231], v[240:243], 0
    s_nop 0
    s_nop 0
    s_nop 0
    s_nop 0
    s_nop 0
    s_nop 0
    s_nop 0
    s_nop 0
    s_nop 0
    s_nop 0
    s_nop 0
    s_nop 0
    v_sub_f32 v196, v196, v244
    v_sub_f32 v197, v197, v244
    v_sub_f32 v198, v198, v244
    v_sub_f32 v199, v199, v244
    v_sub_f32 v200, v200, v244
    v_sub_f32 v201, v201, v244
    v_sub_f32 v202, v202, v244
    v_sub_f32 v203, v203, v244
    v_sub_f32 v204, v204, v244
    v_sub_f32 v205, v205, v244
    v_sub_f32 v206, v206, v244
    v_sub_f32 v207, v207, v244
    v_sub_f32 v208, v208, v244
    v_sub_f32 v209, v209, v244
    v_sub_f32 v210, v210, v244
    v_sub_f32 v211, v211, v244
    v_exp_f32 v196, v196
    v_exp_f32 v197, v197
    v_exp_f32 v198, v198
    v_exp_f32 v199, v199
    v_exp_f32 v200, v200
    v_exp_f32 v201, v201
    v_exp_f32 v202, v202
    v_exp_f32 v203, v203
    v_exp_f32 v204, v204
    v_exp_f32 v205, v205
    v_exp_f32 v206, v206
    v_exp_f32 v207, v207
    v_exp_f32 v208, v208
    v_exp_f32 v209, v209
    v_exp_f32 v210, v210
    v_exp_f32 v211, v211
    s_nop 0
    s_nop 0
    v_smfmac_f32_32x32x32_bf16 v[212:227], v[232:235], v[196:203], v245
    v_smfmac_f32_32x32x32_bf16 v[212:227], v[236:239], v[204:211], v245
    s_add_u32 s55, s55, 1
    s_cmp_lt_u32 s55, 64
    s_cbranch_scc1 EX_L1
    s_nop 0
    s_nop 0
    s_nop 0
    s_nop 0
    s_nop 0
    s_nop 0
    s_nop 0
    s_nop 0
    s_nop 0
    s_nop 0
    v_rcp_f32 v248, v220
    s_nop 0
    v_pk_mul_f32 v[212:213], v[212:213], v[248:249] op_sel_hi:[1,0]
    v_pk_mul_f32 v[214:215], v[214:215], v[248:249] op_sel_hi:[1,0]
    v_pk_mul_f32 v[216:217], v[216:217], v[248:249] op_sel_hi:[1,0]
    v_pk_mul_f32 v[218:219], v[218:219], v[248:249] op_sel_hi:[1,0]
    v_cvt_pk_bf16_f32 v212, v212, v213
    v_cvt_pk_bf16_f32 v213, v214, v215
    v_cvt_pk_bf16_f32 v214, v216, v217
    v_cvt_pk_bf16_f32 v215, v218, v219
    ds_write_b64 v247, v[212:213]
    ds_write_b64 v247, v[214:215] offset:512
    s_waitcnt lgkmcnt(0)
    s_add_u32 s54, s86, 0
    buffer_load_dwordx4 v[196:199], v129, s[32:35], s54 offen sc1
    s_add_u32 s54, s86, 1024
    buffer_load_dwordx4 v[200:203], v129, s[32:35], s54 offen sc1
    s_add_u32 s54, s86, 2048
    buffer_load_dwordx4 v[204:207], v129, s[32:35], s54 offen sc1
    s_add_u32 s54, s86, 3072
    buffer_load_dwordx4 v[208:211], v129, s[32:35], s54 offen sc1
    s_add_u32 s54, s86, 4096
    buffer_load_dwordx4 v[212:215], v129, s[32:35], s54 offen sc1
    s_add_u32 s54, s86, 5120
    buffer_load_dwordx4 v[216:219], v129, s[32:35], s54 offen sc1
    s_add_u32 s54, s86, 6144
    buffer_load_dwordx4 v[220:223], v129, s[32:35], s54 offen sc1
    s_add_u32 s54, s86, 7168
    buffer_load_dwordx4 v[224:227], v129, s[32:35], s54 offen sc1
    s_add_u32 s54, s86, 8192
    buffer_load_dwordx4 v[228:231], v129, s[32:35], s54 offen sc1
    s_add_u32 s54, s86, 9216
    buffer_load_dwordx4 v[232:235], v129, s[32:35], s54 offen sc1
    s_add_u32 s54, s86, 10240
    buffer_load_dwordx4 v[236:239], v129, s[32:35], s54 offen sc1
    s_add_u32 s54, s86, 11264
    buffer_load_dwordx4 v[240:243], v129, s[32:35], s54 offen sc1
    s_add_u32 s54, s86, 12288
    buffer_load_dwordx4 v[244:247], v129, s[32:35], s54 offen sc1
    s_add_u32 s54, s86, 13312
    buffer_load_dwordx4 v[248:251], v129, s[32:35], s54 offen sc1
    s_waitcnt vmcnt(0)
    s_setpc_b64 s[62:63]
CODE_END:
.section .rodata,"a"
.p2align 6
.amdhsa_kernel interleave_layers__grouped_kv_mqa__ssm_conv_h3__prompt_kernel
  .amdhsa_next_free_vgpr 256
  .amdhsa_next_free_sgpr 102
  .amdhsa_accum_offset 256
  .amdhsa_group_segment_fixed_size 0
  .amdhsa_kernarg_size 112
  .amdhsa_user_sgpr_count 2
  .amdhsa_user_sgpr_kernarg_segment_ptr 1
  .amdhsa_system_sgpr_workgroup_id_x 1
  .amdhsa_float_denorm_mode_32 3
.end_amdhsa_kernel
```
